```python
import torch

def _softmax(x, axis=-1):
    return torch.softmax(x, dim=axis)

def _gelu(x):
    return torch.nn.functional.gelu(x, approximate='tanh')

def _silu(x):
    return torch.nn.functional.silu(x)

def _sigmoid(x):
    return torch.sigmoid(x)

def _layernorm(x, axis=-1, eps=1e-05):
    m = x.mean(dim=axis, keepdim=True)
    v = x.var(dim=axis, keepdim=True, unbiased=False)
    return (x - m) / torch.sqrt(v + eps)

def _scatter_add(tgt, idx, src, axis=0):
    return tgt.clone().index_add_(axis, idx, src)

def _segment_sum(src, seg, n):
    out = torch.zeros((n,) + src.shape[1:], dtype=src.dtype)
    return out.index_add_(0, seg, src)

def _pad(x, pw):
    flat = tuple((v for pair in reversed(pw) for v in pair))
    return torch.nn.functional.pad(x, flat)
kernel_name = 'adaLN_cond__ssm_conv_s4__mixer_s_mlp__prompt'

def setup_inputs():

    _w = lambda a: (lambda t: t.to(torch.bfloat16) if t.is_floating_point() else t)(torch.as_tensor(a))

    def _A_setup():
        B, L, D, N = (1, 2048, 640, 128)
        A_re = -(lambda _x: torch.exp(torch.as_tensor(_x)))((lambda *s: torch.randn(*s, dtype=torch.bfloat16) * 3.2)(D, N))
        A_im = torch.pi * (lambda *s: torch.randn(*s, dtype=torch.bfloat16) * 0.1)(D, N)
        B_re = (lambda *s: torch.randn(*s, dtype=torch.bfloat16) * 0.2)(D, N)
        B_im = (lambda *s: torch.randn(*s, dtype=torch.bfloat16) * 0.2)(D, N)
        C_re = (lambda *s: torch.randn(*s, dtype=torch.bfloat16) * 0.2)(D, N)
        C_im = (lambda *s: torch.randn(*s, dtype=torch.bfloat16) * 0.2)(D, N)
        log_dt = (lambda *s: torch.randn(*s, dtype=torch.bfloat16) * 0.1)(D) * 0.5 - 4.0
        Dskip = (lambda *s: torch.randn(*s, dtype=torch.bfloat16) * 0.1)(D)
        return {'u': _w((lambda *s: torch.randn(*s, dtype=torch.bfloat16) * 0.05)(B, L, D)), 'A_re': _w(A_re), 'A_im': _w(A_im), 'B_re': _w(B_re), 'B_im': _w(B_im), 'C_re': _w(C_re), 'C_im': _w(C_im), 'log_dt': _w(log_dt), 'Dskip': _w(Dskip)}
    _A_in = _A_setup()

    def _B_setup():
        B, S, D, F = (1, 2048, 640, 1728)
        return {'x': _w((lambda *s: torch.randn(*s, dtype=torch.bfloat16) * 0.05)(B, S, D)), 'w1': _w((lambda *s: torch.randn(*s, dtype=torch.bfloat16) * 3.2)(D, D) * D ** (-0.5)), 'w2': _w((lambda *s: torch.randn(*s, dtype=torch.bfloat16) * 3.2)(D, D) * D ** (-0.5)), 'w3': _w((lambda *s: torch.randn(*s, dtype=torch.bfloat16) * 3.2)(D, F) * D ** (-0.5)), 'w4': _w((lambda *s: torch.randn(*s, dtype=torch.bfloat16) * 3.2)(F, D) * F ** (-0.5))}
    _B_in = _B_setup()
    return {'A_u': _A_in['u'], 'A_A_re': _A_in['A_re'], 'A_A_im': _A_in['A_im'], 'A_B_re': _A_in['B_re'], 'A_B_im': _A_in['B_im'], 'A_C_re': _A_in['C_re'], 'A_C_im': _A_in['C_im'], 'A_log_dt': _A_in['log_dt'], 'A_Dskip': _A_in['Dskip'], 'B_x': _B_in['x'], 'B_w1': _B_in['w1'], 'B_w2': _B_in['w2'], 'B_w3': _B_in['w3'], 'B_w4': _B_in['w4'], 'c': _w((lambda *s: torch.randn(*s, dtype=torch.bfloat16) * 0.1)(1, 640) * 8.0), 'w_mod': _w((lambda *s: torch.randn(*s, dtype=torch.bfloat16) * 0.1)(640, 6 * 640) * 640 ** (-0.5) * 8.0)}

def reference(A_u, A_A_re, A_A_im, A_B_re, A_B_im, A_C_re, A_C_im, A_log_dt, A_Dskip, B_x, B_w1, B_w2, B_w3, B_w4, c, w_mod):

    def _A_ref(u, A_re, A_im, B_re, B_im, C_re, C_im, log_dt, Dskip):
        Bsz, L, D = u.shape
        dt = torch.exp(log_dt)[:, None]
        A = A_re + 1j * A_im
        Bc = B_re + 1j * B_im
        Cc = C_re + 1j * C_im
        logdA = dt * A
        dB = dt * Bc
        l = (lambda x, dt: x.to(dt))(torch.arange(L), A_re.dtype)
        P = torch.exp(logdA[:, :, None] * l[None, None, :])
        K = torch.einsum('dn,dnl,dn->dl', Cc, P, dB).real
        L2 = 2 * L
        Kp = _pad(K, ((0, 0), (0, L)))
        up = (lambda x, *d: x.permute(*d))(u, 0, 2, 1)
        up = _pad(up, ((0, 0), (0, 0), (0, L)))
        Kf = (lambda x, axes=(-2, -1): torch.fft.rfft2(x.float(), dim=axes))(Kp[:, None, :], axes=(-2, -1))
        Uf = (lambda x, axes=(-2, -1): torch.fft.rfft2(x.float(), dim=axes))(up[:, :, None, :], axes=(-2, -1))
        Yf = Uf * Kf[None, :, :, :]
        y = (lambda x, s, axes=(-2, -1): torch.fft.irfft2(x, s=s, dim=axes).to(torch.bfloat16))(Yf, (1, L2), axes=(-2, -1))[:, :, 0, :L]
        y = (lambda x, *d: x.permute(*d))(y, 0, 2, 1) + u * Dskip[None, None, :]
        return y

    def _B_ref(x, w1, w2, w3, w4):
        B, S, D = x.shape
        h = _gelu(_layernorm(x, axis=-1) @ w1)
        c = D // 4
        g0 = _pad(h[:, :, 0 * c:1 * c], ((0, 0), (1, 0), (0, 0)))[:, :S, :]
        g1 = _pad(h[:, :, 1 * c:2 * c], ((0, 0), (0, 1), (0, 0)))[:, 1:, :]
        g2 = _pad(h[:, :, 2 * c:3 * c], ((0, 0), (2, 0), (0, 0)))[:, :S, :]
        g3 = _pad(h[:, :, 3 * c:], ((0, 0), (0, 2), (0, 0)))[:, 2:, :]
        hs = torch.concatenate([g0, g1, g2, g3], axis=-1) @ w2
        x1 = x + hs
        h2 = _gelu(_layernorm(x1, axis=-1) @ w3) @ w4
        return x1 + h2
    x = A_u
    mod = (_silu(c) @ w_mod).reshape(c.shape[0], 6, 1, -1)
    sa, ca, ga, sb, cb, gb = (mod[:, 0].clone(), mod[:, 1].clone(), mod[:, 2].clone(), mod[:, 3].clone(), mod[:, 4].clone(), mod[:, 5].clone())
    h = _layernorm(x, axis=-1) * (1 + ca) + sa
    x = x + ga * _A_ref(h, A_A_re, A_A_im, A_B_re, A_B_im, A_C_re, A_C_im, A_log_dt, A_Dskip)
    h = _layernorm(x, axis=-1) * (1 + cb) + sb
    x = x + gb * _B_ref(h, B_w1, B_w2, B_w3, B_w4)
    return x
```

```asm
; @launch kernel=k1_kernel grid=(478,1,1) block=(256,1,1) lds=45056
; @launch kernel=k2_kernel grid=(227,1,1) block=(512,1,1) lds=142336
; @launch kernel=adaLN_cond__ssm_conv_s4__mixer_s_mlp__prompt_kernel grid=(256,1,1) block=(512,1,1) lds=144384
.amdgcn_target "amdgcn-amd-amdhsa--gfx950"
.text
.globl k1_kernel
.p2align 8
.type k1_kernel,@function
k1_kernel:
    s_cmp_ge_u32 s2, 478
    s_cbranch_scc1 K1_end
    s_add_u32 s20, s2, 158
    s_sub_u32 s21, s2, 320
    s_cmp_lt_u32 s2, 320
    s_cselect_b32 s2, s20, s21
    v_lshrrev_b32 v1, 6, v0
    s_nop 0
    v_readfirstlane_b32 s3, v1
    s_load_dwordx2 s[4:5], s[0:1], 144
    s_cmp_ge_u32 s2, 158
    s_cbranch_scc1 K1_kgen
    s_cmp_ge_u32 s2, 128
    s_cbranch_scc1 K1_mod
    s_load_dwordx2 s[6:7], s[0:1], 0
    s_waitcnt lgkmcnt(0)
    s_mov_b32 s8, s6
    s_mov_b32 s9, s7
    s_mov_b32 s10, 2621440
    s_mov_b32 s11, 0x00020000
    v_lshrrev_b32 v1, 4, v0
    v_and_b32 v2, 15, v0
    s_lshl_b32 s12, s2, 4
    v_add_u32 v3, s12, v1
    v_mul_u32_u24 v3, 1280, v3
    v_lshl_add_u32 v3, v2, 4, v3
    buffer_load_dwordx4 v[8:11], v3, s[8:11], 0 offen offset:0
    buffer_load_dwordx4 v[12:15], v3, s[8:11], 0 offen offset:256
    buffer_load_dwordx4 v[16:19], v3, s[8:11], 0 offen offset:512
    buffer_load_dwordx4 v[20:23], v3, s[8:11], 0 offen offset:768
    buffer_load_dwordx4 v[24:27], v3, s[8:11], 0 offen offset:1024
    v_mul_u32_u24 v4, 1344, v1
    v_lshl_add_u32 v4, v2, 4, v4
    s_add_u32 s12, s4, 1048576
    s_addc_u32 s13, s5, 0
    s_mov_b32 s14, 2621440
    s_mov_b32 s15, 0x00020000
    s_add_u32 s16, s4, 4194304
    s_addc_u32 s17, s5, 0
    s_mov_b32 s18, 2621440
    s_mov_b32 s19, 0x00020000
    s_waitcnt vmcnt(0)
    ds_write_b128 v4, v[8:11] offset:21504
    ds_write_b128 v4, v[12:15] offset:21760
    ds_write_b128 v4, v[16:19] offset:22016
    ds_write_b128 v4, v[20:23] offset:22272
    ds_write_b128 v4, v[24:27] offset:22528
    v_lshlrev_b32 v32, 16, v8
    v_and_b32 v33, 0xffff0000, v8
    v_lshlrev_b32 v34, 16, v9
    v_and_b32 v35, 0xffff0000, v9
    v_lshlrev_b32 v36, 16, v10
    v_and_b32 v37, 0xffff0000, v10
    v_lshlrev_b32 v38, 16, v11
    v_and_b32 v39, 0xffff0000, v11
    v_lshlrev_b32 v40, 16, v12
    v_and_b32 v41, 0xffff0000, v12
    v_lshlrev_b32 v42, 16, v13
    v_and_b32 v43, 0xffff0000, v13
    v_lshlrev_b32 v44, 16, v14
    v_and_b32 v45, 0xffff0000, v14
    v_lshlrev_b32 v46, 16, v15
    v_and_b32 v47, 0xffff0000, v15
    v_lshlrev_b32 v48, 16, v16
    v_and_b32 v49, 0xffff0000, v16
    v_lshlrev_b32 v50, 16, v17
    v_and_b32 v51, 0xffff0000, v17
    v_lshlrev_b32 v52, 16, v18
    v_and_b32 v53, 0xffff0000, v18
    v_lshlrev_b32 v54, 16, v19
    v_and_b32 v55, 0xffff0000, v19
    v_lshlrev_b32 v56, 16, v20
    v_and_b32 v57, 0xffff0000, v20
    v_lshlrev_b32 v58, 16, v21
    v_and_b32 v59, 0xffff0000, v21
    v_lshlrev_b32 v60, 16, v22
    v_and_b32 v61, 0xffff0000, v22
    v_lshlrev_b32 v62, 16, v23
    v_and_b32 v63, 0xffff0000, v23
    v_lshlrev_b32 v64, 16, v24
    v_and_b32 v65, 0xffff0000, v24
    v_lshlrev_b32 v66, 16, v25
    v_and_b32 v67, 0xffff0000, v25
    v_lshlrev_b32 v68, 16, v26
    v_and_b32 v69, 0xffff0000, v26
    v_lshlrev_b32 v70, 16, v27
    v_and_b32 v71, 0xffff0000, v27
    v_add_f32 v5, v32, v33
    v_add_f32 v5, v5, v34
    v_add_f32 v5, v5, v35
    v_add_f32 v5, v5, v36
    v_add_f32 v5, v5, v37
    v_add_f32 v5, v5, v38
    v_add_f32 v5, v5, v39
    v_add_f32 v5, v5, v40
    v_add_f32 v5, v5, v41
    v_add_f32 v5, v5, v42
    v_add_f32 v5, v5, v43
    v_add_f32 v5, v5, v44
    v_add_f32 v5, v5, v45
    v_add_f32 v5, v5, v46
    v_add_f32 v5, v5, v47
    v_add_f32 v5, v5, v48
    v_add_f32 v5, v5, v49
    v_add_f32 v5, v5, v50
    v_add_f32 v5, v5, v51
    v_add_f32 v5, v5, v52
    v_add_f32 v5, v5, v53
    v_add_f32 v5, v5, v54
    v_add_f32 v5, v5, v55
    v_add_f32 v5, v5, v56
    v_add_f32 v5, v5, v57
    v_add_f32 v5, v5, v58
    v_add_f32 v5, v5, v59
    v_add_f32 v5, v5, v60
    v_add_f32 v5, v5, v61
    v_add_f32 v5, v5, v62
    v_add_f32 v5, v5, v63
    v_add_f32 v5, v5, v64
    v_add_f32 v5, v5, v65
    v_add_f32 v5, v5, v66
    v_add_f32 v5, v5, v67
    v_add_f32 v5, v5, v68
    v_add_f32 v5, v5, v69
    v_add_f32 v5, v5, v70
    v_add_f32 v5, v5, v71
    s_nop 1
    v_add_f32_dpp v5, v5, v5 row_ror:8 row_mask:0xf bank_mask:0xf
    s_nop 1
    v_add_f32_dpp v5, v5, v5 row_ror:4 row_mask:0xf bank_mask:0xf
    s_nop 1
    v_add_f32_dpp v5, v5, v5 row_ror:2 row_mask:0xf bank_mask:0xf
    s_nop 1
    v_add_f32_dpp v5, v5, v5 row_ror:1 row_mask:0xf bank_mask:0xf
    v_mul_f32 v5, 0.0015625, v5
    v_sub_f32 v32, v32, v5
    v_sub_f32 v33, v33, v5
    v_sub_f32 v34, v34, v5
    v_sub_f32 v35, v35, v5
    v_sub_f32 v36, v36, v5
    v_sub_f32 v37, v37, v5
    v_sub_f32 v38, v38, v5
    v_sub_f32 v39, v39, v5
    v_sub_f32 v40, v40, v5
    v_sub_f32 v41, v41, v5
    v_sub_f32 v42, v42, v5
    v_sub_f32 v43, v43, v5
    v_sub_f32 v44, v44, v5
    v_sub_f32 v45, v45, v5
    v_sub_f32 v46, v46, v5
    v_sub_f32 v47, v47, v5
    v_sub_f32 v48, v48, v5
    v_sub_f32 v49, v49, v5
    v_sub_f32 v50, v50, v5
    v_sub_f32 v51, v51, v5
    v_sub_f32 v52, v52, v5
    v_sub_f32 v53, v53, v5
    v_sub_f32 v54, v54, v5
    v_sub_f32 v55, v55, v5
    v_sub_f32 v56, v56, v5
    v_sub_f32 v57, v57, v5
    v_sub_f32 v58, v58, v5
    v_sub_f32 v59, v59, v5
    v_sub_f32 v60, v60, v5
    v_sub_f32 v61, v61, v5
    v_sub_f32 v62, v62, v5
    v_sub_f32 v63, v63, v5
    v_sub_f32 v64, v64, v5
    v_sub_f32 v65, v65, v5
    v_sub_f32 v66, v66, v5
    v_sub_f32 v67, v67, v5
    v_sub_f32 v68, v68, v5
    v_sub_f32 v69, v69, v5
    v_sub_f32 v70, v70, v5
    v_sub_f32 v71, v71, v5
    v_mul_f32 v6, v32, v32
    v_fmac_f32 v6, v33, v33
    v_fmac_f32 v6, v34, v34
    v_fmac_f32 v6, v35, v35
    v_fmac_f32 v6, v36, v36
    v_fmac_f32 v6, v37, v37
    v_fmac_f32 v6, v38, v38
    v_fmac_f32 v6, v39, v39
    v_fmac_f32 v6, v40, v40
    v_fmac_f32 v6, v41, v41
    v_fmac_f32 v6, v42, v42
    v_fmac_f32 v6, v43, v43
    v_fmac_f32 v6, v44, v44
    v_fmac_f32 v6, v45, v45
    v_fmac_f32 v6, v46, v46
    v_fmac_f32 v6, v47, v47
    v_fmac_f32 v6, v48, v48
    v_fmac_f32 v6, v49, v49
    v_fmac_f32 v6, v50, v50
    v_fmac_f32 v6, v51, v51
    v_fmac_f32 v6, v52, v52
    v_fmac_f32 v6, v53, v53
    v_fmac_f32 v6, v54, v54
    v_fmac_f32 v6, v55, v55
    v_fmac_f32 v6, v56, v56
    v_fmac_f32 v6, v57, v57
    v_fmac_f32 v6, v58, v58
    v_fmac_f32 v6, v59, v59
    v_fmac_f32 v6, v60, v60
    v_fmac_f32 v6, v61, v61
    v_fmac_f32 v6, v62, v62
    v_fmac_f32 v6, v63, v63
    v_fmac_f32 v6, v64, v64
    v_fmac_f32 v6, v65, v65
    v_fmac_f32 v6, v66, v66
    v_fmac_f32 v6, v67, v67
    v_fmac_f32 v6, v68, v68
    v_fmac_f32 v6, v69, v69
    v_fmac_f32 v6, v70, v70
    v_fmac_f32 v6, v71, v71
    s_nop 1
    v_add_f32_dpp v6, v6, v6 row_ror:8 row_mask:0xf bank_mask:0xf
    s_nop 1
    v_add_f32_dpp v6, v6, v6 row_ror:4 row_mask:0xf bank_mask:0xf
    s_nop 1
    v_add_f32_dpp v6, v6, v6 row_ror:2 row_mask:0xf bank_mask:0xf
    s_nop 1
    v_add_f32_dpp v6, v6, v6 row_ror:1 row_mask:0xf bank_mask:0xf
    v_mov_b32 v7, 1e-5
    v_fmac_f32 v7, 0.0015625, v6
    v_rsq_f32 v7, v7
    s_nop 0
    v_mul_f32 v32, v32, v7
    v_mul_f32 v33, v33, v7
    v_cvt_pk_bf16_f32 v8, v32, v33
    v_mul_f32 v34, v34, v7
    v_mul_f32 v35, v35, v7
    v_cvt_pk_bf16_f32 v9, v34, v35
    v_mul_f32 v36, v36, v7
    v_mul_f32 v37, v37, v7
    v_cvt_pk_bf16_f32 v10, v36, v37
    v_mul_f32 v38, v38, v7
    v_mul_f32 v39, v39, v7
    v_cvt_pk_bf16_f32 v11, v38, v39
    v_mul_f32 v40, v40, v7
    v_mul_f32 v41, v41, v7
    v_cvt_pk_bf16_f32 v12, v40, v41
    v_mul_f32 v42, v42, v7
    v_mul_f32 v43, v43, v7
    v_cvt_pk_bf16_f32 v13, v42, v43
    v_mul_f32 v44, v44, v7
    v_mul_f32 v45, v45, v7
    v_cvt_pk_bf16_f32 v14, v44, v45
    v_mul_f32 v46, v46, v7
    v_mul_f32 v47, v47, v7
    v_cvt_pk_bf16_f32 v15, v46, v47
    v_mul_f32 v48, v48, v7
    v_mul_f32 v49, v49, v7
    v_cvt_pk_bf16_f32 v16, v48, v49
    v_mul_f32 v50, v50, v7
    v_mul_f32 v51, v51, v7
    v_cvt_pk_bf16_f32 v17, v50, v51
    v_mul_f32 v52, v52, v7
    v_mul_f32 v53, v53, v7
    v_cvt_pk_bf16_f32 v18, v52, v53
    v_mul_f32 v54, v54, v7
    v_mul_f32 v55, v55, v7
    v_cvt_pk_bf16_f32 v19, v54, v55
    v_mul_f32 v56, v56, v7
    v_mul_f32 v57, v57, v7
    v_cvt_pk_bf16_f32 v20, v56, v57
    v_mul_f32 v58, v58, v7
    v_mul_f32 v59, v59, v7
    v_cvt_pk_bf16_f32 v21, v58, v59
    v_mul_f32 v60, v60, v7
    v_mul_f32 v61, v61, v7
    v_cvt_pk_bf16_f32 v22, v60, v61
    v_mul_f32 v62, v62, v7
    v_mul_f32 v63, v63, v7
    v_cvt_pk_bf16_f32 v23, v62, v63
    v_mul_f32 v64, v64, v7
    v_mul_f32 v65, v65, v7
    v_cvt_pk_bf16_f32 v24, v64, v65
    v_mul_f32 v66, v66, v7
    v_mul_f32 v67, v67, v7
    v_cvt_pk_bf16_f32 v25, v66, v67
    v_mul_f32 v68, v68, v7
    v_mul_f32 v69, v69, v7
    v_cvt_pk_bf16_f32 v26, v68, v69
    v_mul_f32 v70, v70, v7
    v_mul_f32 v71, v71, v7
    v_cvt_pk_bf16_f32 v27, v70, v71
    ds_write_b128 v4, v[8:11] offset:0
    ds_write_b128 v4, v[12:15] offset:256
    ds_write_b128 v4, v[16:19] offset:512
    ds_write_b128 v4, v[20:23] offset:768
    ds_write_b128 v4, v[24:27] offset:1024
    v_and_b32 v1, 63, v0
    v_lshrrev_b32 v2, 4, v1
    v_and_b32 v3, 15, v1
    v_lshrrev_b32 v5, 2, v3
    v_and_b32 v6, 3, v3
    v_mul_u32_u24 v5, 1344, v5
    v_lshl_add_u32 v5, v6, 3, v5
    v_lshl_add_u32 v5, v2, 5, v5
    s_lshl_b32 s20, s3, 7
    v_add_u32 v5, s20, v5
    v_lshlrev_b32 v6, 4, v1
    s_lshl_b32 s21, s3, 10
    s_mul_i32 s22, s2, 20480
    s_add_u32 s21, s21, s22
    v_add_u32 v6, s21, v6
    s_waitcnt lgkmcnt(0)
    s_barrier
    ds_read_b64_tr_b16 v[8:9], v5 offset:0
    ds_read_b64_tr_b16 v[10:11], v5 offset:5376
    ds_read_b64_tr_b16 v[12:13], v5 offset:10752
    ds_read_b64_tr_b16 v[14:15], v5 offset:16128
    ds_read_b64_tr_b16 v[16:17], v5 offset:21504
    ds_read_b64_tr_b16 v[18:19], v5 offset:26880
    ds_read_b64_tr_b16 v[20:21], v5 offset:32256
    ds_read_b64_tr_b16 v[22:23], v5 offset:37632
    s_waitcnt lgkmcnt(4)
    s_mov_b32 s23, 0
    s_mov_b32 s24, 10240
    buffer_store_dwordx4 v[8:11], v6, s[12:15], s23 offen
    buffer_store_dwordx4 v[12:15], v6, s[12:15], s24 offen
    s_waitcnt lgkmcnt(0)
    s_mov_b32 s23, 0
    s_mov_b32 s24, 10240
    buffer_store_dwordx4 v[16:19], v6, s[16:19], s23 offen
    buffer_store_dwordx4 v[20:23], v6, s[16:19], s24 offen
    s_nop 1
    ds_read_b64_tr_b16 v[8:9], v5 offset:512
    ds_read_b64_tr_b16 v[10:11], v5 offset:5888
    ds_read_b64_tr_b16 v[12:13], v5 offset:11264
    ds_read_b64_tr_b16 v[14:15], v5 offset:16640
    ds_read_b64_tr_b16 v[16:17], v5 offset:22016
    ds_read_b64_tr_b16 v[18:19], v5 offset:27392
    ds_read_b64_tr_b16 v[20:21], v5 offset:32768
    ds_read_b64_tr_b16 v[22:23], v5 offset:38144
    s_waitcnt lgkmcnt(4)
    s_mov_b32 s23, 4096
    s_mov_b32 s24, 14336
    buffer_store_dwordx4 v[8:11], v6, s[12:15], s23 offen
    buffer_store_dwordx4 v[12:15], v6, s[12:15], s24 offen
    s_waitcnt lgkmcnt(0)
    s_mov_b32 s23, 4096
    s_mov_b32 s24, 14336
    buffer_store_dwordx4 v[16:19], v6, s[16:19], s23 offen
    buffer_store_dwordx4 v[20:23], v6, s[16:19], s24 offen
    s_nop 1
    s_cmp_ge_u32 s3, 2
    s_cbranch_scc1 K1_end
    ds_read_b64_tr_b16 v[8:9], v5 offset:1024
    ds_read_b64_tr_b16 v[10:11], v5 offset:6400
    ds_read_b64_tr_b16 v[12:13], v5 offset:11776
    ds_read_b64_tr_b16 v[14:15], v5 offset:17152
    ds_read_b64_tr_b16 v[16:17], v5 offset:22528
    ds_read_b64_tr_b16 v[18:19], v5 offset:27904
    ds_read_b64_tr_b16 v[20:21], v5 offset:33280
    ds_read_b64_tr_b16 v[22:23], v5 offset:38656
    s_waitcnt lgkmcnt(4)
    s_mov_b32 s23, 8192
    s_mov_b32 s24, 18432
    buffer_store_dwordx4 v[8:11], v6, s[12:15], s23 offen
    buffer_store_dwordx4 v[12:15], v6, s[12:15], s24 offen
    s_waitcnt lgkmcnt(0)
    s_mov_b32 s23, 8192
    s_mov_b32 s24, 18432
    buffer_store_dwordx4 v[16:19], v6, s[16:19], s23 offen
    buffer_store_dwordx4 v[20:23], v6, s[16:19], s24 offen
    s_nop 1
    s_endpgm
K1_mod:
    s_load_dwordx2 s[6:7], s[0:1], 120
    s_load_dwordx2 s[8:9], s[0:1], 112
    s_sub_u32 s22, s2, 128
    s_add_u32 s22, s22, 0
    v_lshrrev_b32 v1, 3, v0
    v_and_b32 v2, 7, v0
    v_mul_u32_u24 v3, 20, v1
    v_mul_u32_u24 v4, 7680, v3
    v_lshl_add_u32 v4, v2, 4, v4
    s_lshl_b32 s24, s22, 7
    v_add_u32 v4, s24, v4
    v_lshlrev_b32 v3, 1, v3
    s_waitcnt lgkmcnt(0)
    s_mov_b32 s12, s6
    s_mov_b32 s13, s7
    s_mov_b32 s14, 4915200
    s_mov_b32 s15, 0x00020000
    s_mov_b32 s16, s8
    s_mov_b32 s17, s9
    s_mov_b32 s18, 1280
    s_mov_b32 s19, 0x00020000
    buffer_load_dwordx4 v[8:11], v3, s[16:19], 0 offen
    buffer_load_dwordx4 v[12:15], v3, s[16:19], 0 offen offset:16
    buffer_load_dwordx2 v[16:17], v3, s[16:19], 0 offen offset:32
    s_mov_b32 s25, 0
    buffer_load_dwordx4 v[48:51], v4, s[12:15], s25 offen
    s_mov_b32 s25, 7680
    buffer_load_dwordx4 v[52:55], v4, s[12:15], s25 offen
    s_mov_b32 s25, 15360
    buffer_load_dwordx4 v[56:59], v4, s[12:15], s25 offen
    s_mov_b32 s25, 23040
    buffer_load_dwordx4 v[60:63], v4, s[12:15], s25 offen
    s_mov_b32 s25, 30720
    buffer_load_dwordx4 v[64:67], v4, s[12:15], s25 offen
    s_mov_b32 s25, 38400
    buffer_load_dwordx4 v[68:71], v4, s[12:15], s25 offen
    s_mov_b32 s25, 46080
    buffer_load_dwordx4 v[72:75], v4, s[12:15], s25 offen
    s_mov_b32 s25, 53760
    buffer_load_dwordx4 v[76:79], v4, s[12:15], s25 offen
    s_mov_b32 s25, 61440
    buffer_load_dwordx4 v[80:83], v4, s[12:15], s25 offen
    s_mov_b32 s25, 69120
    buffer_load_dwordx4 v[84:87], v4, s[12:15], s25 offen
    s_mov_b32 s25, 76800
    buffer_load_dwordx4 v[88:91], v4, s[12:15], s25 offen
    s_mov_b32 s25, 84480
    buffer_load_dwordx4 v[92:95], v4, s[12:15], s25 offen
    s_mov_b32 s25, 92160
    buffer_load_dwordx4 v[96:99], v4, s[12:15], s25 offen
    s_mov_b32 s25, 99840
    buffer_load_dwordx4 v[100:103], v4, s[12:15], s25 offen
    s_mov_b32 s25, 107520
    buffer_load_dwordx4 v[104:107], v4, s[12:15], s25 offen
    s_mov_b32 s25, 115200
    buffer_load_dwordx4 v[108:111], v4, s[12:15], s25 offen
    s_mov_b32 s25, 122880
    buffer_load_dwordx4 v[112:115], v4, s[12:15], s25 offen
    s_mov_b32 s25, 130560
    buffer_load_dwordx4 v[116:119], v4, s[12:15], s25 offen
    s_mov_b32 s25, 138240
    buffer_load_dwordx4 v[120:123], v4, s[12:15], s25 offen
    s_mov_b32 s25, 145920
    buffer_load_dwordx4 v[124:127], v4, s[12:15], s25 offen
    v_mov_b32 v40, 0
    v_mov_b32 v41, 0
    v_mov_b32 v42, 0
    v_mov_b32 v43, 0
    v_mov_b32 v44, 0
    v_mov_b32 v45, 0
    v_mov_b32 v46, 0
    v_mov_b32 v47, 0
    s_waitcnt vmcnt(20)
    v_lshlrev_b32 v128, 16, v8
    v_and_b32 v129, 0xffff0000, v8
    v_lshlrev_b32 v130, 16, v9
    v_and_b32 v131, 0xffff0000, v9
    v_lshlrev_b32 v132, 16, v10
    v_and_b32 v133, 0xffff0000, v10
    v_lshlrev_b32 v134, 16, v11
    v_and_b32 v135, 0xffff0000, v11
    v_lshlrev_b32 v136, 16, v12
    v_and_b32 v137, 0xffff0000, v12
    v_lshlrev_b32 v138, 16, v13
    v_and_b32 v139, 0xffff0000, v13
    v_lshlrev_b32 v140, 16, v14
    v_and_b32 v141, 0xffff0000, v14
    v_lshlrev_b32 v142, 16, v15
    v_and_b32 v143, 0xffff0000, v15
    v_lshlrev_b32 v144, 16, v16
    v_and_b32 v145, 0xffff0000, v16
    v_lshlrev_b32 v146, 16, v17
    v_and_b32 v147, 0xffff0000, v17
    v_mul_f32 v148, -1.4426950408889634, v128
    v_mul_f32 v149, -1.4426950408889634, v129
    v_mul_f32 v150, -1.4426950408889634, v130
    v_mul_f32 v151, -1.4426950408889634, v131
    v_mul_f32 v152, -1.4426950408889634, v132
    v_mul_f32 v153, -1.4426950408889634, v133
    v_mul_f32 v154, -1.4426950408889634, v134
    v_mul_f32 v155, -1.4426950408889634, v135
    v_mul_f32 v156, -1.4426950408889634, v136
    v_mul_f32 v157, -1.4426950408889634, v137
    v_mul_f32 v158, -1.4426950408889634, v138
    v_mul_f32 v159, -1.4426950408889634, v139
    v_mul_f32 v160, -1.4426950408889634, v140
    v_mul_f32 v161, -1.4426950408889634, v141
    v_mul_f32 v162, -1.4426950408889634, v142
    v_mul_f32 v163, -1.4426950408889634, v143
    v_mul_f32 v164, -1.4426950408889634, v144
    v_mul_f32 v165, -1.4426950408889634, v145
    v_mul_f32 v166, -1.4426950408889634, v146
    v_mul_f32 v167, -1.4426950408889634, v147
    v_exp_f32 v148, v148
    v_exp_f32 v149, v149
    v_exp_f32 v150, v150
    v_exp_f32 v151, v151
    v_exp_f32 v152, v152
    v_exp_f32 v153, v153
    v_exp_f32 v154, v154
    v_exp_f32 v155, v155
    v_exp_f32 v156, v156
    v_exp_f32 v157, v157
    v_exp_f32 v158, v158
    v_exp_f32 v159, v159
    v_exp_f32 v160, v160
    v_exp_f32 v161, v161
    v_exp_f32 v162, v162
    v_exp_f32 v163, v163
    v_exp_f32 v164, v164
    v_exp_f32 v165, v165
    v_exp_f32 v166, v166
    v_exp_f32 v167, v167
    v_add_f32 v148, 1.0, v148
    v_add_f32 v149, 1.0, v149
    v_add_f32 v150, 1.0, v150
    v_add_f32 v151, 1.0, v151
    v_add_f32 v152, 1.0, v152
    v_add_f32 v153, 1.0, v153
    v_add_f32 v154, 1.0, v154
    v_add_f32 v155, 1.0, v155
    v_add_f32 v156, 1.0, v156
    v_add_f32 v157, 1.0, v157
    v_add_f32 v158, 1.0, v158
    v_add_f32 v159, 1.0, v159
    v_add_f32 v160, 1.0, v160
    v_add_f32 v161, 1.0, v161
    v_add_f32 v162, 1.0, v162
    v_add_f32 v163, 1.0, v163
    v_add_f32 v164, 1.0, v164
    v_add_f32 v165, 1.0, v165
    v_add_f32 v166, 1.0, v166
    v_add_f32 v167, 1.0, v167
    v_rcp_f32 v148, v148
    v_rcp_f32 v149, v149
    v_rcp_f32 v150, v150
    v_rcp_f32 v151, v151
    v_rcp_f32 v152, v152
    v_rcp_f32 v153, v153
    v_rcp_f32 v154, v154
    v_rcp_f32 v155, v155
    v_rcp_f32 v156, v156
    v_rcp_f32 v157, v157
    v_rcp_f32 v158, v158
    v_rcp_f32 v159, v159
    v_rcp_f32 v160, v160
    v_rcp_f32 v161, v161
    v_rcp_f32 v162, v162
    v_rcp_f32 v163, v163
    v_rcp_f32 v164, v164
    v_rcp_f32 v165, v165
    v_rcp_f32 v166, v166
    v_rcp_f32 v167, v167
    v_mul_f32 v148, v148, v128
    v_mul_f32 v149, v149, v129
    v_mul_f32 v150, v150, v130
    v_mul_f32 v151, v151, v131
    v_mul_f32 v152, v152, v132
    v_mul_f32 v153, v153, v133
    v_mul_f32 v154, v154, v134
    v_mul_f32 v155, v155, v135
    v_mul_f32 v156, v156, v136
    v_mul_f32 v157, v157, v137
    v_mul_f32 v158, v158, v138
    v_mul_f32 v159, v159, v139
    v_mul_f32 v160, v160, v140
    v_mul_f32 v161, v161, v141
    v_mul_f32 v162, v162, v142
    v_mul_f32 v163, v163, v143
    v_mul_f32 v164, v164, v144
    v_mul_f32 v165, v165, v145
    v_mul_f32 v166, v166, v146
    v_mul_f32 v167, v167, v147
    v_cvt_pk_bf16_f32 v148, v148, v148
    v_cvt_pk_bf16_f32 v149, v149, v149
    v_cvt_pk_bf16_f32 v150, v150, v150
    v_cvt_pk_bf16_f32 v151, v151, v151
    v_cvt_pk_bf16_f32 v152, v152, v152
    v_cvt_pk_bf16_f32 v153, v153, v153
    v_cvt_pk_bf16_f32 v154, v154, v154
    v_cvt_pk_bf16_f32 v155, v155, v155
    v_cvt_pk_bf16_f32 v156, v156, v156
    v_cvt_pk_bf16_f32 v157, v157, v157
    v_cvt_pk_bf16_f32 v158, v158, v158
    v_cvt_pk_bf16_f32 v159, v159, v159
    v_cvt_pk_bf16_f32 v160, v160, v160
    v_cvt_pk_bf16_f32 v161, v161, v161
    v_cvt_pk_bf16_f32 v162, v162, v162
    v_cvt_pk_bf16_f32 v163, v163, v163
    v_cvt_pk_bf16_f32 v164, v164, v164
    v_cvt_pk_bf16_f32 v165, v165, v165
    v_cvt_pk_bf16_f32 v166, v166, v166
    v_cvt_pk_bf16_f32 v167, v167, v167
    v_lshlrev_b32 v128, 16, v148
    v_lshlrev_b32 v129, 16, v149
    v_lshlrev_b32 v130, 16, v150
    v_lshlrev_b32 v131, 16, v151
    v_lshlrev_b32 v132, 16, v152
    v_lshlrev_b32 v133, 16, v153
    v_lshlrev_b32 v134, 16, v154
    v_lshlrev_b32 v135, 16, v155
    v_lshlrev_b32 v136, 16, v156
    v_lshlrev_b32 v137, 16, v157
    v_lshlrev_b32 v138, 16, v158
    v_lshlrev_b32 v139, 16, v159
    v_lshlrev_b32 v140, 16, v160
    v_lshlrev_b32 v141, 16, v161
    v_lshlrev_b32 v142, 16, v162
    v_lshlrev_b32 v143, 16, v163
    v_lshlrev_b32 v144, 16, v164
    v_lshlrev_b32 v145, 16, v165
    v_lshlrev_b32 v146, 16, v166
    v_lshlrev_b32 v147, 16, v167
    s_waitcnt vmcnt(19)
    v_lshlrev_b32 v14, 16, v48
    v_and_b32 v15, 0xffff0000, v48
    v_fmac_f32 v40, v14, v128
    v_fmac_f32 v41, v15, v128
    v_lshlrev_b32 v14, 16, v49
    v_and_b32 v15, 0xffff0000, v49
    v_fmac_f32 v42, v14, v128
    v_fmac_f32 v43, v15, v128
    v_lshlrev_b32 v14, 16, v50
    v_and_b32 v15, 0xffff0000, v50
    v_fmac_f32 v44, v14, v128
    v_fmac_f32 v45, v15, v128
    v_lshlrev_b32 v14, 16, v51
    v_and_b32 v15, 0xffff0000, v51
    v_fmac_f32 v46, v14, v128
    v_fmac_f32 v47, v15, v128
    s_waitcnt vmcnt(18)
    v_lshlrev_b32 v14, 16, v52
    v_and_b32 v15, 0xffff0000, v52
    v_fmac_f32 v40, v14, v129
    v_fmac_f32 v41, v15, v129
    v_lshlrev_b32 v14, 16, v53
    v_and_b32 v15, 0xffff0000, v53
    v_fmac_f32 v42, v14, v129
    v_fmac_f32 v43, v15, v129
    v_lshlrev_b32 v14, 16, v54
    v_and_b32 v15, 0xffff0000, v54
    v_fmac_f32 v44, v14, v129
    v_fmac_f32 v45, v15, v129
    v_lshlrev_b32 v14, 16, v55
    v_and_b32 v15, 0xffff0000, v55
    v_fmac_f32 v46, v14, v129
    v_fmac_f32 v47, v15, v129
    s_waitcnt vmcnt(17)
    v_lshlrev_b32 v14, 16, v56
    v_and_b32 v15, 0xffff0000, v56
    v_fmac_f32 v40, v14, v130
    v_fmac_f32 v41, v15, v130
    v_lshlrev_b32 v14, 16, v57
    v_and_b32 v15, 0xffff0000, v57
    v_fmac_f32 v42, v14, v130
    v_fmac_f32 v43, v15, v130
    v_lshlrev_b32 v14, 16, v58
    v_and_b32 v15, 0xffff0000, v58
    v_fmac_f32 v44, v14, v130
    v_fmac_f32 v45, v15, v130
    v_lshlrev_b32 v14, 16, v59
    v_and_b32 v15, 0xffff0000, v59
    v_fmac_f32 v46, v14, v130
    v_fmac_f32 v47, v15, v130
    s_waitcnt vmcnt(16)
    v_lshlrev_b32 v14, 16, v60
    v_and_b32 v15, 0xffff0000, v60
    v_fmac_f32 v40, v14, v131
    v_fmac_f32 v41, v15, v131
    v_lshlrev_b32 v14, 16, v61
    v_and_b32 v15, 0xffff0000, v61
    v_fmac_f32 v42, v14, v131
    v_fmac_f32 v43, v15, v131
    v_lshlrev_b32 v14, 16, v62
    v_and_b32 v15, 0xffff0000, v62
    v_fmac_f32 v44, v14, v131
    v_fmac_f32 v45, v15, v131
    v_lshlrev_b32 v14, 16, v63
    v_and_b32 v15, 0xffff0000, v63
    v_fmac_f32 v46, v14, v131
    v_fmac_f32 v47, v15, v131
    s_waitcnt vmcnt(15)
    v_lshlrev_b32 v14, 16, v64
    v_and_b32 v15, 0xffff0000, v64
    v_fmac_f32 v40, v14, v132
    v_fmac_f32 v41, v15, v132
    v_lshlrev_b32 v14, 16, v65
    v_and_b32 v15, 0xffff0000, v65
    v_fmac_f32 v42, v14, v132
    v_fmac_f32 v43, v15, v132
    v_lshlrev_b32 v14, 16, v66
    v_and_b32 v15, 0xffff0000, v66
    v_fmac_f32 v44, v14, v132
    v_fmac_f32 v45, v15, v132
    v_lshlrev_b32 v14, 16, v67
    v_and_b32 v15, 0xffff0000, v67
    v_fmac_f32 v46, v14, v132
    v_fmac_f32 v47, v15, v132
    s_waitcnt vmcnt(14)
    v_lshlrev_b32 v14, 16, v68
    v_and_b32 v15, 0xffff0000, v68
    v_fmac_f32 v40, v14, v133
    v_fmac_f32 v41, v15, v133
    v_lshlrev_b32 v14, 16, v69
    v_and_b32 v15, 0xffff0000, v69
    v_fmac_f32 v42, v14, v133
    v_fmac_f32 v43, v15, v133
    v_lshlrev_b32 v14, 16, v70
    v_and_b32 v15, 0xffff0000, v70
    v_fmac_f32 v44, v14, v133
    v_fmac_f32 v45, v15, v133
    v_lshlrev_b32 v14, 16, v71
    v_and_b32 v15, 0xffff0000, v71
    v_fmac_f32 v46, v14, v133
    v_fmac_f32 v47, v15, v133
    s_waitcnt vmcnt(13)
    v_lshlrev_b32 v14, 16, v72
    v_and_b32 v15, 0xffff0000, v72
    v_fmac_f32 v40, v14, v134
    v_fmac_f32 v41, v15, v134
    v_lshlrev_b32 v14, 16, v73
    v_and_b32 v15, 0xffff0000, v73
    v_fmac_f32 v42, v14, v134
    v_fmac_f32 v43, v15, v134
    v_lshlrev_b32 v14, 16, v74
    v_and_b32 v15, 0xffff0000, v74
    v_fmac_f32 v44, v14, v134
    v_fmac_f32 v45, v15, v134
    v_lshlrev_b32 v14, 16, v75
    v_and_b32 v15, 0xffff0000, v75
    v_fmac_f32 v46, v14, v134
    v_fmac_f32 v47, v15, v134
    s_waitcnt vmcnt(12)
    v_lshlrev_b32 v14, 16, v76
    v_and_b32 v15, 0xffff0000, v76
    v_fmac_f32 v40, v14, v135
    v_fmac_f32 v41, v15, v135
    v_lshlrev_b32 v14, 16, v77
    v_and_b32 v15, 0xffff0000, v77
    v_fmac_f32 v42, v14, v135
    v_fmac_f32 v43, v15, v135
    v_lshlrev_b32 v14, 16, v78
    v_and_b32 v15, 0xffff0000, v78
    v_fmac_f32 v44, v14, v135
    v_fmac_f32 v45, v15, v135
    v_lshlrev_b32 v14, 16, v79
    v_and_b32 v15, 0xffff0000, v79
    v_fmac_f32 v46, v14, v135
    v_fmac_f32 v47, v15, v135
    s_waitcnt vmcnt(11)
    v_lshlrev_b32 v14, 16, v80
    v_and_b32 v15, 0xffff0000, v80
    v_fmac_f32 v40, v14, v136
    v_fmac_f32 v41, v15, v136
    v_lshlrev_b32 v14, 16, v81
    v_and_b32 v15, 0xffff0000, v81
    v_fmac_f32 v42, v14, v136
    v_fmac_f32 v43, v15, v136
    v_lshlrev_b32 v14, 16, v82
    v_and_b32 v15, 0xffff0000, v82
    v_fmac_f32 v44, v14, v136
    v_fmac_f32 v45, v15, v136
    v_lshlrev_b32 v14, 16, v83
    v_and_b32 v15, 0xffff0000, v83
    v_fmac_f32 v46, v14, v136
    v_fmac_f32 v47, v15, v136
    s_waitcnt vmcnt(10)
    v_lshlrev_b32 v14, 16, v84
    v_and_b32 v15, 0xffff0000, v84
    v_fmac_f32 v40, v14, v137
    v_fmac_f32 v41, v15, v137
    v_lshlrev_b32 v14, 16, v85
    v_and_b32 v15, 0xffff0000, v85
    v_fmac_f32 v42, v14, v137
    v_fmac_f32 v43, v15, v137
    v_lshlrev_b32 v14, 16, v86
    v_and_b32 v15, 0xffff0000, v86
    v_fmac_f32 v44, v14, v137
    v_fmac_f32 v45, v15, v137
    v_lshlrev_b32 v14, 16, v87
    v_and_b32 v15, 0xffff0000, v87
    v_fmac_f32 v46, v14, v137
    v_fmac_f32 v47, v15, v137
    s_waitcnt vmcnt(9)
    v_lshlrev_b32 v14, 16, v88
    v_and_b32 v15, 0xffff0000, v88
    v_fmac_f32 v40, v14, v138
    v_fmac_f32 v41, v15, v138
    v_lshlrev_b32 v14, 16, v89
    v_and_b32 v15, 0xffff0000, v89
    v_fmac_f32 v42, v14, v138
    v_fmac_f32 v43, v15, v138
    v_lshlrev_b32 v14, 16, v90
    v_and_b32 v15, 0xffff0000, v90
    v_fmac_f32 v44, v14, v138
    v_fmac_f32 v45, v15, v138
    v_lshlrev_b32 v14, 16, v91
    v_and_b32 v15, 0xffff0000, v91
    v_fmac_f32 v46, v14, v138
    v_fmac_f32 v47, v15, v138
    s_waitcnt vmcnt(8)
    v_lshlrev_b32 v14, 16, v92
    v_and_b32 v15, 0xffff0000, v92
    v_fmac_f32 v40, v14, v139
    v_fmac_f32 v41, v15, v139
    v_lshlrev_b32 v14, 16, v93
    v_and_b32 v15, 0xffff0000, v93
    v_fmac_f32 v42, v14, v139
    v_fmac_f32 v43, v15, v139
    v_lshlrev_b32 v14, 16, v94
    v_and_b32 v15, 0xffff0000, v94
    v_fmac_f32 v44, v14, v139
    v_fmac_f32 v45, v15, v139
    v_lshlrev_b32 v14, 16, v95
    v_and_b32 v15, 0xffff0000, v95
    v_fmac_f32 v46, v14, v139
    v_fmac_f32 v47, v15, v139
    s_waitcnt vmcnt(7)
    v_lshlrev_b32 v14, 16, v96
    v_and_b32 v15, 0xffff0000, v96
    v_fmac_f32 v40, v14, v140
    v_fmac_f32 v41, v15, v140
    v_lshlrev_b32 v14, 16, v97
    v_and_b32 v15, 0xffff0000, v97
    v_fmac_f32 v42, v14, v140
    v_fmac_f32 v43, v15, v140
    v_lshlrev_b32 v14, 16, v98
    v_and_b32 v15, 0xffff0000, v98
    v_fmac_f32 v44, v14, v140
    v_fmac_f32 v45, v15, v140
    v_lshlrev_b32 v14, 16, v99
    v_and_b32 v15, 0xffff0000, v99
    v_fmac_f32 v46, v14, v140
    v_fmac_f32 v47, v15, v140
    s_waitcnt vmcnt(6)
    v_lshlrev_b32 v14, 16, v100
    v_and_b32 v15, 0xffff0000, v100
    v_fmac_f32 v40, v14, v141
    v_fmac_f32 v41, v15, v141
    v_lshlrev_b32 v14, 16, v101
    v_and_b32 v15, 0xffff0000, v101
    v_fmac_f32 v42, v14, v141
    v_fmac_f32 v43, v15, v141
    v_lshlrev_b32 v14, 16, v102
    v_and_b32 v15, 0xffff0000, v102
    v_fmac_f32 v44, v14, v141
    v_fmac_f32 v45, v15, v141
    v_lshlrev_b32 v14, 16, v103
    v_and_b32 v15, 0xffff0000, v103
    v_fmac_f32 v46, v14, v141
    v_fmac_f32 v47, v15, v141
    s_waitcnt vmcnt(5)
    v_lshlrev_b32 v14, 16, v104
    v_and_b32 v15, 0xffff0000, v104
    v_fmac_f32 v40, v14, v142
    v_fmac_f32 v41, v15, v142
    v_lshlrev_b32 v14, 16, v105
    v_and_b32 v15, 0xffff0000, v105
    v_fmac_f32 v42, v14, v142
    v_fmac_f32 v43, v15, v142
    v_lshlrev_b32 v14, 16, v106
    v_and_b32 v15, 0xffff0000, v106
    v_fmac_f32 v44, v14, v142
    v_fmac_f32 v45, v15, v142
    v_lshlrev_b32 v14, 16, v107
    v_and_b32 v15, 0xffff0000, v107
    v_fmac_f32 v46, v14, v142
    v_fmac_f32 v47, v15, v142
    s_waitcnt vmcnt(4)
    v_lshlrev_b32 v14, 16, v108
    v_and_b32 v15, 0xffff0000, v108
    v_fmac_f32 v40, v14, v143
    v_fmac_f32 v41, v15, v143
    v_lshlrev_b32 v14, 16, v109
    v_and_b32 v15, 0xffff0000, v109
    v_fmac_f32 v42, v14, v143
    v_fmac_f32 v43, v15, v143
    v_lshlrev_b32 v14, 16, v110
    v_and_b32 v15, 0xffff0000, v110
    v_fmac_f32 v44, v14, v143
    v_fmac_f32 v45, v15, v143
    v_lshlrev_b32 v14, 16, v111
    v_and_b32 v15, 0xffff0000, v111
    v_fmac_f32 v46, v14, v143
    v_fmac_f32 v47, v15, v143
    s_waitcnt vmcnt(3)
    v_lshlrev_b32 v14, 16, v112
    v_and_b32 v15, 0xffff0000, v112
    v_fmac_f32 v40, v14, v144
    v_fmac_f32 v41, v15, v144
    v_lshlrev_b32 v14, 16, v113
    v_and_b32 v15, 0xffff0000, v113
    v_fmac_f32 v42, v14, v144
    v_fmac_f32 v43, v15, v144
    v_lshlrev_b32 v14, 16, v114
    v_and_b32 v15, 0xffff0000, v114
    v_fmac_f32 v44, v14, v144
    v_fmac_f32 v45, v15, v144
    v_lshlrev_b32 v14, 16, v115
    v_and_b32 v15, 0xffff0000, v115
    v_fmac_f32 v46, v14, v144
    v_fmac_f32 v47, v15, v144
    s_waitcnt vmcnt(2)
    v_lshlrev_b32 v14, 16, v116
    v_and_b32 v15, 0xffff0000, v116
    v_fmac_f32 v40, v14, v145
    v_fmac_f32 v41, v15, v145
    v_lshlrev_b32 v14, 16, v117
    v_and_b32 v15, 0xffff0000, v117
    v_fmac_f32 v42, v14, v145
    v_fmac_f32 v43, v15, v145
    v_lshlrev_b32 v14, 16, v118
    v_and_b32 v15, 0xffff0000, v118
    v_fmac_f32 v44, v14, v145
    v_fmac_f32 v45, v15, v145
    v_lshlrev_b32 v14, 16, v119
    v_and_b32 v15, 0xffff0000, v119
    v_fmac_f32 v46, v14, v145
    v_fmac_f32 v47, v15, v145
    s_waitcnt vmcnt(1)
    v_lshlrev_b32 v14, 16, v120
    v_and_b32 v15, 0xffff0000, v120
    v_fmac_f32 v40, v14, v146
    v_fmac_f32 v41, v15, v146
    v_lshlrev_b32 v14, 16, v121
    v_and_b32 v15, 0xffff0000, v121
    v_fmac_f32 v42, v14, v146
    v_fmac_f32 v43, v15, v146
    v_lshlrev_b32 v14, 16, v122
    v_and_b32 v15, 0xffff0000, v122
    v_fmac_f32 v44, v14, v146
    v_fmac_f32 v45, v15, v146
    v_lshlrev_b32 v14, 16, v123
    v_and_b32 v15, 0xffff0000, v123
    v_fmac_f32 v46, v14, v146
    v_fmac_f32 v47, v15, v146
    s_waitcnt vmcnt(0)
    v_lshlrev_b32 v14, 16, v124
    v_and_b32 v15, 0xffff0000, v124
    v_fmac_f32 v40, v14, v147
    v_fmac_f32 v41, v15, v147
    v_lshlrev_b32 v14, 16, v125
    v_and_b32 v15, 0xffff0000, v125
    v_fmac_f32 v42, v14, v147
    v_fmac_f32 v43, v15, v147
    v_lshlrev_b32 v14, 16, v126
    v_and_b32 v15, 0xffff0000, v126
    v_fmac_f32 v44, v14, v147
    v_fmac_f32 v45, v15, v147
    v_lshlrev_b32 v14, 16, v127
    v_and_b32 v15, 0xffff0000, v127
    v_fmac_f32 v46, v14, v147
    v_fmac_f32 v47, v15, v147
    v_lshlrev_b32 v5, 8, v1
    v_lshl_add_u32 v5, v2, 5, v5
    ds_write_b128 v5, v[40:43]
    ds_write_b128 v5, v[44:47] offset:16
    s_waitcnt lgkmcnt(0)
    s_barrier
    v_and_b32 v6, 63, v0
    v_lshlrev_b32 v6, 2, v6
    s_lshl_b32 s25, s3, 11
    v_add_u32 v7, s25, v6
    ds_read_b32 v16, v7 offset:0
    ds_read_b32 v17, v7 offset:256
    ds_read_b32 v18, v7 offset:512
    ds_read_b32 v19, v7 offset:768
    ds_read_b32 v20, v7 offset:1024
    ds_read_b32 v21, v7 offset:1280
    ds_read_b32 v22, v7 offset:1536
    ds_read_b32 v23, v7 offset:1792
    s_waitcnt lgkmcnt(0)
    v_add_f32 v16, v16, v17
    v_add_f32 v16, v16, v18
    v_add_f32 v16, v16, v19
    v_add_f32 v16, v16, v20
    v_add_f32 v16, v16, v21
    v_add_f32 v16, v16, v22
    v_add_f32 v16, v16, v23
    s_lshl_b32 s25, s3, 8
    v_add_u32 v7, s25, v6
    ds_write_b32 v7, v16 offset:8192
    s_waitcnt lgkmcnt(0)
    s_barrier
    s_mov_b32 s28, s4
    s_mov_b32 s29, s5
    s_mov_b32 s30, 1048576
    s_mov_b32 s31, 0x00020000
    s_cmp_ge_u32 s22, 24
    s_cbranch_scc1 K1_nz
    s_lshl_b32 s27, s22, 12
    s_add_u32 s27, s27, 524288
    v_lshlrev_b32 v12, 4, v0
    v_mov_b32 v8, 0
    v_mov_b32 v9, 0
    v_mov_b32 v10, 0
    v_mov_b32 v11, 0
    buffer_store_dwordx4 v[8:11], v12, s[28:31], s27 offen
K1_nz:
    s_cmp_lg_u32 s3, 0
    s_cbranch_scc1 K1_end
    ds_read_b32 v16, v6 offset:8192
    ds_read_b32 v17, v6 offset:8448
    ds_read_b32 v18, v6 offset:8704
    ds_read_b32 v19, v6 offset:8960
    s_add_u32 s12, s4, 90112
    s_addc_u32 s13, s5, 0
    s_mov_b32 s14, 15360
    s_mov_b32 s15, 0x00020000
    s_lshl_b32 s25, s22, 8
    s_mul_i32 s21, s22, 6554
    s_lshr_b32 s21, s21, 16
    s_waitcnt lgkmcnt(0)
    v_add_f32 v16, v16, v17
    v_add_f32 v18, v18, v19
    v_add_f32 v16, v16, v18
    v_cvt_pk_bf16_f32 v16, v16, v16
    v_lshlrev_b32 v16, 16, v16
    s_cmp_eq_u32 s21, 1
    s_cselect_b32 s26, 1.0, 0
    s_cmp_eq_u32 s21, 4
    s_cselect_b32 s26, 1.0, s26
    v_add_f32 v16, s26, v16
    v_cvt_pk_bf16_f32 v16, v16, v16
    v_lshlrev_b32 v16, 16, v16
    buffer_store_dword v16, v6, s[12:15], s25 offen
    s_endpgm
K1_kgen:
    s_load_dwordx2 s[40:41], s[0:1], 8
    s_load_dwordx2 s[42:43], s[0:1], 16
    s_load_dwordx2 s[44:45], s[0:1], 24
    s_load_dwordx2 s[46:47], s[0:1], 32
    s_load_dwordx2 s[48:49], s[0:1], 40
    s_load_dwordx2 s[50:51], s[0:1], 48
    s_load_dwordx2 s[52:53], s[0:1], 56
    s_sub_u32 s20, s2, 158
    s_lshl_b32 s20, s20, 1
    s_lshr_b32 s21, s3, 1
    s_add_u32 s20, s20, s21
    s_and_b32 s22, s3, 1
    v_and_b32 v1, 63, v0
    s_lshl_b32 s23, s20, 7
    s_lshl_b32 s24, s22, 6
    s_add_u32 s23, s23, s24
    v_add_u32 v2, s23, v1
    v_lshlrev_b32 v2, 1, v2
    s_lshl_b32 s24, s20, 1
    v_mov_b32 v3, s24
    s_waitcnt lgkmcnt(0)
    s_mov_b32 s8, s40
    s_mov_b32 s9, s41
    s_mov_b32 s10, 163840
    s_mov_b32 s11, 0x00020000
    buffer_load_ushort v8, v2, s[8:11], 0 offen
    s_mov_b32 s8, s42
    s_mov_b32 s9, s43
    s_mov_b32 s10, 163840
    s_mov_b32 s11, 0x00020000
    buffer_load_ushort v9, v2, s[8:11], 0 offen
    s_mov_b32 s8, s44
    s_mov_b32 s9, s45
    s_mov_b32 s10, 163840
    s_mov_b32 s11, 0x00020000
    buffer_load_ushort v10, v2, s[8:11], 0 offen
    s_mov_b32 s8, s46
    s_mov_b32 s9, s47
    s_mov_b32 s10, 163840
    s_mov_b32 s11, 0x00020000
    buffer_load_ushort v11, v2, s[8:11], 0 offen
    s_mov_b32 s8, s48
    s_mov_b32 s9, s49
    s_mov_b32 s10, 163840
    s_mov_b32 s11, 0x00020000
    buffer_load_ushort v12, v2, s[8:11], 0 offen
    s_mov_b32 s8, s50
    s_mov_b32 s9, s51
    s_mov_b32 s10, 163840
    s_mov_b32 s11, 0x00020000
    buffer_load_ushort v13, v2, s[8:11], 0 offen
    s_mov_b32 s8, s52
    s_mov_b32 s9, s53
    s_mov_b32 s10, 1280
    s_mov_b32 s11, 0x00020000
    buffer_load_ushort v14, v3, s[8:11], 0 offen
    s_add_u32 s12, s4, 7340032
    s_addc_u32 s13, s5, 0
    s_mov_b32 s14, 2704384
    s_mov_b32 s15, 0x00020000
    s_mul_i32 s25, s3, 8704
    v_lshlrev_b32 v4, 2, v1
    v_add_u32 v4, s25, v4
    v_and_b32 v5, 15, v1
    v_lshrrev_b32 v6, 4, v1
    v_mul_u32_u24 v7, 272, v5
    v_lshl_add_u32 v7, v6, 4, v7
    v_add_u32 v7, s25, v7
    s_waitcnt vmcnt(0)
    v_lshlrev_b32 v8, 16, v8
    v_lshlrev_b32 v9, 16, v9
    v_lshlrev_b32 v10, 16, v10
    v_lshlrev_b32 v11, 16, v11
    v_lshlrev_b32 v12, 16, v12
    v_lshlrev_b32 v13, 16, v13
    v_lshlrev_b32 v14, 16, v14
    v_mul_f32 v14, 1.4426950408889634, v14
    v_exp_f32 v14, v14
    s_nop 0
    v_cvt_pk_bf16_f32 v14, v14, v14
    v_lshlrev_b32 v14, 16, v14
    v_mul_f32 v16, v14, v8
    v_mul_f32 v17, v14, v9
    v_mul_f32 v16, 1.4426950408889634, v16
    v_mul_f32 v17, 0.15915494309189535, v17
    v_mul_f32 v10, v14, v10
    v_mul_f32 v11, v14, v11
    v_pk_mul_f32 v[18:19], v[12:13], v[10:11] op_sel:[0,0] op_sel_hi:[0,1]
    v_pk_fma_f32 v[18:19], v[12:13], v[10:11], v[18:19] op_sel:[1,1,0] op_sel_hi:[1,0,1] neg_lo:[0,1,0]
    v_mul_f32 v20, 1.0, v16
    v_mul_f32 v15, 1.0, v17
    v_exp_f32 v20, v20
    v_fract_f32 v15, v15
    s_nop 0
    v_sin_f32 v21, v15
    v_cos_f32 v15, v15
    s_nop 0
    v_mul_f32 v21, v21, v20
    v_mul_f32 v20, v15, v20
    v_mul_f32 v22, 2.0, v16
    v_mul_f32 v15, 2.0, v17
    v_exp_f32 v22, v22
    v_fract_f32 v15, v15
    s_nop 0
    v_sin_f32 v23, v15
    v_cos_f32 v15, v15
    s_nop 0
    v_mul_f32 v23, v23, v22
    v_mul_f32 v22, v15, v22
    v_mul_f32 v26, 4.0, v16
    v_mul_f32 v15, 4.0, v17
    v_exp_f32 v26, v26
    v_fract_f32 v15, v15
    s_nop 0
    v_sin_f32 v27, v15
    v_cos_f32 v15, v15
    s_nop 0
    v_mul_f32 v27, v27, v26
    v_mul_f32 v26, v15, v26
    v_mul_f32 v34, 8.0, v16
    v_mul_f32 v15, 8.0, v17
    v_exp_f32 v34, v34
    v_fract_f32 v15, v15
    s_nop 0
    v_sin_f32 v35, v15
    v_cos_f32 v15, v15
    s_nop 0
    v_mul_f32 v35, v35, v34
    v_mul_f32 v34, v15, v34
    v_mul_f32 v36, 128.0, v16
    v_mul_f32 v15, 128.0, v17
    v_exp_f32 v36, v36
    v_fract_f32 v15, v15
    s_nop 0
    v_sin_f32 v37, v15
    v_cos_f32 v15, v15
    s_nop 0
    v_mul_f32 v37, v37, v36
    v_mul_f32 v36, v15, v36
    v_pk_mul_f32 v[24:25], v[20:21], v[22:23] op_sel:[0,0] op_sel_hi:[0,1]
    v_pk_fma_f32 v[24:25], v[20:21], v[22:23], v[24:25] op_sel:[1,1,0] op_sel_hi:[1,0,1] neg_lo:[0,1,0]
    v_pk_mul_f32 v[28:29], v[20:21], v[26:27] op_sel:[0,0] op_sel_hi:[0,1]
    v_pk_fma_f32 v[28:29], v[20:21], v[26:27], v[28:29] op_sel:[1,1,0] op_sel_hi:[1,0,1] neg_lo:[0,1,0]
    v_pk_mul_f32 v[30:31], v[22:23], v[26:27] op_sel:[0,0] op_sel_hi:[0,1]
    v_pk_fma_f32 v[30:31], v[22:23], v[26:27], v[30:31] op_sel:[1,1,0] op_sel_hi:[1,0,1] neg_lo:[0,1,0]
    v_pk_mul_f32 v[32:33], v[24:25], v[26:27] op_sel:[0,0] op_sel_hi:[0,1]
    v_pk_fma_f32 v[32:33], v[24:25], v[26:27], v[32:33] op_sel:[1,1,0] op_sel_hi:[1,0,1] neg_lo:[0,1,0]
    v_mov_b32 v38, 1.0
    v_mov_b32 v39, 0
    v_xor_b32 v15, 0x80000000, v39
    v_cvt_pk_bf16_f32 v15, v38, v15
    ds_write_b32 v4, v15 offset:0
    v_xor_b32 v15, 0x80000000, v35
    v_cvt_pk_bf16_f32 v15, v34, v15
    ds_write_b32 v4, v15 offset:272
    v_pk_mul_f32 v[38:39], v[34:35], v[34:35] op_sel:[0,0] op_sel_hi:[0,1]
    v_pk_fma_f32 v[38:39], v[34:35], v[34:35], v[38:39] op_sel:[1,1,0] op_sel_hi:[1,0,1] neg_lo:[0,1,0]
    v_xor_b32 v15, 0x80000000, v39
    v_cvt_pk_bf16_f32 v15, v38, v15
    ds_write_b32 v4, v15 offset:544
    v_pk_mul_f32 v[40:41], v[38:39], v[34:35] op_sel:[0,0] op_sel_hi:[0,1]
    v_pk_fma_f32 v[40:41], v[38:39], v[34:35], v[40:41] op_sel:[1,1,0] op_sel_hi:[1,0,1] neg_lo:[0,1,0]
    v_xor_b32 v15, 0x80000000, v41
    v_cvt_pk_bf16_f32 v15, v40, v15
    ds_write_b32 v4, v15 offset:816
    v_pk_mul_f32 v[38:39], v[40:41], v[34:35] op_sel:[0,0] op_sel_hi:[0,1]
    v_pk_fma_f32 v[38:39], v[40:41], v[34:35], v[38:39] op_sel:[1,1,0] op_sel_hi:[1,0,1] neg_lo:[0,1,0]
    v_xor_b32 v15, 0x80000000, v39
    v_cvt_pk_bf16_f32 v15, v38, v15
    ds_write_b32 v4, v15 offset:1088
    v_pk_mul_f32 v[40:41], v[38:39], v[34:35] op_sel:[0,0] op_sel_hi:[0,1]
    v_pk_fma_f32 v[40:41], v[38:39], v[34:35], v[40:41] op_sel:[1,1,0] op_sel_hi:[1,0,1] neg_lo:[0,1,0]
    v_xor_b32 v15, 0x80000000, v41
    v_cvt_pk_bf16_f32 v15, v40, v15
    ds_write_b32 v4, v15 offset:1360
    v_pk_mul_f32 v[38:39], v[40:41], v[34:35] op_sel:[0,0] op_sel_hi:[0,1]
    v_pk_fma_f32 v[38:39], v[40:41], v[34:35], v[38:39] op_sel:[1,1,0] op_sel_hi:[1,0,1] neg_lo:[0,1,0]
    v_xor_b32 v15, 0x80000000, v39
    v_cvt_pk_bf16_f32 v15, v38, v15
    ds_write_b32 v4, v15 offset:1632
    v_pk_mul_f32 v[40:41], v[38:39], v[34:35] op_sel:[0,0] op_sel_hi:[0,1]
    v_pk_fma_f32 v[40:41], v[38:39], v[34:35], v[40:41] op_sel:[1,1,0] op_sel_hi:[1,0,1] neg_lo:[0,1,0]
    v_xor_b32 v15, 0x80000000, v41
    v_cvt_pk_bf16_f32 v15, v40, v15
    ds_write_b32 v4, v15 offset:1904
    v_pk_mul_f32 v[38:39], v[40:41], v[34:35] op_sel:[0,0] op_sel_hi:[0,1]
    v_pk_fma_f32 v[38:39], v[40:41], v[34:35], v[38:39] op_sel:[1,1,0] op_sel_hi:[1,0,1] neg_lo:[0,1,0]
    v_xor_b32 v15, 0x80000000, v39
    v_cvt_pk_bf16_f32 v15, v38, v15
    ds_write_b32 v4, v15 offset:2176
    v_pk_mul_f32 v[40:41], v[38:39], v[34:35] op_sel:[0,0] op_sel_hi:[0,1]
    v_pk_fma_f32 v[40:41], v[38:39], v[34:35], v[40:41] op_sel:[1,1,0] op_sel_hi:[1,0,1] neg_lo:[0,1,0]
    v_xor_b32 v15, 0x80000000, v41
    v_cvt_pk_bf16_f32 v15, v40, v15
    ds_write_b32 v4, v15 offset:2448
    v_pk_mul_f32 v[38:39], v[40:41], v[34:35] op_sel:[0,0] op_sel_hi:[0,1]
    v_pk_fma_f32 v[38:39], v[40:41], v[34:35], v[38:39] op_sel:[1,1,0] op_sel_hi:[1,0,1] neg_lo:[0,1,0]
    v_xor_b32 v15, 0x80000000, v39
    v_cvt_pk_bf16_f32 v15, v38, v15
    ds_write_b32 v4, v15 offset:2720
    v_pk_mul_f32 v[40:41], v[38:39], v[34:35] op_sel:[0,0] op_sel_hi:[0,1]
    v_pk_fma_f32 v[40:41], v[38:39], v[34:35], v[40:41] op_sel:[1,1,0] op_sel_hi:[1,0,1] neg_lo:[0,1,0]
    v_xor_b32 v15, 0x80000000, v41
    v_cvt_pk_bf16_f32 v15, v40, v15
    ds_write_b32 v4, v15 offset:2992
    v_pk_mul_f32 v[38:39], v[40:41], v[34:35] op_sel:[0,0] op_sel_hi:[0,1]
    v_pk_fma_f32 v[38:39], v[40:41], v[34:35], v[38:39] op_sel:[1,1,0] op_sel_hi:[1,0,1] neg_lo:[0,1,0]
    v_xor_b32 v15, 0x80000000, v39
    v_cvt_pk_bf16_f32 v15, v38, v15
    ds_write_b32 v4, v15 offset:3264
    v_pk_mul_f32 v[40:41], v[38:39], v[34:35] op_sel:[0,0] op_sel_hi:[0,1]
    v_pk_fma_f32 v[40:41], v[38:39], v[34:35], v[40:41] op_sel:[1,1,0] op_sel_hi:[1,0,1] neg_lo:[0,1,0]
    v_xor_b32 v15, 0x80000000, v41
    v_cvt_pk_bf16_f32 v15, v40, v15
    ds_write_b32 v4, v15 offset:3536
    v_pk_mul_f32 v[38:39], v[40:41], v[34:35] op_sel:[0,0] op_sel_hi:[0,1]
    v_pk_fma_f32 v[38:39], v[40:41], v[34:35], v[38:39] op_sel:[1,1,0] op_sel_hi:[1,0,1] neg_lo:[0,1,0]
    v_xor_b32 v15, 0x80000000, v39
    v_cvt_pk_bf16_f32 v15, v38, v15
    ds_write_b32 v4, v15 offset:3808
    v_pk_mul_f32 v[40:41], v[38:39], v[34:35] op_sel:[0,0] op_sel_hi:[0,1]
    v_pk_fma_f32 v[40:41], v[38:39], v[34:35], v[40:41] op_sel:[1,1,0] op_sel_hi:[1,0,1] neg_lo:[0,1,0]
    v_xor_b32 v15, 0x80000000, v41
    v_cvt_pk_bf16_f32 v15, v40, v15
    ds_write_b32 v4, v15 offset:4080
    s_waitcnt lgkmcnt(0)
    ds_read_b128 v[48:51], v7 offset:0
    ds_read_b128 v[52:55], v7 offset:64
    ds_read_b128 v[56:59], v7 offset:128
    ds_read_b128 v[60:63], v7 offset:192
    v_cvt_pk_bf16_f32 v15, v18, v19
    ds_write_b32 v4, v15 offset:4352
    v_pk_mul_f32 v[44:45], v[18:19], v[20:21] op_sel:[0,0] op_sel_hi:[0,1]
    v_pk_fma_f32 v[44:45], v[18:19], v[20:21], v[44:45] op_sel:[1,1,0] op_sel_hi:[1,0,1] neg_lo:[0,1,0]
    v_cvt_pk_bf16_f32 v15, v44, v45
    ds_write_b32 v4, v15 offset:4624
    v_pk_mul_f32 v[44:45], v[18:19], v[22:23] op_sel:[0,0] op_sel_hi:[0,1]
    v_pk_fma_f32 v[44:45], v[18:19], v[22:23], v[44:45] op_sel:[1,1,0] op_sel_hi:[1,0,1] neg_lo:[0,1,0]
    v_cvt_pk_bf16_f32 v15, v44, v45
    ds_write_b32 v4, v15 offset:4896
    v_pk_mul_f32 v[44:45], v[18:19], v[24:25] op_sel:[0,0] op_sel_hi:[0,1]
    v_pk_fma_f32 v[44:45], v[18:19], v[24:25], v[44:45] op_sel:[1,1,0] op_sel_hi:[1,0,1] neg_lo:[0,1,0]
    v_cvt_pk_bf16_f32 v15, v44, v45
    ds_write_b32 v4, v15 offset:5168
    v_pk_mul_f32 v[44:45], v[18:19], v[26:27] op_sel:[0,0] op_sel_hi:[0,1]
    v_pk_fma_f32 v[44:45], v[18:19], v[26:27], v[44:45] op_sel:[1,1,0] op_sel_hi:[1,0,1] neg_lo:[0,1,0]
    v_cvt_pk_bf16_f32 v15, v44, v45
    ds_write_b32 v4, v15 offset:5440
    v_pk_mul_f32 v[44:45], v[18:19], v[28:29] op_sel:[0,0] op_sel_hi:[0,1]
    v_pk_fma_f32 v[44:45], v[18:19], v[28:29], v[44:45] op_sel:[1,1,0] op_sel_hi:[1,0,1] neg_lo:[0,1,0]
    v_cvt_pk_bf16_f32 v15, v44, v45
    ds_write_b32 v4, v15 offset:5712
    v_pk_mul_f32 v[44:45], v[18:19], v[30:31] op_sel:[0,0] op_sel_hi:[0,1]
    v_pk_fma_f32 v[44:45], v[18:19], v[30:31], v[44:45] op_sel:[1,1,0] op_sel_hi:[1,0,1] neg_lo:[0,1,0]
    v_cvt_pk_bf16_f32 v15, v44, v45
    ds_write_b32 v4, v15 offset:5984
    v_pk_mul_f32 v[44:45], v[18:19], v[32:33] op_sel:[0,0] op_sel_hi:[0,1]
    v_pk_fma_f32 v[44:45], v[18:19], v[32:33], v[44:45] op_sel:[1,1,0] op_sel_hi:[1,0,1] neg_lo:[0,1,0]
    v_cvt_pk_bf16_f32 v15, v44, v45
    ds_write_b32 v4, v15 offset:6256
    v_pk_mul_f32 v[42:43], v[18:19], v[36:37] op_sel:[0,0] op_sel_hi:[0,1]
    v_pk_fma_f32 v[42:43], v[18:19], v[36:37], v[42:43] op_sel:[1,1,0] op_sel_hi:[1,0,1] neg_lo:[0,1,0]
    v_cvt_pk_bf16_f32 v15, v42, v43
    ds_write_b32 v4, v15 offset:6528
    v_pk_mul_f32 v[44:45], v[42:43], v[20:21] op_sel:[0,0] op_sel_hi:[0,1]
    v_pk_fma_f32 v[44:45], v[42:43], v[20:21], v[44:45] op_sel:[1,1,0] op_sel_hi:[1,0,1] neg_lo:[0,1,0]
    v_cvt_pk_bf16_f32 v15, v44, v45
    ds_write_b32 v4, v15 offset:6800
    v_pk_mul_f32 v[44:45], v[42:43], v[22:23] op_sel:[0,0] op_sel_hi:[0,1]
    v_pk_fma_f32 v[44:45], v[42:43], v[22:23], v[44:45] op_sel:[1,1,0] op_sel_hi:[1,0,1] neg_lo:[0,1,0]
    v_cvt_pk_bf16_f32 v15, v44, v45
    ds_write_b32 v4, v15 offset:7072
    v_pk_mul_f32 v[44:45], v[42:43], v[24:25] op_sel:[0,0] op_sel_hi:[0,1]
    v_pk_fma_f32 v[44:45], v[42:43], v[24:25], v[44:45] op_sel:[1,1,0] op_sel_hi:[1,0,1] neg_lo:[0,1,0]
    v_cvt_pk_bf16_f32 v15, v44, v45
    ds_write_b32 v4, v15 offset:7344
    v_pk_mul_f32 v[44:45], v[42:43], v[26:27] op_sel:[0,0] op_sel_hi:[0,1]
    v_pk_fma_f32 v[44:45], v[42:43], v[26:27], v[44:45] op_sel:[1,1,0] op_sel_hi:[1,0,1] neg_lo:[0,1,0]
    v_cvt_pk_bf16_f32 v15, v44, v45
    ds_write_b32 v4, v15 offset:7616
    v_pk_mul_f32 v[44:45], v[42:43], v[28:29] op_sel:[0,0] op_sel_hi:[0,1]
    v_pk_fma_f32 v[44:45], v[42:43], v[28:29], v[44:45] op_sel:[1,1,0] op_sel_hi:[1,0,1] neg_lo:[0,1,0]
    v_cvt_pk_bf16_f32 v15, v44, v45
    ds_write_b32 v4, v15 offset:7888
    v_pk_mul_f32 v[44:45], v[42:43], v[30:31] op_sel:[0,0] op_sel_hi:[0,1]
    v_pk_fma_f32 v[44:45], v[42:43], v[30:31], v[44:45] op_sel:[1,1,0] op_sel_hi:[1,0,1] neg_lo:[0,1,0]
    v_cvt_pk_bf16_f32 v15, v44, v45
    ds_write_b32 v4, v15 offset:8160
    v_pk_mul_f32 v[44:45], v[42:43], v[32:33] op_sel:[0,0] op_sel_hi:[0,1]
    v_pk_fma_f32 v[44:45], v[42:43], v[32:33], v[44:45] op_sel:[1,1,0] op_sel_hi:[1,0,1] neg_lo:[0,1,0]
    v_cvt_pk_bf16_f32 v15, v44, v45
    ds_write_b32 v4, v15 offset:8432
    s_waitcnt lgkmcnt(0)
    ds_read_b128 v[64:67], v7 offset:4352
    ds_read_b128 v[68:71], v7 offset:4416
    ds_read_b128 v[72:75], v7 offset:4480
    ds_read_b128 v[76:79], v7 offset:4544
    v_mov_b32 v80, 0
    v_mov_b32 v81, 0
    v_mov_b32 v82, 0
    v_mov_b32 v83, 0
    s_waitcnt lgkmcnt(3)
    v_mfma_f32_16x16x32_bf16 v[80:83], v[64:67], v[48:51], v[80:83]
    s_waitcnt lgkmcnt(2)
    v_mfma_f32_16x16x32_bf16 v[80:83], v[68:71], v[52:55], v[80:83]
    s_waitcnt lgkmcnt(1)
    v_mfma_f32_16x16x32_bf16 v[80:83], v[72:75], v[56:59], v[80:83]
    s_waitcnt lgkmcnt(0)
    v_mfma_f32_16x16x32_bf16 v[80:83], v[76:79], v[60:63], v[80:83]
    v_pk_mul_f32 v[18:19], v[42:43], v[36:37] op_sel:[0,0] op_sel_hi:[0,1]
    v_pk_fma_f32 v[18:19], v[42:43], v[36:37], v[18:19] op_sel:[1,1,0] op_sel_hi:[1,0,1] neg_lo:[0,1,0]
    v_cvt_pk_bf16_f32 v15, v18, v19
    ds_write_b32 v4, v15 offset:4352
    v_pk_mul_f32 v[44:45], v[18:19], v[22:23] op_sel:[0,0] op_sel_hi:[0,1]
    v_pk_fma_f32 v[44:45], v[18:19], v[22:23], v[44:45] op_sel:[1,1,0] op_sel_hi:[1,0,1] neg_lo:[0,1,0]
    v_cvt_pk_bf16_f32 v15, v44, v45
    ds_write_b32 v4, v15 offset:4624
    v_pk_mul_f32 v[44:45], v[18:19], v[26:27] op_sel:[0,0] op_sel_hi:[0,1]
    v_pk_fma_f32 v[44:45], v[18:19], v[26:27], v[44:45] op_sel:[1,1,0] op_sel_hi:[1,0,1] neg_lo:[0,1,0]
    v_cvt_pk_bf16_f32 v15, v44, v45
    ds_write_b32 v4, v15 offset:4896
    v_pk_mul_f32 v[44:45], v[18:19], v[30:31] op_sel:[0,0] op_sel_hi:[0,1]
    v_pk_fma_f32 v[44:45], v[18:19], v[30:31], v[44:45] op_sel:[1,1,0] op_sel_hi:[1,0,1] neg_lo:[0,1,0]
    v_cvt_pk_bf16_f32 v15, v44, v45
    ds_write_b32 v4, v15 offset:5168
    v_pk_mul_f32 v[42:43], v[18:19], v[36:37] op_sel:[0,0] op_sel_hi:[0,1]
    v_pk_fma_f32 v[42:43], v[18:19], v[36:37], v[42:43] op_sel:[1,1,0] op_sel_hi:[1,0,1] neg_lo:[0,1,0]
    v_cvt_pk_bf16_f32 v15, v42, v43
    ds_write_b32 v4, v15 offset:5440
    v_pk_mul_f32 v[44:45], v[42:43], v[22:23] op_sel:[0,0] op_sel_hi:[0,1]
    v_pk_fma_f32 v[44:45], v[42:43], v[22:23], v[44:45] op_sel:[1,1,0] op_sel_hi:[1,0,1] neg_lo:[0,1,0]
    v_cvt_pk_bf16_f32 v15, v44, v45
    ds_write_b32 v4, v15 offset:5712
    v_pk_mul_f32 v[44:45], v[42:43], v[26:27] op_sel:[0,0] op_sel_hi:[0,1]
    v_pk_fma_f32 v[44:45], v[42:43], v[26:27], v[44:45] op_sel:[1,1,0] op_sel_hi:[1,0,1] neg_lo:[0,1,0]
    v_cvt_pk_bf16_f32 v15, v44, v45
    ds_write_b32 v4, v15 offset:5984
    v_pk_mul_f32 v[44:45], v[42:43], v[30:31] op_sel:[0,0] op_sel_hi:[0,1]
    v_pk_fma_f32 v[44:45], v[42:43], v[30:31], v[44:45] op_sel:[1,1,0] op_sel_hi:[1,0,1] neg_lo:[0,1,0]
    v_cvt_pk_bf16_f32 v15, v44, v45
    ds_write_b32 v4, v15 offset:6256
    v_pk_mul_f32 v[18:19], v[42:43], v[36:37] op_sel:[0,0] op_sel_hi:[0,1]
    v_pk_fma_f32 v[18:19], v[42:43], v[36:37], v[18:19] op_sel:[1,1,0] op_sel_hi:[1,0,1] neg_lo:[0,1,0]
    v_cvt_pk_bf16_f32 v15, v18, v19
    ds_write_b32 v4, v15 offset:6528
    v_pk_mul_f32 v[44:45], v[18:19], v[26:27] op_sel:[0,0] op_sel_hi:[0,1]
    v_pk_fma_f32 v[44:45], v[18:19], v[26:27], v[44:45] op_sel:[1,1,0] op_sel_hi:[1,0,1] neg_lo:[0,1,0]
    v_cvt_pk_bf16_f32 v15, v44, v45
    ds_write_b32 v4, v15 offset:6800
    v_pk_mul_f32 v[42:43], v[18:19], v[36:37] op_sel:[0,0] op_sel_hi:[0,1]
    v_pk_fma_f32 v[42:43], v[18:19], v[36:37], v[42:43] op_sel:[1,1,0] op_sel_hi:[1,0,1] neg_lo:[0,1,0]
    v_cvt_pk_bf16_f32 v15, v42, v43
    ds_write_b32 v4, v15 offset:7072
    v_pk_mul_f32 v[44:45], v[42:43], v[26:27] op_sel:[0,0] op_sel_hi:[0,1]
    v_pk_fma_f32 v[44:45], v[42:43], v[26:27], v[44:45] op_sel:[1,1,0] op_sel_hi:[1,0,1] neg_lo:[0,1,0]
    v_cvt_pk_bf16_f32 v15, v44, v45
    ds_write_b32 v4, v15 offset:7344
    v_pk_mul_f32 v[18:19], v[42:43], v[36:37] op_sel:[0,0] op_sel_hi:[0,1]
    v_pk_fma_f32 v[18:19], v[42:43], v[36:37], v[18:19] op_sel:[1,1,0] op_sel_hi:[1,0,1] neg_lo:[0,1,0]
    v_cvt_pk_bf16_f32 v15, v18, v19
    ds_write_b32 v4, v15 offset:7616
    v_pk_mul_f32 v[44:45], v[18:19], v[26:27] op_sel:[0,0] op_sel_hi:[0,1]
    v_pk_fma_f32 v[44:45], v[18:19], v[26:27], v[44:45] op_sel:[1,1,0] op_sel_hi:[1,0,1] neg_lo:[0,1,0]
    v_cvt_pk_bf16_f32 v15, v44, v45
    ds_write_b32 v4, v15 offset:7888
    v_pk_mul_f32 v[42:43], v[18:19], v[36:37] op_sel:[0,0] op_sel_hi:[0,1]
    v_pk_fma_f32 v[42:43], v[18:19], v[36:37], v[42:43] op_sel:[1,1,0] op_sel_hi:[1,0,1] neg_lo:[0,1,0]
    v_cvt_pk_bf16_f32 v15, v42, v43
    ds_write_b32 v4, v15 offset:8160
    v_pk_mul_f32 v[44:45], v[42:43], v[26:27] op_sel:[0,0] op_sel_hi:[0,1]
    v_pk_fma_f32 v[44:45], v[42:43], v[26:27], v[44:45] op_sel:[1,1,0] op_sel_hi:[1,0,1] neg_lo:[0,1,0]
    v_cvt_pk_bf16_f32 v15, v44, v45
    ds_write_b32 v4, v15 offset:8432
    s_waitcnt lgkmcnt(0)
    ds_read_b128 v[64:67], v7 offset:4352
    ds_read_b128 v[68:71], v7 offset:4416
    ds_read_b128 v[72:75], v7 offset:4480
    ds_read_b128 v[76:79], v7 offset:4544
    v_mov_b32 v84, 0
    v_mov_b32 v85, 0
    v_mov_b32 v86, 0
    v_mov_b32 v87, 0
    s_waitcnt lgkmcnt(3)
    v_mfma_f32_16x16x32_bf16 v[84:87], v[64:67], v[48:51], v[84:87]
    s_waitcnt lgkmcnt(2)
    v_mfma_f32_16x16x32_bf16 v[84:87], v[68:71], v[52:55], v[84:87]
    s_waitcnt lgkmcnt(1)
    v_mfma_f32_16x16x32_bf16 v[84:87], v[72:75], v[56:59], v[84:87]
    s_waitcnt lgkmcnt(0)
    v_mfma_f32_16x16x32_bf16 v[84:87], v[76:79], v[60:63], v[84:87]
    v_pk_mul_f32 v[18:19], v[42:43], v[36:37] op_sel:[0,0] op_sel_hi:[0,1]
    v_pk_fma_f32 v[18:19], v[42:43], v[36:37], v[18:19] op_sel:[1,1,0] op_sel_hi:[1,0,1] neg_lo:[0,1,0]
    v_cvt_pk_bf16_f32 v15, v18, v19
    ds_write_b32 v4, v15 offset:4352
    v_pk_mul_f32 v[42:43], v[18:19], v[36:37] op_sel:[0,0] op_sel_hi:[0,1]
    v_pk_fma_f32 v[42:43], v[18:19], v[36:37], v[42:43] op_sel:[1,1,0] op_sel_hi:[1,0,1] neg_lo:[0,1,0]
    v_cvt_pk_bf16_f32 v15, v42, v43
    ds_write_b32 v4, v15 offset:4624
    v_pk_mul_f32 v[18:19], v[42:43], v[36:37] op_sel:[0,0] op_sel_hi:[0,1]
    v_pk_fma_f32 v[18:19], v[42:43], v[36:37], v[18:19] op_sel:[1,1,0] op_sel_hi:[1,0,1] neg_lo:[0,1,0]
    v_cvt_pk_bf16_f32 v15, v18, v19
    ds_write_b32 v4, v15 offset:4896
    v_pk_mul_f32 v[42:43], v[18:19], v[36:37] op_sel:[0,0] op_sel_hi:[0,1]
    v_pk_fma_f32 v[42:43], v[18:19], v[36:37], v[42:43] op_sel:[1,1,0] op_sel_hi:[1,0,1] neg_lo:[0,1,0]
    v_cvt_pk_bf16_f32 v15, v42, v43
    ds_write_b32 v4, v15 offset:5168
    v_pk_mul_f32 v[18:19], v[42:43], v[36:37] op_sel:[0,0] op_sel_hi:[0,1]
    v_pk_fma_f32 v[18:19], v[42:43], v[36:37], v[18:19] op_sel:[1,1,0] op_sel_hi:[1,0,1] neg_lo:[0,1,0]
    v_cvt_pk_bf16_f32 v15, v18, v19
    ds_write_b32 v4, v15 offset:5440
    v_pk_mul_f32 v[42:43], v[18:19], v[36:37] op_sel:[0,0] op_sel_hi:[0,1]
    v_pk_fma_f32 v[42:43], v[18:19], v[36:37], v[42:43] op_sel:[1,1,0] op_sel_hi:[1,0,1] neg_lo:[0,1,0]
    v_cvt_pk_bf16_f32 v15, v42, v43
    ds_write_b32 v4, v15 offset:5712
    v_pk_mul_f32 v[18:19], v[42:43], v[36:37] op_sel:[0,0] op_sel_hi:[0,1]
    v_pk_fma_f32 v[18:19], v[42:43], v[36:37], v[18:19] op_sel:[1,1,0] op_sel_hi:[1,0,1] neg_lo:[0,1,0]
    v_cvt_pk_bf16_f32 v15, v18, v19
    ds_write_b32 v4, v15 offset:5984
    v_pk_mul_f32 v[42:43], v[18:19], v[36:37] op_sel:[0,0] op_sel_hi:[0,1]
    v_pk_fma_f32 v[42:43], v[18:19], v[36:37], v[42:43] op_sel:[1,1,0] op_sel_hi:[1,0,1] neg_lo:[0,1,0]
    v_cvt_pk_bf16_f32 v15, v42, v43
    ds_write_b32 v4, v15 offset:6256
    v_pk_mul_f32 v[18:19], v[42:43], v[36:37] op_sel:[0,0] op_sel_hi:[0,1]
    v_pk_fma_f32 v[18:19], v[42:43], v[36:37], v[18:19] op_sel:[1,1,0] op_sel_hi:[1,0,1] neg_lo:[0,1,0]
    v_cvt_pk_bf16_f32 v15, v18, v19
    ds_write_b32 v4, v15 offset:6528
    v_mov_b32 v15, 0
    ds_write_b32 v4, v15 offset:6800
    v_mov_b32 v15, 0
    ds_write_b32 v4, v15 offset:7072
    v_mov_b32 v15, 0
    ds_write_b32 v4, v15 offset:7344
    v_mov_b32 v15, 0
    ds_write_b32 v4, v15 offset:7616
    v_mov_b32 v15, 0
    ds_write_b32 v4, v15 offset:7888
    v_mov_b32 v15, 0
    ds_write_b32 v4, v15 offset:8160
    v_mov_b32 v15, 0
    ds_write_b32 v4, v15 offset:8432
    s_waitcnt lgkmcnt(0)
    ds_read_b128 v[64:67], v7 offset:4352
    ds_read_b128 v[68:71], v7 offset:4416
    ds_read_b128 v[72:75], v7 offset:4480
    ds_read_b128 v[76:79], v7 offset:4544
    v_mov_b32 v88, 0
    v_mov_b32 v89, 0
    v_mov_b32 v90, 0
    v_mov_b32 v91, 0
    s_waitcnt lgkmcnt(3)
    v_mfma_f32_16x16x32_bf16 v[88:91], v[64:67], v[48:51], v[88:91]
    s_waitcnt lgkmcnt(2)
    v_mfma_f32_16x16x32_bf16 v[88:91], v[68:71], v[52:55], v[88:91]
    s_waitcnt lgkmcnt(1)
    v_mfma_f32_16x16x32_bf16 v[88:91], v[72:75], v[56:59], v[88:91]
    s_waitcnt lgkmcnt(0)
    v_mfma_f32_16x16x32_bf16 v[88:91], v[76:79], v[60:63], v[88:91]
    s_mul_i32 s26, s21, 4608
    s_add_u32 s26, s26, 34816
    v_lshlrev_b32 v8, 4, v1
    v_add_u32 v8, s26, v8
    s_nop 7
    s_cmp_eq_u32 s22, 0
    s_cbranch_scc1 K1_kg_a
    ds_write_b128 v8, v[80:83] offset:0
    ds_write_b128 v8, v[84:87] offset:1024
    ds_write_b128 v8, v[88:91] offset:2048
K1_kg_a:
    s_waitcnt lgkmcnt(0)
    s_barrier
    s_add_u32 s27, s26, 3072
    s_cmp_lg_u32 s22, 0
    s_cbranch_scc1 K1_kg_b
    ds_read_b128 v[64:67], v8 offset:0
    ds_read_b128 v[68:71], v8 offset:1024
    ds_read_b128 v[72:75], v8 offset:2048
    v_and_b32 v9, 1, v6
    v_lshrrev_b32 v10, 1, v6
    v_lshlrev_b32 v11, 2, v9
    v_lshl_add_u32 v11, v10, 7, v11
    v_lshl_add_u32 v11, v5, 3, v11
    v_cmp_gt_u32 vcc, 2, v6
    v_lshlrev_b32 v12, 6, v9
    v_lshl_add_u32 v13, v5, 2, v12
    v_add_u32 v13, 256, v13
    v_lshl_add_u32 v14, v5, 1, v12
    v_add_u32 v14, 384, v14
    v_cndmask_b32 v12, v14, v13, vcc
    v_mov_b32 v13, 32
    v_cndmask_b32 v13, v13, 2, vcc
    v_add_u32 v13, v12, v13
    v_lshl_add_u32 v14, v6, 6, v5
    v_add_u32 v14, 512, v14
    v_lshl_add_u32 v11, v11, 1, s27
    v_lshl_add_u32 v12, v12, 1, s27
    v_lshl_add_u32 v13, v13, 1, s27
    v_lshl_add_u32 v14, v14, 1, s27
    s_waitcnt lgkmcnt(0)
    v_add_f32 v80, v80, v64
    v_add_f32 v81, v81, v65
    v_add_f32 v82, v82, v66
    v_add_f32 v83, v83, v67
    v_add_f32 v84, v84, v68
    v_add_f32 v85, v85, v69
    v_add_f32 v86, v86, v70
    v_add_f32 v87, v87, v71
    v_add_f32 v88, v88, v72
    v_add_f32 v89, v89, v73
    v_add_f32 v90, v90, v74
    v_add_f32 v91, v91, v75
    v_cvt_pk_bf16_f32 v64, v80, v81
    v_cvt_pk_bf16_f32 v65, v82, v83
    v_cvt_pk_bf16_f32 v66, v84, v85
    v_cvt_pk_bf16_f32 v67, v86, v87
    v_cvt_pk_bf16_f32 v68, v88, v89
    v_cvt_pk_bf16_f32 v69, v90, v91
    ds_write_b64 v11, v[64:65]
    ds_write_b16 v12, v66
    ds_write_b16_d16_hi v12, v66 offset:2
    ds_write_b16 v13, v67
    ds_write_b16_d16_hi v13, v67 offset:2
    ds_write_b16 v14, v68
    ds_write_b16_d16_hi v14, v68 offset:32
    ds_write_b16 v14, v69 offset:64
    ds_write_b16_d16_hi v14, v69 offset:96
K1_kg_b:
    s_waitcnt lgkmcnt(0)
    s_barrier
    s_lshl_b32 s28, s22, 6
    v_add_u32 v2, s28, v1
    s_mul_i32 s29, s20, 4224
    v_lshl_add_u32 v8, v2, 1, s27
    ds_read_u16 v9, v8 offset:1024
    ds_read_u16 v10, v8 offset:1026
    v_sub_u32 v11, 130, v2
    v_lshlrev_b32 v11, 4, v11
    v_and_b32 v12, 1, v2
    v_cmp_eq_u32 vcc, 1, v12
    s_waitcnt lgkmcnt(0)
    v_lshl_or_b32 v16, v10, 16, v10
    v_lshl_or_b32 v18, v9, 16, v9
    v_lshl_or_b32 v17, v9, 16, v10
    v_mov_b32 v19, v18
    v_cndmask_b32 v17, v17, v16, vcc
    buffer_store_dwordx4 v[16:19], v11, s[12:15], s29 offen
    v_sub_u32 v11, 258, v2
    v_lshlrev_b32 v11, 4, v11
    s_cmp_eq_u32 s22, 0
    s_cbranch_scc1 K1_kg_c
    v_lshl_add_u32 v8, v2, 2, s27
    ds_read_u16 v9, v8 offset:512
    ds_read_u16 v10, v8 offset:514
    ds_read_u16 v12, v8 offset:516
    s_waitcnt lgkmcnt(0)
    v_lshl_or_b32 v20, v12, 16, v12
    v_lshl_or_b32 v21, v10, 16, v10
    v_lshl_or_b32 v22, v9, 16, v10
    v_lshl_or_b32 v23, v9, 16, v9
    buffer_store_dwordx4 v[20:23], v11, s[12:15], s29 offen
    s_endpgm
K1_kg_c:
    v_lshl_add_u32 v8, v2, 4, s27
    ds_read_b128 v[24:27], v8
    v_lshl_add_u32 v8, v2, 3, s27
    ds_read_b64 v[28:29], v8 offset:256
    ds_read_u16 v30, v8 offset:264
    s_waitcnt lgkmcnt(0)
    v_alignbit_b32 v20, v27, v27, 16
    v_alignbit_b32 v21, v26, v26, 16
    v_alignbit_b32 v22, v25, v25, 16
    v_alignbit_b32 v23, v24, v24, 16
    v_and_b32 v9, 0xffff0000, v29
    v_or_b32 v24, v9, v30
    v_and_b32 v10, 0xffff, v29
    v_lshl_or_b32 v25, v10, 16, v10
    v_and_b32 v9, 0xffff0000, v28
    v_or_b32 v26, v9, v10
    v_and_b32 v10, 0xffff, v28
    v_lshl_or_b32 v27, v10, 16, v10
    v_cmp_gt_u32 vcc, 32, v1
    s_nop 1
    v_cndmask_b32 v20, v24, v20, vcc
    v_cndmask_b32 v21, v25, v21, vcc
    v_cndmask_b32 v22, v26, v22, vcc
    v_cndmask_b32 v23, v27, v23, vcc
    buffer_store_dwordx4 v[20:23], v11, s[12:15], s29 offen
    v_add_u32 v9, 256, v1
    v_cmp_gt_u32 vcc, 3, v1
    v_cndmask_b32 v9, v9, v1, vcc
    v_lshlrev_b32 v9, 4, v9
    v_mov_b32 v24, 0
    v_mov_b32 v25, 0
    v_mov_b32 v26, 0
    v_mov_b32 v27, 0
    v_cmp_gt_u32 vcc, 8, v1
    s_and_saveexec_b64 s[30:31], vcc
    buffer_store_dwordx4 v[24:27], v9, s[12:15], s29 offen
K1_end:
    s_endpgm
.globl k2_kernel
.p2align 8
.type k2_kernel,@function
k2_kernel:
    s_cmp_ge_u32 s2, 227
    s_cbranch_scc1 K2_end
    v_lshrrev_b32 v1, 6, v0
    s_nop 0
    v_readfirstlane_b32 s3, v1
    s_load_dwordx2 s[4:5], s[0:1], 144
    s_load_dwordx2 s[6:7], s[0:1], 64
    s_cmp_ge_u32 s2, 160
    s_cbranch_scc1 K2_oth
    s_cmp_ge_u32 s3, 4
    s_cbranch_scc1 K2_pp
    s_lshr_b32 s59, s2, 3
    s_lshr_b32 s58, s59, 2
    s_lshl_b32 s58, s58, 2
    s_and_b32 s57, s2, 7
    s_lshr_b32 s56, s57, 1
    s_add_u32 s58, s58, s56
    s_lshl_b32 s58, s58, 3
    s_and_b32 s57, s57, 1
    s_lshl_b32 s57, s57, 1
    s_add_u32 s58, s58, s57
    s_and_b32 s57, s59, 1
    s_add_u32 s58, s58, s57
    s_and_b32 s57, s59, 2
    s_lshl_b32 s57, s57, 1
    s_add_u32 s58, s58, s57
    s_lshl_b32 s20, s58, 2
    s_add_u32 s20, s20, s3
    v_and_b32 v1, 63, v0
    v_lshlrev_b32 v2, 4, v1
    s_mul_i32 s21, s20, 4224
    s_waitcnt lgkmcnt(0)
    s_add_u32 s8, s4, 7340032
    s_addc_u32 s9, s5, 0
    s_mov_b32 s10, 2705408
    s_mov_b32 s11, 0x00020000
    s_add_u32 s12, s4, 1048576
    s_addc_u32 s13, s5, 0
    s_mov_b32 s14, 2621440
    s_mov_b32 s15, 0x00020000
    s_add_u32 s16, s4, 4194304
    s_addc_u32 s17, s5, 0
    s_mov_b32 s18, 2621440
    s_mov_b32 s19, 0x00020000
    v_lshrrev_b32 v48, 2, v1
    v_mul_u32_u24 v48, 10240, v48
    v_and_b32 v49, 3, v1
    v_lshl_add_u32 v48, v49, 4, v48
    s_lshl_b32 s35, s58, 6
    s_mul_i32 s36, s3, 655360
    s_add_u32 s35, s35, s36
    s_lshl_b32 s37, s3, 12
    s_add_u32 m0, s37, 76544
    s_add_u32 s36, s35, 0
    buffer_load_dwordx4 v48, s[12:15], s36 offen lds
    s_add_u32 m0, s37, 77568
    s_add_u32 s36, s35, 163840
    buffer_load_dwordx4 v48, s[12:15], s36 offen lds
    s_add_u32 m0, s37, 78592
    s_add_u32 s36, s35, 327680
    buffer_load_dwordx4 v48, s[12:15], s36 offen lds
    s_add_u32 m0, s37, 79616
    s_add_u32 s36, s35, 491520
    buffer_load_dwordx4 v48, s[12:15], s36 offen lds
    s_lshl_b32 s22, s20, 2
    s_add_u32 s24, s4, s22
    s_addc_u32 s25, s5, 0
    s_load_dword s40, s[24:25], 90112
    s_load_dword s41, s[24:25], 92672
    s_load_dword s42, s[24:25], 95232
    s_lshl_b32 s22, s20, 1
    s_and_b32 s23, s22, 0xfffffffc
    s_add_u32 s26, s6, s23
    s_addc_u32 s27, s7, 0
    s_load_dword s52, s[26:27], 0
    s_mul_i32 s28, s3, 10368
    v_add_u32 v3, 2, v2
    s_add_u32 m0, s28, 0
    s_add_u32 s29, s21, 0
    buffer_load_dwordx4 v2, s[8:11], s29 offen lds
    s_add_u32 m0, s28, 1024
    s_add_u32 s29, s21, 1024
    buffer_load_dwordx4 v2, s[8:11], s29 offen lds
    s_add_u32 m0, s28, 2048
    s_add_u32 s29, s21, 2048
    buffer_load_dwordx4 v2, s[8:11], s29 offen lds
    s_add_u32 m0, s28, 3072
    s_add_u32 s29, s21, 3072
    buffer_load_dwordx4 v2, s[8:11], s29 offen lds
    s_add_u32 m0, s28, 4096
    s_add_u32 s29, s21, 4096
    buffer_load_dwordx4 v2, s[8:11], s29 offen lds
    s_add_u32 m0, s28, 5184
    s_add_u32 s29, s21, 0
    buffer_load_dwordx4 v3, s[8:11], s29 offen lds
    s_add_u32 m0, s28, 6208
    s_add_u32 s29, s21, 1024
    buffer_load_dwordx4 v3, s[8:11], s29 offen lds
    s_add_u32 m0, s28, 7232
    s_add_u32 s29, s21, 2048
    buffer_load_dwordx4 v3, s[8:11], s29 offen lds
    s_add_u32 m0, s28, 8256
    s_add_u32 s29, s21, 3072
    buffer_load_dwordx4 v3, s[8:11], s29 offen lds
    s_add_u32 m0, s28, 9280
    s_add_u32 s29, s21, 4096
    buffer_load_dwordx4 v3, s[8:11], s29 offen lds
    v_and_b32 v4, 15, v1
    v_lshrrev_b32 v5, 4, v1
    v_lshlrev_b32 v6, 5, v4
    v_lshl_add_u32 v6, v5, 3, v6
    s_lshl_b32 s34, s3, 12
    s_add_u32 s34, s34, 60160
    s_waitcnt lgkmcnt(0)
    v_mov_b32 v40, s40
    v_mov_b32 v41, s41
    v_mov_b32 v42, s42
    s_and_b32 s22, s20, 1
    s_lshl_b32 s22, s22, 4
    s_lshr_b32 s52, s52, s22
    s_lshl_b32 s52, s52, 16
    v_mov_b32 v43, s52
    s_mul_i32 s30, s3, 4672
    s_add_u32 s30, s30, 41472
    v_add_u32 v7, s30, v2
    v_mov_b32 v44, 0
    v_mov_b32 v45, 0
    v_mov_b32 v46, 0
    v_mov_b32 v47, 0
    v_cmp_gt_u32 vcc, 32, v1
    s_and_saveexec_b64 s[32:33], vcc
    ds_write_b128 v7, v[44:47]
    v_cmp_gt_u32 vcc, 4, v1
    s_and_b64 exec, exec, vcc
    ds_write_b128 v7, v[44:47] offset:4608
    s_mov_b64 exec, s[32:33]
    v_lshlrev_b32 v49, 6, v1
    s_lshl_b32 s36, s3, 4
    s_add_u32 s36, s36, 76544
    v_add_u32 v49, s36, v49
    v_mul_u32_u24 v56, 10240, v1
    s_lshl_b32 s35, s20, 4
    s_waitcnt vmcnt(10)
    s_barrier
    s_add_u32 m0, s34, 0
    s_add_u32 s29, s35, 0
    buffer_load_dwordx4 v56, s[16:19], s29 offen lds
    s_add_u32 m0, s34, 1024
    s_add_u32 s29, s35, 655360
    buffer_load_dwordx4 v56, s[16:19], s29 offen lds
    s_add_u32 m0, s34, 2048
    s_add_u32 s29, s35, 1310720
    buffer_load_dwordx4 v56, s[16:19], s29 offen lds
    s_add_u32 m0, s34, 3072
    s_add_u32 s29, s35, 1966080
    buffer_load_dwordx4 v56, s[16:19], s29 offen lds
    ds_read_b128 v[8:11], v49 offset:0
    ds_read_b128 v[12:15], v49 offset:4096
    ds_read_b128 v[16:19], v49 offset:8192
    ds_read_b128 v[20:23], v49 offset:12288
    s_waitcnt lgkmcnt(0)
    v_lshlrev_b32 v48, 16, v8
    v_and_b32 v49, 0xffff0000, v8
    v_fma_f32 v48, v48, v41, v40
    v_fma_f32 v49, v49, v41, v40
    v_cvt_pk_bf16_f32 v8, v48, v49
    v_lshlrev_b32 v48, 16, v9
    v_and_b32 v49, 0xffff0000, v9
    v_fma_f32 v48, v48, v41, v40
    v_fma_f32 v49, v49, v41, v40
    v_cvt_pk_bf16_f32 v9, v48, v49
    v_lshlrev_b32 v48, 16, v10
    v_and_b32 v49, 0xffff0000, v10
    v_fma_f32 v48, v48, v41, v40
    v_fma_f32 v49, v49, v41, v40
    v_cvt_pk_bf16_f32 v10, v48, v49
    v_lshlrev_b32 v48, 16, v11
    v_and_b32 v49, 0xffff0000, v11
    v_fma_f32 v48, v48, v41, v40
    v_fma_f32 v49, v49, v41, v40
    v_cvt_pk_bf16_f32 v11, v48, v49
    ds_write_b128 v7, v[8:11] offset:512
    v_lshlrev_b32 v48, 16, v12
    v_and_b32 v49, 0xffff0000, v12
    v_fma_f32 v48, v48, v41, v40
    v_fma_f32 v49, v49, v41, v40
    v_cvt_pk_bf16_f32 v12, v48, v49
    v_lshlrev_b32 v48, 16, v13
    v_and_b32 v49, 0xffff0000, v13
    v_fma_f32 v48, v48, v41, v40
    v_fma_f32 v49, v49, v41, v40
    v_cvt_pk_bf16_f32 v13, v48, v49
    v_lshlrev_b32 v48, 16, v14
    v_and_b32 v49, 0xffff0000, v14
    v_fma_f32 v48, v48, v41, v40
    v_fma_f32 v49, v49, v41, v40
    v_cvt_pk_bf16_f32 v14, v48, v49
    v_lshlrev_b32 v48, 16, v15
    v_and_b32 v49, 0xffff0000, v15
    v_fma_f32 v48, v48, v41, v40
    v_fma_f32 v49, v49, v41, v40
    v_cvt_pk_bf16_f32 v15, v48, v49
    ds_write_b128 v7, v[12:15] offset:1536
    v_lshlrev_b32 v48, 16, v16
    v_and_b32 v49, 0xffff0000, v16
    v_fma_f32 v48, v48, v41, v40
    v_fma_f32 v49, v49, v41, v40
    v_cvt_pk_bf16_f32 v16, v48, v49
    v_lshlrev_b32 v48, 16, v17
    v_and_b32 v49, 0xffff0000, v17
    v_fma_f32 v48, v48, v41, v40
    v_fma_f32 v49, v49, v41, v40
    v_cvt_pk_bf16_f32 v17, v48, v49
    v_lshlrev_b32 v48, 16, v18
    v_and_b32 v49, 0xffff0000, v18
    v_fma_f32 v48, v48, v41, v40
    v_fma_f32 v49, v49, v41, v40
    v_cvt_pk_bf16_f32 v18, v48, v49
    v_lshlrev_b32 v48, 16, v19
    v_and_b32 v49, 0xffff0000, v19
    v_fma_f32 v48, v48, v41, v40
    v_fma_f32 v49, v49, v41, v40
    v_cvt_pk_bf16_f32 v19, v48, v49
    ds_write_b128 v7, v[16:19] offset:2560
    v_lshlrev_b32 v48, 16, v20
    v_and_b32 v49, 0xffff0000, v20
    v_fma_f32 v48, v48, v41, v40
    v_fma_f32 v49, v49, v41, v40
    v_cvt_pk_bf16_f32 v20, v48, v49
    v_lshlrev_b32 v48, 16, v21
    v_and_b32 v49, 0xffff0000, v21
    v_fma_f32 v48, v48, v41, v40
    v_fma_f32 v49, v49, v41, v40
    v_cvt_pk_bf16_f32 v21, v48, v49
    v_lshlrev_b32 v48, 16, v22
    v_and_b32 v49, 0xffff0000, v22
    v_fma_f32 v48, v48, v41, v40
    v_fma_f32 v49, v49, v41, v40
    v_cvt_pk_bf16_f32 v22, v48, v49
    v_lshlrev_b32 v48, 16, v23
    v_and_b32 v49, 0xffff0000, v23
    v_fma_f32 v48, v48, v41, v40
    v_fma_f32 v49, v49, v41, v40
    v_cvt_pk_bf16_f32 v23, v48, v49
    ds_write_b128 v7, v[20:23] offset:3584
    v_lshlrev_b32 v50, 3, v5
    v_sub_u32 v50, v50, v4
    v_add_u32 v50, 2070, v50
    v_lshlrev_b32 v50, 1, v50
    v_and_b32 v51, 1, v4
    v_cmp_eq_u32 vcc, 1, v51
    v_mov_b32 v51, 5184
    v_cndmask_b32 v51, v51, 2, vcc
    v_add_u32 v50, v50, v51
    s_sub_u32 s31, s28, 4096
    v_add_u32 v50, s31, v50
    v_add_u32 v51, 1024, v50
    v_add_u32 v52, 2048, v50
    v_add_u32 v53, 3072, v50
    v_add_u32 v54, 4096, v50
    v_lshlrev_b32 v55, 5, v4
    v_lshl_add_u32 v55, v5, 4, v55
    v_add_u32 v55, s30, v55
    v_mov_b32 v56, 0
    v_mov_b32 v57, 0
    v_mov_b32 v58, 0
    v_mov_b32 v59, 0
    v_mov_b32 v60, 0
    v_mov_b32 v61, 0
    v_mov_b32 v62, 0
    v_mov_b32 v63, 0
    v_mov_b32 v64, 0
    v_mov_b32 v65, 0
    v_mov_b32 v66, 0
    v_mov_b32 v67, 0
    v_mov_b32 v68, 0
    v_mov_b32 v69, 0
    v_mov_b32 v70, 0
    v_mov_b32 v71, 0
    v_mov_b32 v72, 0
    v_mov_b32 v73, 0
    v_mov_b32 v74, 0
    v_mov_b32 v75, 0
    v_mov_b32 v76, 0
    v_mov_b32 v77, 0
    v_mov_b32 v78, 0
    v_mov_b32 v79, 0
    v_mov_b32 v80, 0
    v_mov_b32 v81, 0
    v_mov_b32 v82, 0
    v_mov_b32 v83, 0
    v_mov_b32 v84, 0
    v_mov_b32 v85, 0
    v_mov_b32 v86, 0
    v_mov_b32 v87, 0
    s_waitcnt vmcnt(4) lgkmcnt(0)
    ds_read_b128 v[120:123], v55 offset:0
    ds_read2_b32 v[116:117], v50 offset0:0 offset1:1
    ds_read2_b32 v[118:119], v50 offset0:2 offset1:3
    ds_read_b128 v[124:127], v55 offset:512
    ds_read2_b32 v[112:113], v50 offset0:128 offset1:129
    ds_read2_b32 v[114:115], v50 offset0:130 offset1:131
    ds_read_b128 v[128:131], v55 offset:1024
    ds_read2_b32 v[108:109], v51 offset0:0 offset1:1
    ds_read2_b32 v[110:111], v51 offset0:2 offset1:3
    ds_read_b128 v[132:135], v55 offset:1536
    ds_read2_b32 v[104:105], v51 offset0:128 offset1:129
    ds_read2_b32 v[106:107], v51 offset0:130 offset1:131
    ds_read_b128 v[136:139], v55 offset:2048
    ds_read2_b32 v[100:101], v52 offset0:0 offset1:1
    ds_read2_b32 v[102:103], v52 offset0:2 offset1:3
    ds_read_b128 v[140:143], v55 offset:2560
    ds_read2_b32 v[96:97], v52 offset0:128 offset1:129
    ds_read2_b32 v[98:99], v52 offset0:130 offset1:131
    ds_read_b128 v[144:147], v55 offset:3072
    ds_read2_b32 v[92:93], v53 offset0:0 offset1:1
    ds_read2_b32 v[94:95], v53 offset0:2 offset1:3
    ds_read_b128 v[148:151], v55 offset:3584
    ds_read2_b32 v[88:89], v53 offset0:128 offset1:129
    ds_read2_b32 v[90:91], v53 offset0:130 offset1:131
    ds_read2_b32 v[216:217], v54 offset0:0 offset1:1
    ds_read2_b32 v[218:219], v54 offset0:2 offset1:3
    ds_read_b128 v[220:223], v55 offset:4096
    s_waitcnt lgkmcnt(0)
    v_mfma_f32_16x16x32_bf16 v[84:87], v[116:119], v[120:123], v[84:87]
    ds_read_b128 v[184:187], v55 offset:64
    v_mfma_f32_16x16x32_bf16 v[80:83], v[112:115], v[120:123], v[80:83]
    ds_read2_b32 v[180:181], v50 offset0:16 offset1:17
    v_mfma_f32_16x16x32_bf16 v[84:87], v[112:115], v[124:127], v[84:87]
    ds_read2_b32 v[182:183], v50 offset0:18 offset1:19
    v_mfma_f32_16x16x32_bf16 v[76:79], v[108:111], v[120:123], v[76:79]
    ds_read_b128 v[188:191], v55 offset:576
    v_mfma_f32_16x16x32_bf16 v[80:83], v[108:111], v[124:127], v[80:83]
    ds_read2_b32 v[176:177], v50 offset0:144 offset1:145
    v_mfma_f32_16x16x32_bf16 v[84:87], v[108:111], v[128:131], v[84:87]
    ds_read2_b32 v[178:179], v50 offset0:146 offset1:147
    v_mfma_f32_16x16x32_bf16 v[72:75], v[104:107], v[120:123], v[72:75]
    ds_read_b128 v[192:195], v55 offset:1088
    v_mfma_f32_16x16x32_bf16 v[76:79], v[104:107], v[124:127], v[76:79]
    ds_read2_b32 v[172:173], v51 offset0:16 offset1:17
    v_mfma_f32_16x16x32_bf16 v[80:83], v[104:107], v[128:131], v[80:83]
    ds_read2_b32 v[174:175], v51 offset0:18 offset1:19
    v_mfma_f32_16x16x32_bf16 v[84:87], v[104:107], v[132:135], v[84:87]
    ds_read_b128 v[196:199], v55 offset:1600
    v_mfma_f32_16x16x32_bf16 v[68:71], v[100:103], v[120:123], v[68:71]
    ds_read2_b32 v[168:169], v51 offset0:144 offset1:145
    v_mfma_f32_16x16x32_bf16 v[72:75], v[100:103], v[124:127], v[72:75]
    ds_read2_b32 v[170:171], v51 offset0:146 offset1:147
    v_mfma_f32_16x16x32_bf16 v[76:79], v[100:103], v[128:131], v[76:79]
    ds_read_b128 v[200:203], v55 offset:2112
    v_mfma_f32_16x16x32_bf16 v[80:83], v[100:103], v[132:135], v[80:83]
    ds_read2_b32 v[164:165], v52 offset0:16 offset1:17
    v_mfma_f32_16x16x32_bf16 v[84:87], v[100:103], v[136:139], v[84:87]
    ds_read2_b32 v[166:167], v52 offset0:18 offset1:19
    v_mfma_f32_16x16x32_bf16 v[64:67], v[96:99], v[120:123], v[64:67]
    ds_read_b128 v[204:207], v55 offset:2624
    v_mfma_f32_16x16x32_bf16 v[68:71], v[96:99], v[124:127], v[68:71]
    ds_read2_b32 v[160:161], v52 offset0:144 offset1:145
    v_mfma_f32_16x16x32_bf16 v[72:75], v[96:99], v[128:131], v[72:75]
    ds_read2_b32 v[162:163], v52 offset0:146 offset1:147
    v_mfma_f32_16x16x32_bf16 v[76:79], v[96:99], v[132:135], v[76:79]
    ds_read_b128 v[208:211], v55 offset:3136
    v_mfma_f32_16x16x32_bf16 v[80:83], v[96:99], v[136:139], v[80:83]
    ds_read2_b32 v[156:157], v53 offset0:16 offset1:17
    v_mfma_f32_16x16x32_bf16 v[84:87], v[96:99], v[140:143], v[84:87]
    ds_read2_b32 v[158:159], v53 offset0:18 offset1:19
    v_mfma_f32_16x16x32_bf16 v[60:63], v[92:95], v[120:123], v[60:63]
    ds_read_b128 v[212:215], v55 offset:3648
    v_mfma_f32_16x16x32_bf16 v[64:67], v[92:95], v[124:127], v[64:67]
    ds_read2_b32 v[152:153], v53 offset0:144 offset1:145
    v_mfma_f32_16x16x32_bf16 v[68:71], v[92:95], v[128:131], v[68:71]
    ds_read2_b32 v[154:155], v53 offset0:146 offset1:147
    v_mfma_f32_16x16x32_bf16 v[72:75], v[92:95], v[132:135], v[72:75]
    v_mfma_f32_16x16x32_bf16 v[76:79], v[92:95], v[136:139], v[76:79]
    v_mfma_f32_16x16x32_bf16 v[80:83], v[92:95], v[140:143], v[80:83]
    v_mfma_f32_16x16x32_bf16 v[84:87], v[92:95], v[144:147], v[84:87]
    v_mfma_f32_16x16x32_bf16 v[56:59], v[88:91], v[120:123], v[56:59]
    v_mfma_f32_16x16x32_bf16 v[60:63], v[88:91], v[124:127], v[60:63]
    v_mfma_f32_16x16x32_bf16 v[64:67], v[88:91], v[128:131], v[64:67]
    v_mfma_f32_16x16x32_bf16 v[68:71], v[88:91], v[132:135], v[68:71]
    v_mfma_f32_16x16x32_bf16 v[72:75], v[88:91], v[136:139], v[72:75]
    v_mfma_f32_16x16x32_bf16 v[76:79], v[88:91], v[140:143], v[76:79]
    v_mfma_f32_16x16x32_bf16 v[80:83], v[88:91], v[144:147], v[80:83]
    v_mfma_f32_16x16x32_bf16 v[84:87], v[88:91], v[148:151], v[84:87]
    v_mfma_f32_16x16x32_bf16 v[56:59], v[216:219], v[124:127], v[56:59]
    v_mfma_f32_16x16x32_bf16 v[60:63], v[216:219], v[128:131], v[60:63]
    v_mfma_f32_16x16x32_bf16 v[64:67], v[216:219], v[132:135], v[64:67]
    v_mfma_f32_16x16x32_bf16 v[68:71], v[216:219], v[136:139], v[68:71]
    v_mfma_f32_16x16x32_bf16 v[72:75], v[216:219], v[140:143], v[72:75]
    v_mfma_f32_16x16x32_bf16 v[76:79], v[216:219], v[144:147], v[76:79]
    v_mfma_f32_16x16x32_bf16 v[80:83], v[216:219], v[148:151], v[80:83]
    v_mfma_f32_16x16x32_bf16 v[84:87], v[216:219], v[220:223], v[84:87]
    s_waitcnt lgkmcnt(0)
    v_mfma_f32_16x16x32_bf16 v[84:87], v[180:183], v[184:187], v[84:87]
    ds_read_b128 v[120:123], v55 offset:128
    v_mfma_f32_16x16x32_bf16 v[80:83], v[176:179], v[184:187], v[80:83]
    ds_read2_b32 v[116:117], v50 offset0:32 offset1:33
    v_mfma_f32_16x16x32_bf16 v[84:87], v[176:179], v[188:191], v[84:87]
    ds_read2_b32 v[118:119], v50 offset0:34 offset1:35
    v_mfma_f32_16x16x32_bf16 v[76:79], v[172:175], v[184:187], v[76:79]
    ds_read_b128 v[124:127], v55 offset:640
    v_mfma_f32_16x16x32_bf16 v[80:83], v[172:175], v[188:191], v[80:83]
    ds_read2_b32 v[112:113], v50 offset0:160 offset1:161
    v_mfma_f32_16x16x32_bf16 v[84:87], v[172:175], v[192:195], v[84:87]
    ds_read2_b32 v[114:115], v50 offset0:162 offset1:163
    v_mfma_f32_16x16x32_bf16 v[72:75], v[168:171], v[184:187], v[72:75]
    ds_read_b128 v[128:131], v55 offset:1152
    v_mfma_f32_16x16x32_bf16 v[76:79], v[168:171], v[188:191], v[76:79]
    ds_read2_b32 v[108:109], v51 offset0:32 offset1:33
    v_mfma_f32_16x16x32_bf16 v[80:83], v[168:171], v[192:195], v[80:83]
    ds_read2_b32 v[110:111], v51 offset0:34 offset1:35
    v_mfma_f32_16x16x32_bf16 v[84:87], v[168:171], v[196:199], v[84:87]
    ds_read_b128 v[132:135], v55 offset:1664
    v_mfma_f32_16x16x32_bf16 v[68:71], v[164:167], v[184:187], v[68:71]
    ds_read2_b32 v[104:105], v51 offset0:160 offset1:161
    v_mfma_f32_16x16x32_bf16 v[72:75], v[164:167], v[188:191], v[72:75]
    ds_read2_b32 v[106:107], v51 offset0:162 offset1:163
    v_mfma_f32_16x16x32_bf16 v[76:79], v[164:167], v[192:195], v[76:79]
    ds_read_b128 v[136:139], v55 offset:2176
    v_mfma_f32_16x16x32_bf16 v[80:83], v[164:167], v[196:199], v[80:83]
    ds_read2_b32 v[100:101], v52 offset0:32 offset1:33
    v_mfma_f32_16x16x32_bf16 v[84:87], v[164:167], v[200:203], v[84:87]
    ds_read2_b32 v[102:103], v52 offset0:34 offset1:35
    v_mfma_f32_16x16x32_bf16 v[64:67], v[160:163], v[184:187], v[64:67]
    ds_read_b128 v[140:143], v55 offset:2688
    v_mfma_f32_16x16x32_bf16 v[68:71], v[160:163], v[188:191], v[68:71]
    ds_read2_b32 v[96:97], v52 offset0:160 offset1:161
    v_mfma_f32_16x16x32_bf16 v[72:75], v[160:163], v[192:195], v[72:75]
    ds_read2_b32 v[98:99], v52 offset0:162 offset1:163
    v_mfma_f32_16x16x32_bf16 v[76:79], v[160:163], v[196:199], v[76:79]
    ds_read_b128 v[144:147], v55 offset:3200
    v_mfma_f32_16x16x32_bf16 v[80:83], v[160:163], v[200:203], v[80:83]
    ds_read2_b32 v[92:93], v53 offset0:32 offset1:33
    v_mfma_f32_16x16x32_bf16 v[84:87], v[160:163], v[204:207], v[84:87]
    ds_read2_b32 v[94:95], v53 offset0:34 offset1:35
    v_mfma_f32_16x16x32_bf16 v[60:63], v[156:159], v[184:187], v[60:63]
    ds_read_b128 v[148:151], v55 offset:3712
    v_mfma_f32_16x16x32_bf16 v[64:67], v[156:159], v[188:191], v[64:67]
    ds_read2_b32 v[88:89], v53 offset0:160 offset1:161
    v_mfma_f32_16x16x32_bf16 v[68:71], v[156:159], v[192:195], v[68:71]
    ds_read2_b32 v[90:91], v53 offset0:162 offset1:163
    v_mfma_f32_16x16x32_bf16 v[72:75], v[156:159], v[196:199], v[72:75]
    v_mfma_f32_16x16x32_bf16 v[76:79], v[156:159], v[200:203], v[76:79]
    v_mfma_f32_16x16x32_bf16 v[80:83], v[156:159], v[204:207], v[80:83]
    v_mfma_f32_16x16x32_bf16 v[84:87], v[156:159], v[208:211], v[84:87]
    v_mfma_f32_16x16x32_bf16 v[56:59], v[152:155], v[184:187], v[56:59]
    v_mfma_f32_16x16x32_bf16 v[60:63], v[152:155], v[188:191], v[60:63]
    v_mfma_f32_16x16x32_bf16 v[64:67], v[152:155], v[192:195], v[64:67]
    v_mfma_f32_16x16x32_bf16 v[68:71], v[152:155], v[196:199], v[68:71]
    v_mfma_f32_16x16x32_bf16 v[72:75], v[152:155], v[200:203], v[72:75]
    v_mfma_f32_16x16x32_bf16 v[76:79], v[152:155], v[204:207], v[76:79]
    v_mfma_f32_16x16x32_bf16 v[80:83], v[152:155], v[208:211], v[80:83]
    v_mfma_f32_16x16x32_bf16 v[84:87], v[152:155], v[212:215], v[84:87]
    s_waitcnt lgkmcnt(0)
    v_mfma_f32_16x16x32_bf16 v[84:87], v[116:119], v[120:123], v[84:87]
    ds_read_b128 v[184:187], v55 offset:192
    v_mfma_f32_16x16x32_bf16 v[80:83], v[112:115], v[120:123], v[80:83]
    ds_read2_b32 v[180:181], v50 offset0:48 offset1:49
    v_mfma_f32_16x16x32_bf16 v[84:87], v[112:115], v[124:127], v[84:87]
    ds_read2_b32 v[182:183], v50 offset0:50 offset1:51
    v_mfma_f32_16x16x32_bf16 v[76:79], v[108:111], v[120:123], v[76:79]
    ds_read_b128 v[188:191], v55 offset:704
    v_mfma_f32_16x16x32_bf16 v[80:83], v[108:111], v[124:127], v[80:83]
    ds_read2_b32 v[176:177], v50 offset0:176 offset1:177
    v_mfma_f32_16x16x32_bf16 v[84:87], v[108:111], v[128:131], v[84:87]
    ds_read2_b32 v[178:179], v50 offset0:178 offset1:179
    v_mfma_f32_16x16x32_bf16 v[72:75], v[104:107], v[120:123], v[72:75]
    ds_read_b128 v[192:195], v55 offset:1216
    v_mfma_f32_16x16x32_bf16 v[76:79], v[104:107], v[124:127], v[76:79]
    ds_read2_b32 v[172:173], v51 offset0:48 offset1:49
    v_mfma_f32_16x16x32_bf16 v[80:83], v[104:107], v[128:131], v[80:83]
    ds_read2_b32 v[174:175], v51 offset0:50 offset1:51
    v_mfma_f32_16x16x32_bf16 v[84:87], v[104:107], v[132:135], v[84:87]
    ds_read_b128 v[196:199], v55 offset:1728
    v_mfma_f32_16x16x32_bf16 v[68:71], v[100:103], v[120:123], v[68:71]
    ds_read2_b32 v[168:169], v51 offset0:176 offset1:177
    v_mfma_f32_16x16x32_bf16 v[72:75], v[100:103], v[124:127], v[72:75]
    ds_read2_b32 v[170:171], v51 offset0:178 offset1:179
    v_mfma_f32_16x16x32_bf16 v[76:79], v[100:103], v[128:131], v[76:79]
    ds_read_b128 v[200:203], v55 offset:2240
    v_mfma_f32_16x16x32_bf16 v[80:83], v[100:103], v[132:135], v[80:83]
    ds_read2_b32 v[164:165], v52 offset0:48 offset1:49
    v_mfma_f32_16x16x32_bf16 v[84:87], v[100:103], v[136:139], v[84:87]
    ds_read2_b32 v[166:167], v52 offset0:50 offset1:51
    v_mfma_f32_16x16x32_bf16 v[64:67], v[96:99], v[120:123], v[64:67]
    ds_read_b128 v[204:207], v55 offset:2752
    v_mfma_f32_16x16x32_bf16 v[68:71], v[96:99], v[124:127], v[68:71]
    ds_read2_b32 v[160:161], v52 offset0:176 offset1:177
    v_mfma_f32_16x16x32_bf16 v[72:75], v[96:99], v[128:131], v[72:75]
    ds_read2_b32 v[162:163], v52 offset0:178 offset1:179
    v_mfma_f32_16x16x32_bf16 v[76:79], v[96:99], v[132:135], v[76:79]
    ds_read_b128 v[208:211], v55 offset:3264
    v_mfma_f32_16x16x32_bf16 v[80:83], v[96:99], v[136:139], v[80:83]
    ds_read2_b32 v[156:157], v53 offset0:48 offset1:49
    v_mfma_f32_16x16x32_bf16 v[84:87], v[96:99], v[140:143], v[84:87]
    ds_read2_b32 v[158:159], v53 offset0:50 offset1:51
    v_mfma_f32_16x16x32_bf16 v[60:63], v[92:95], v[120:123], v[60:63]
    ds_read_b128 v[212:215], v55 offset:3776
    v_mfma_f32_16x16x32_bf16 v[64:67], v[92:95], v[124:127], v[64:67]
    ds_read2_b32 v[152:153], v53 offset0:176 offset1:177
    v_mfma_f32_16x16x32_bf16 v[68:71], v[92:95], v[128:131], v[68:71]
    ds_read2_b32 v[154:155], v53 offset0:178 offset1:179
    v_mfma_f32_16x16x32_bf16 v[72:75], v[92:95], v[132:135], v[72:75]
    v_mfma_f32_16x16x32_bf16 v[76:79], v[92:95], v[136:139], v[76:79]
    v_mfma_f32_16x16x32_bf16 v[80:83], v[92:95], v[140:143], v[80:83]
    v_mfma_f32_16x16x32_bf16 v[84:87], v[92:95], v[144:147], v[84:87]
    v_mfma_f32_16x16x32_bf16 v[56:59], v[88:91], v[120:123], v[56:59]
    v_mfma_f32_16x16x32_bf16 v[60:63], v[88:91], v[124:127], v[60:63]
    v_mfma_f32_16x16x32_bf16 v[64:67], v[88:91], v[128:131], v[64:67]
    v_mfma_f32_16x16x32_bf16 v[68:71], v[88:91], v[132:135], v[68:71]
    v_mfma_f32_16x16x32_bf16 v[72:75], v[88:91], v[136:139], v[72:75]
    v_mfma_f32_16x16x32_bf16 v[76:79], v[88:91], v[140:143], v[76:79]
    v_mfma_f32_16x16x32_bf16 v[80:83], v[88:91], v[144:147], v[80:83]
    v_mfma_f32_16x16x32_bf16 v[84:87], v[88:91], v[148:151], v[84:87]
    s_waitcnt lgkmcnt(0)
    v_mfma_f32_16x16x32_bf16 v[84:87], v[180:183], v[184:187], v[84:87]
    ds_read_b128 v[120:123], v55 offset:256
    v_mfma_f32_16x16x32_bf16 v[80:83], v[176:179], v[184:187], v[80:83]
    ds_read2_b32 v[116:117], v50 offset0:64 offset1:65
    v_mfma_f32_16x16x32_bf16 v[84:87], v[176:179], v[188:191], v[84:87]
    ds_read2_b32 v[118:119], v50 offset0:66 offset1:67
    v_mfma_f32_16x16x32_bf16 v[76:79], v[172:175], v[184:187], v[76:79]
    ds_read_b128 v[124:127], v55 offset:768
    v_mfma_f32_16x16x32_bf16 v[80:83], v[172:175], v[188:191], v[80:83]
    ds_read2_b32 v[112:113], v50 offset0:192 offset1:193
    v_mfma_f32_16x16x32_bf16 v[84:87], v[172:175], v[192:195], v[84:87]
    ds_read2_b32 v[114:115], v50 offset0:194 offset1:195
    v_mfma_f32_16x16x32_bf16 v[72:75], v[168:171], v[184:187], v[72:75]
    ds_read_b128 v[128:131], v55 offset:1280
    v_mfma_f32_16x16x32_bf16 v[76:79], v[168:171], v[188:191], v[76:79]
    ds_read2_b32 v[108:109], v51 offset0:64 offset1:65
    v_mfma_f32_16x16x32_bf16 v[80:83], v[168:171], v[192:195], v[80:83]
    ds_read2_b32 v[110:111], v51 offset0:66 offset1:67
    v_mfma_f32_16x16x32_bf16 v[84:87], v[168:171], v[196:199], v[84:87]
    ds_read_b128 v[132:135], v55 offset:1792
    v_mfma_f32_16x16x32_bf16 v[68:71], v[164:167], v[184:187], v[68:71]
    ds_read2_b32 v[104:105], v51 offset0:192 offset1:193
    v_mfma_f32_16x16x32_bf16 v[72:75], v[164:167], v[188:191], v[72:75]
    ds_read2_b32 v[106:107], v51 offset0:194 offset1:195
    v_mfma_f32_16x16x32_bf16 v[76:79], v[164:167], v[192:195], v[76:79]
    ds_read_b128 v[136:139], v55 offset:2304
    v_mfma_f32_16x16x32_bf16 v[80:83], v[164:167], v[196:199], v[80:83]
    ds_read2_b32 v[100:101], v52 offset0:64 offset1:65
    v_mfma_f32_16x16x32_bf16 v[84:87], v[164:167], v[200:203], v[84:87]
    ds_read2_b32 v[102:103], v52 offset0:66 offset1:67
    v_mfma_f32_16x16x32_bf16 v[64:67], v[160:163], v[184:187], v[64:67]
    ds_read_b128 v[140:143], v55 offset:2816
    v_mfma_f32_16x16x32_bf16 v[68:71], v[160:163], v[188:191], v[68:71]
    ds_read2_b32 v[96:97], v52 offset0:192 offset1:193
    v_mfma_f32_16x16x32_bf16 v[72:75], v[160:163], v[192:195], v[72:75]
    ds_read2_b32 v[98:99], v52 offset0:194 offset1:195
    v_mfma_f32_16x16x32_bf16 v[76:79], v[160:163], v[196:199], v[76:79]
    ds_read_b128 v[144:147], v55 offset:3328
    v_mfma_f32_16x16x32_bf16 v[80:83], v[160:163], v[200:203], v[80:83]
    ds_read2_b32 v[92:93], v53 offset0:64 offset1:65
    v_mfma_f32_16x16x32_bf16 v[84:87], v[160:163], v[204:207], v[84:87]
    ds_read2_b32 v[94:95], v53 offset0:66 offset1:67
    v_mfma_f32_16x16x32_bf16 v[60:63], v[156:159], v[184:187], v[60:63]
    ds_read_b128 v[148:151], v55 offset:3840
    v_mfma_f32_16x16x32_bf16 v[64:67], v[156:159], v[188:191], v[64:67]
    ds_read2_b32 v[88:89], v53 offset0:192 offset1:193
    v_mfma_f32_16x16x32_bf16 v[68:71], v[156:159], v[192:195], v[68:71]
    ds_read2_b32 v[90:91], v53 offset0:194 offset1:195
    v_mfma_f32_16x16x32_bf16 v[72:75], v[156:159], v[196:199], v[72:75]
    v_mfma_f32_16x16x32_bf16 v[76:79], v[156:159], v[200:203], v[76:79]
    v_mfma_f32_16x16x32_bf16 v[80:83], v[156:159], v[204:207], v[80:83]
    v_mfma_f32_16x16x32_bf16 v[84:87], v[156:159], v[208:211], v[84:87]
    v_mfma_f32_16x16x32_bf16 v[56:59], v[152:155], v[184:187], v[56:59]
    v_mfma_f32_16x16x32_bf16 v[60:63], v[152:155], v[188:191], v[60:63]
    v_mfma_f32_16x16x32_bf16 v[64:67], v[152:155], v[192:195], v[64:67]
    v_mfma_f32_16x16x32_bf16 v[68:71], v[152:155], v[196:199], v[68:71]
    v_mfma_f32_16x16x32_bf16 v[72:75], v[152:155], v[200:203], v[72:75]
    v_mfma_f32_16x16x32_bf16 v[76:79], v[152:155], v[204:207], v[76:79]
    v_mfma_f32_16x16x32_bf16 v[80:83], v[152:155], v[208:211], v[80:83]
    v_mfma_f32_16x16x32_bf16 v[84:87], v[152:155], v[212:215], v[84:87]
    s_waitcnt lgkmcnt(0)
    v_mfma_f32_16x16x32_bf16 v[84:87], v[116:119], v[120:123], v[84:87]
    ds_read_b128 v[184:187], v55 offset:320
    v_mfma_f32_16x16x32_bf16 v[80:83], v[112:115], v[120:123], v[80:83]
    ds_read2_b32 v[180:181], v50 offset0:80 offset1:81
    v_mfma_f32_16x16x32_bf16 v[84:87], v[112:115], v[124:127], v[84:87]
    ds_read2_b32 v[182:183], v50 offset0:82 offset1:83
    v_mfma_f32_16x16x32_bf16 v[76:79], v[108:111], v[120:123], v[76:79]
    ds_read_b128 v[188:191], v55 offset:832
    v_mfma_f32_16x16x32_bf16 v[80:83], v[108:111], v[124:127], v[80:83]
    ds_read2_b32 v[176:177], v50 offset0:208 offset1:209
    v_mfma_f32_16x16x32_bf16 v[84:87], v[108:111], v[128:131], v[84:87]
    ds_read2_b32 v[178:179], v50 offset0:210 offset1:211
    v_mfma_f32_16x16x32_bf16 v[72:75], v[104:107], v[120:123], v[72:75]
    ds_read_b128 v[192:195], v55 offset:1344
    v_mfma_f32_16x16x32_bf16 v[76:79], v[104:107], v[124:127], v[76:79]
    ds_read2_b32 v[172:173], v51 offset0:80 offset1:81
    v_mfma_f32_16x16x32_bf16 v[80:83], v[104:107], v[128:131], v[80:83]
    ds_read2_b32 v[174:175], v51 offset0:82 offset1:83
    v_mfma_f32_16x16x32_bf16 v[84:87], v[104:107], v[132:135], v[84:87]
    ds_read_b128 v[196:199], v55 offset:1856
    v_mfma_f32_16x16x32_bf16 v[68:71], v[100:103], v[120:123], v[68:71]
    ds_read2_b32 v[168:169], v51 offset0:208 offset1:209
    v_mfma_f32_16x16x32_bf16 v[72:75], v[100:103], v[124:127], v[72:75]
    ds_read2_b32 v[170:171], v51 offset0:210 offset1:211
    v_mfma_f32_16x16x32_bf16 v[76:79], v[100:103], v[128:131], v[76:79]
    ds_read_b128 v[200:203], v55 offset:2368
    v_mfma_f32_16x16x32_bf16 v[80:83], v[100:103], v[132:135], v[80:83]
    ds_read2_b32 v[164:165], v52 offset0:80 offset1:81
    v_mfma_f32_16x16x32_bf16 v[84:87], v[100:103], v[136:139], v[84:87]
    ds_read2_b32 v[166:167], v52 offset0:82 offset1:83
    v_mfma_f32_16x16x32_bf16 v[64:67], v[96:99], v[120:123], v[64:67]
    ds_read_b128 v[204:207], v55 offset:2880
    v_mfma_f32_16x16x32_bf16 v[68:71], v[96:99], v[124:127], v[68:71]
    ds_read2_b32 v[160:161], v52 offset0:208 offset1:209
    v_mfma_f32_16x16x32_bf16 v[72:75], v[96:99], v[128:131], v[72:75]
    ds_read2_b32 v[162:163], v52 offset0:210 offset1:211
    v_mfma_f32_16x16x32_bf16 v[76:79], v[96:99], v[132:135], v[76:79]
    ds_read_b128 v[208:211], v55 offset:3392
    v_mfma_f32_16x16x32_bf16 v[80:83], v[96:99], v[136:139], v[80:83]
    ds_read2_b32 v[156:157], v53 offset0:80 offset1:81
    v_mfma_f32_16x16x32_bf16 v[84:87], v[96:99], v[140:143], v[84:87]
    ds_read2_b32 v[158:159], v53 offset0:82 offset1:83
    v_mfma_f32_16x16x32_bf16 v[60:63], v[92:95], v[120:123], v[60:63]
    ds_read_b128 v[212:215], v55 offset:3904
    v_mfma_f32_16x16x32_bf16 v[64:67], v[92:95], v[124:127], v[64:67]
    ds_read2_b32 v[152:153], v53 offset0:208 offset1:209
    v_mfma_f32_16x16x32_bf16 v[68:71], v[92:95], v[128:131], v[68:71]
    ds_read2_b32 v[154:155], v53 offset0:210 offset1:211
    v_mfma_f32_16x16x32_bf16 v[72:75], v[92:95], v[132:135], v[72:75]
    v_mfma_f32_16x16x32_bf16 v[76:79], v[92:95], v[136:139], v[76:79]
    v_mfma_f32_16x16x32_bf16 v[80:83], v[92:95], v[140:143], v[80:83]
    v_mfma_f32_16x16x32_bf16 v[84:87], v[92:95], v[144:147], v[84:87]
    v_mfma_f32_16x16x32_bf16 v[56:59], v[88:91], v[120:123], v[56:59]
    v_mfma_f32_16x16x32_bf16 v[60:63], v[88:91], v[124:127], v[60:63]
    v_mfma_f32_16x16x32_bf16 v[64:67], v[88:91], v[128:131], v[64:67]
    v_mfma_f32_16x16x32_bf16 v[68:71], v[88:91], v[132:135], v[68:71]
    v_mfma_f32_16x16x32_bf16 v[72:75], v[88:91], v[136:139], v[72:75]
    v_mfma_f32_16x16x32_bf16 v[76:79], v[88:91], v[140:143], v[76:79]
    v_mfma_f32_16x16x32_bf16 v[80:83], v[88:91], v[144:147], v[80:83]
    v_mfma_f32_16x16x32_bf16 v[84:87], v[88:91], v[148:151], v[84:87]
    s_waitcnt lgkmcnt(0)
    v_mfma_f32_16x16x32_bf16 v[84:87], v[180:183], v[184:187], v[84:87]
    ds_read_b128 v[120:123], v55 offset:384
    v_mfma_f32_16x16x32_bf16 v[80:83], v[176:179], v[184:187], v[80:83]
    ds_read2_b32 v[116:117], v50 offset0:96 offset1:97
    v_mfma_f32_16x16x32_bf16 v[84:87], v[176:179], v[188:191], v[84:87]
    ds_read2_b32 v[118:119], v50 offset0:98 offset1:99
    v_mfma_f32_16x16x32_bf16 v[76:79], v[172:175], v[184:187], v[76:79]
    ds_read_b128 v[124:127], v55 offset:896
    v_mfma_f32_16x16x32_bf16 v[80:83], v[172:175], v[188:191], v[80:83]
    ds_read2_b32 v[112:113], v50 offset0:224 offset1:225
    v_mfma_f32_16x16x32_bf16 v[84:87], v[172:175], v[192:195], v[84:87]
    ds_read2_b32 v[114:115], v50 offset0:226 offset1:227
    v_mfma_f32_16x16x32_bf16 v[72:75], v[168:171], v[184:187], v[72:75]
    ds_read_b128 v[128:131], v55 offset:1408
    v_mfma_f32_16x16x32_bf16 v[76:79], v[168:171], v[188:191], v[76:79]
    ds_read2_b32 v[108:109], v51 offset0:96 offset1:97
    v_mfma_f32_16x16x32_bf16 v[80:83], v[168:171], v[192:195], v[80:83]
    ds_read2_b32 v[110:111], v51 offset0:98 offset1:99
    v_mfma_f32_16x16x32_bf16 v[84:87], v[168:171], v[196:199], v[84:87]
    ds_read_b128 v[132:135], v55 offset:1920
    v_mfma_f32_16x16x32_bf16 v[68:71], v[164:167], v[184:187], v[68:71]
    ds_read2_b32 v[104:105], v51 offset0:224 offset1:225
    v_mfma_f32_16x16x32_bf16 v[72:75], v[164:167], v[188:191], v[72:75]
    ds_read2_b32 v[106:107], v51 offset0:226 offset1:227
    v_mfma_f32_16x16x32_bf16 v[76:79], v[164:167], v[192:195], v[76:79]
    ds_read_b128 v[136:139], v55 offset:2432
    v_mfma_f32_16x16x32_bf16 v[80:83], v[164:167], v[196:199], v[80:83]
    ds_read2_b32 v[100:101], v52 offset0:96 offset1:97
    v_mfma_f32_16x16x32_bf16 v[84:87], v[164:167], v[200:203], v[84:87]
    ds_read2_b32 v[102:103], v52 offset0:98 offset1:99
    v_mfma_f32_16x16x32_bf16 v[64:67], v[160:163], v[184:187], v[64:67]
    ds_read_b128 v[140:143], v55 offset:2944
    v_mfma_f32_16x16x32_bf16 v[68:71], v[160:163], v[188:191], v[68:71]
    ds_read2_b32 v[96:97], v52 offset0:224 offset1:225
    v_mfma_f32_16x16x32_bf16 v[72:75], v[160:163], v[192:195], v[72:75]
    ds_read2_b32 v[98:99], v52 offset0:226 offset1:227
    v_mfma_f32_16x16x32_bf16 v[76:79], v[160:163], v[196:199], v[76:79]
    ds_read_b128 v[144:147], v55 offset:3456
    v_mfma_f32_16x16x32_bf16 v[80:83], v[160:163], v[200:203], v[80:83]
    ds_read2_b32 v[92:93], v53 offset0:96 offset1:97
    v_mfma_f32_16x16x32_bf16 v[84:87], v[160:163], v[204:207], v[84:87]
    ds_read2_b32 v[94:95], v53 offset0:98 offset1:99
    v_mfma_f32_16x16x32_bf16 v[60:63], v[156:159], v[184:187], v[60:63]
    ds_read_b128 v[148:151], v55 offset:3968
    v_mfma_f32_16x16x32_bf16 v[64:67], v[156:159], v[188:191], v[64:67]
    ds_read2_b32 v[88:89], v53 offset0:224 offset1:225
    v_mfma_f32_16x16x32_bf16 v[68:71], v[156:159], v[192:195], v[68:71]
    ds_read2_b32 v[90:91], v53 offset0:226 offset1:227
    v_mfma_f32_16x16x32_bf16 v[72:75], v[156:159], v[196:199], v[72:75]
    v_mfma_f32_16x16x32_bf16 v[76:79], v[156:159], v[200:203], v[76:79]
    v_mfma_f32_16x16x32_bf16 v[80:83], v[156:159], v[204:207], v[80:83]
    v_mfma_f32_16x16x32_bf16 v[84:87], v[156:159], v[208:211], v[84:87]
    v_mfma_f32_16x16x32_bf16 v[56:59], v[152:155], v[184:187], v[56:59]
    v_mfma_f32_16x16x32_bf16 v[60:63], v[152:155], v[188:191], v[60:63]
    v_mfma_f32_16x16x32_bf16 v[64:67], v[152:155], v[192:195], v[64:67]
    v_mfma_f32_16x16x32_bf16 v[68:71], v[152:155], v[196:199], v[68:71]
    v_mfma_f32_16x16x32_bf16 v[72:75], v[152:155], v[200:203], v[72:75]
    v_mfma_f32_16x16x32_bf16 v[76:79], v[152:155], v[204:207], v[76:79]
    v_mfma_f32_16x16x32_bf16 v[80:83], v[152:155], v[208:211], v[80:83]
    v_mfma_f32_16x16x32_bf16 v[84:87], v[152:155], v[212:215], v[84:87]
    s_waitcnt lgkmcnt(0)
    v_mfma_f32_16x16x32_bf16 v[84:87], v[116:119], v[120:123], v[84:87]
    ds_read_b128 v[184:187], v55 offset:448
    v_mfma_f32_16x16x32_bf16 v[80:83], v[112:115], v[120:123], v[80:83]
    ds_read2_b32 v[180:181], v50 offset0:112 offset1:113
    v_mfma_f32_16x16x32_bf16 v[84:87], v[112:115], v[124:127], v[84:87]
    ds_read2_b32 v[182:183], v50 offset0:114 offset1:115
    v_mfma_f32_16x16x32_bf16 v[76:79], v[108:111], v[120:123], v[76:79]
    ds_read_b128 v[188:191], v55 offset:960
    v_mfma_f32_16x16x32_bf16 v[80:83], v[108:111], v[124:127], v[80:83]
    ds_read2_b32 v[176:177], v50 offset0:240 offset1:241
    v_mfma_f32_16x16x32_bf16 v[84:87], v[108:111], v[128:131], v[84:87]
    ds_read2_b32 v[178:179], v50 offset0:242 offset1:243
    v_mfma_f32_16x16x32_bf16 v[72:75], v[104:107], v[120:123], v[72:75]
    ds_read_b128 v[192:195], v55 offset:1472
    v_mfma_f32_16x16x32_bf16 v[76:79], v[104:107], v[124:127], v[76:79]
    ds_read2_b32 v[172:173], v51 offset0:112 offset1:113
    v_mfma_f32_16x16x32_bf16 v[80:83], v[104:107], v[128:131], v[80:83]
    ds_read2_b32 v[174:175], v51 offset0:114 offset1:115
    v_mfma_f32_16x16x32_bf16 v[84:87], v[104:107], v[132:135], v[84:87]
    ds_read_b128 v[196:199], v55 offset:1984
    v_mfma_f32_16x16x32_bf16 v[68:71], v[100:103], v[120:123], v[68:71]
    ds_read2_b32 v[168:169], v51 offset0:240 offset1:241
    v_mfma_f32_16x16x32_bf16 v[72:75], v[100:103], v[124:127], v[72:75]
    ds_read2_b32 v[170:171], v51 offset0:242 offset1:243
    v_mfma_f32_16x16x32_bf16 v[76:79], v[100:103], v[128:131], v[76:79]
    ds_read_b128 v[200:203], v55 offset:2496
    v_mfma_f32_16x16x32_bf16 v[80:83], v[100:103], v[132:135], v[80:83]
    ds_read2_b32 v[164:165], v52 offset0:112 offset1:113
    v_mfma_f32_16x16x32_bf16 v[84:87], v[100:103], v[136:139], v[84:87]
    ds_read2_b32 v[166:167], v52 offset0:114 offset1:115
    v_mfma_f32_16x16x32_bf16 v[64:67], v[96:99], v[120:123], v[64:67]
    ds_read_b128 v[204:207], v55 offset:3008
    v_mfma_f32_16x16x32_bf16 v[68:71], v[96:99], v[124:127], v[68:71]
    ds_read2_b32 v[160:161], v52 offset0:240 offset1:241
    v_mfma_f32_16x16x32_bf16 v[72:75], v[96:99], v[128:131], v[72:75]
    ds_read2_b32 v[162:163], v52 offset0:242 offset1:243
    v_mfma_f32_16x16x32_bf16 v[76:79], v[96:99], v[132:135], v[76:79]
    ds_read_b128 v[208:211], v55 offset:3520
    v_mfma_f32_16x16x32_bf16 v[80:83], v[96:99], v[136:139], v[80:83]
    ds_read2_b32 v[156:157], v53 offset0:112 offset1:113
    v_mfma_f32_16x16x32_bf16 v[84:87], v[96:99], v[140:143], v[84:87]
    ds_read2_b32 v[158:159], v53 offset0:114 offset1:115
    v_mfma_f32_16x16x32_bf16 v[60:63], v[92:95], v[120:123], v[60:63]
    ds_read_b128 v[212:215], v55 offset:4032
    v_mfma_f32_16x16x32_bf16 v[64:67], v[92:95], v[124:127], v[64:67]
    ds_read2_b32 v[152:153], v53 offset0:240 offset1:241
    v_mfma_f32_16x16x32_bf16 v[68:71], v[92:95], v[128:131], v[68:71]
    ds_read2_b32 v[154:155], v53 offset0:242 offset1:243
    v_mfma_f32_16x16x32_bf16 v[72:75], v[92:95], v[132:135], v[72:75]
    v_mfma_f32_16x16x32_bf16 v[76:79], v[92:95], v[136:139], v[76:79]
    v_mfma_f32_16x16x32_bf16 v[80:83], v[92:95], v[140:143], v[80:83]
    v_mfma_f32_16x16x32_bf16 v[84:87], v[92:95], v[144:147], v[84:87]
    v_mfma_f32_16x16x32_bf16 v[56:59], v[88:91], v[120:123], v[56:59]
    v_mfma_f32_16x16x32_bf16 v[60:63], v[88:91], v[124:127], v[60:63]
    v_mfma_f32_16x16x32_bf16 v[64:67], v[88:91], v[128:131], v[64:67]
    v_mfma_f32_16x16x32_bf16 v[68:71], v[88:91], v[132:135], v[68:71]
    v_mfma_f32_16x16x32_bf16 v[72:75], v[88:91], v[136:139], v[72:75]
    v_mfma_f32_16x16x32_bf16 v[76:79], v[88:91], v[140:143], v[76:79]
    v_mfma_f32_16x16x32_bf16 v[80:83], v[88:91], v[144:147], v[80:83]
    v_mfma_f32_16x16x32_bf16 v[84:87], v[88:91], v[148:151], v[84:87]
    s_waitcnt lgkmcnt(0)
    v_mfma_f32_16x16x32_bf16 v[84:87], v[180:183], v[184:187], v[84:87]
    v_mfma_f32_16x16x32_bf16 v[80:83], v[176:179], v[184:187], v[80:83]
    v_mfma_f32_16x16x32_bf16 v[84:87], v[176:179], v[188:191], v[84:87]
    v_mfma_f32_16x16x32_bf16 v[76:79], v[172:175], v[184:187], v[76:79]
    v_mfma_f32_16x16x32_bf16 v[80:83], v[172:175], v[188:191], v[80:83]
    v_mfma_f32_16x16x32_bf16 v[84:87], v[172:175], v[192:195], v[84:87]
    v_mfma_f32_16x16x32_bf16 v[72:75], v[168:171], v[184:187], v[72:75]
    v_mfma_f32_16x16x32_bf16 v[76:79], v[168:171], v[188:191], v[76:79]
    v_mfma_f32_16x16x32_bf16 v[80:83], v[168:171], v[192:195], v[80:83]
    v_mfma_f32_16x16x32_bf16 v[84:87], v[168:171], v[196:199], v[84:87]
    v_mfma_f32_16x16x32_bf16 v[68:71], v[164:167], v[184:187], v[68:71]
    v_mfma_f32_16x16x32_bf16 v[72:75], v[164:167], v[188:191], v[72:75]
    v_mfma_f32_16x16x32_bf16 v[76:79], v[164:167], v[192:195], v[76:79]
    v_mfma_f32_16x16x32_bf16 v[80:83], v[164:167], v[196:199], v[80:83]
    v_mfma_f32_16x16x32_bf16 v[84:87], v[164:167], v[200:203], v[84:87]
    v_mfma_f32_16x16x32_bf16 v[64:67], v[160:163], v[184:187], v[64:67]
    v_mfma_f32_16x16x32_bf16 v[68:71], v[160:163], v[188:191], v[68:71]
    v_mfma_f32_16x16x32_bf16 v[72:75], v[160:163], v[192:195], v[72:75]
    v_mfma_f32_16x16x32_bf16 v[76:79], v[160:163], v[196:199], v[76:79]
    v_mfma_f32_16x16x32_bf16 v[80:83], v[160:163], v[200:203], v[80:83]
    v_mfma_f32_16x16x32_bf16 v[84:87], v[160:163], v[204:207], v[84:87]
    v_mfma_f32_16x16x32_bf16 v[60:63], v[156:159], v[184:187], v[60:63]
    v_mfma_f32_16x16x32_bf16 v[64:67], v[156:159], v[188:191], v[64:67]
    v_mfma_f32_16x16x32_bf16 v[68:71], v[156:159], v[192:195], v[68:71]
    v_mfma_f32_16x16x32_bf16 v[72:75], v[156:159], v[196:199], v[72:75]
    v_mfma_f32_16x16x32_bf16 v[76:79], v[156:159], v[200:203], v[76:79]
    v_mfma_f32_16x16x32_bf16 v[80:83], v[156:159], v[204:207], v[80:83]
    v_mfma_f32_16x16x32_bf16 v[84:87], v[156:159], v[208:211], v[84:87]
    v_mfma_f32_16x16x32_bf16 v[56:59], v[152:155], v[184:187], v[56:59]
    v_mfma_f32_16x16x32_bf16 v[60:63], v[152:155], v[188:191], v[60:63]
    v_mfma_f32_16x16x32_bf16 v[64:67], v[152:155], v[192:195], v[64:67]
    v_mfma_f32_16x16x32_bf16 v[68:71], v[152:155], v[196:199], v[68:71]
    v_mfma_f32_16x16x32_bf16 v[72:75], v[152:155], v[200:203], v[72:75]
    v_mfma_f32_16x16x32_bf16 v[76:79], v[152:155], v[204:207], v[76:79]
    v_mfma_f32_16x16x32_bf16 v[80:83], v[152:155], v[208:211], v[80:83]
    v_mfma_f32_16x16x32_bf16 v[84:87], v[152:155], v[212:215], v[84:87]
    s_waitcnt lgkmcnt(0)
    s_waitcnt vmcnt(0)
    v_add_u32 v7, s34, v6
    ds_read_b64 v[24:25], v7 offset:0
    ds_read_b64 v[26:27], v7 offset:512
    ds_read_b64 v[28:29], v7 offset:1024
    ds_read_b64 v[30:31], v7 offset:1536
    ds_read_b64 v[32:33], v7 offset:2048
    ds_read_b64 v[34:35], v7 offset:2560
    ds_read_b64 v[36:37], v7 offset:3072
    ds_read_b64 v[38:39], v7 offset:3584
    v_add_u32 v7, s30, v6
    ds_read_b64 v[88:89], v7 offset:512
    ds_read_b64 v[90:91], v7 offset:1024
    ds_read_b64 v[92:93], v7 offset:1536
    ds_read_b64 v[94:95], v7 offset:2048
    ds_read_b64 v[96:97], v7 offset:2560
    ds_read_b64 v[98:99], v7 offset:3072
    ds_read_b64 v[100:101], v7 offset:3584
    ds_read_b64 v[102:103], v7 offset:4096
    s_mul_i32 s31, s3, 4160
    s_add_u32 s31, s31, 76544
    v_add_u32 v8, s31, v6
    s_waitcnt vmcnt(0) lgkmcnt(0)
    v_lshlrev_b32 v10, 16, v88
    v_and_b32 v11, 0xffff0000, v88
    v_lshlrev_b32 v12, 16, v24
    v_and_b32 v13, 0xffff0000, v24
    v_fma_f32 v10, v10, v43, v56
    v_fma_f32 v11, v11, v43, v57
    v_fma_f32 v10, v10, v42, v12
    v_fma_f32 v11, v11, v42, v13
    v_cvt_pk_bf16_f32 v14, v10, v11
    v_lshlrev_b32 v10, 16, v89
    v_and_b32 v11, 0xffff0000, v89
    v_lshlrev_b32 v12, 16, v25
    v_and_b32 v13, 0xffff0000, v25
    v_fma_f32 v10, v10, v43, v58
    v_fma_f32 v11, v11, v43, v59
    v_fma_f32 v10, v10, v42, v12
    v_fma_f32 v11, v11, v42, v13
    v_cvt_pk_bf16_f32 v15, v10, v11
    ds_write_b64 v8, v[14:15] offset:0
    v_lshlrev_b32 v10, 16, v90
    v_and_b32 v11, 0xffff0000, v90
    v_lshlrev_b32 v12, 16, v26
    v_and_b32 v13, 0xffff0000, v26
    v_fma_f32 v10, v10, v43, v60
    v_fma_f32 v11, v11, v43, v61
    v_fma_f32 v10, v10, v42, v12
    v_fma_f32 v11, v11, v42, v13
    v_cvt_pk_bf16_f32 v14, v10, v11
    v_lshlrev_b32 v10, 16, v91
    v_and_b32 v11, 0xffff0000, v91
    v_lshlrev_b32 v12, 16, v27
    v_and_b32 v13, 0xffff0000, v27
    v_fma_f32 v10, v10, v43, v62
    v_fma_f32 v11, v11, v43, v63
    v_fma_f32 v10, v10, v42, v12
    v_fma_f32 v11, v11, v42, v13
    v_cvt_pk_bf16_f32 v15, v10, v11
    ds_write_b64 v8, v[14:15] offset:512
    v_lshlrev_b32 v10, 16, v92
    v_and_b32 v11, 0xffff0000, v92
    v_lshlrev_b32 v12, 16, v28
    v_and_b32 v13, 0xffff0000, v28
    v_fma_f32 v10, v10, v43, v64
    v_fma_f32 v11, v11, v43, v65
    v_fma_f32 v10, v10, v42, v12
    v_fma_f32 v11, v11, v42, v13
    v_cvt_pk_bf16_f32 v14, v10, v11
    v_lshlrev_b32 v10, 16, v93
    v_and_b32 v11, 0xffff0000, v93
    v_lshlrev_b32 v12, 16, v29
    v_and_b32 v13, 0xffff0000, v29
    v_fma_f32 v10, v10, v43, v66
    v_fma_f32 v11, v11, v43, v67
    v_fma_f32 v10, v10, v42, v12
    v_fma_f32 v11, v11, v42, v13
    v_cvt_pk_bf16_f32 v15, v10, v11
    ds_write_b64 v8, v[14:15] offset:1024
    v_lshlrev_b32 v10, 16, v94
    v_and_b32 v11, 0xffff0000, v94
    v_lshlrev_b32 v12, 16, v30
    v_and_b32 v13, 0xffff0000, v30
    v_fma_f32 v10, v10, v43, v68
    v_fma_f32 v11, v11, v43, v69
    v_fma_f32 v10, v10, v42, v12
    v_fma_f32 v11, v11, v42, v13
    v_cvt_pk_bf16_f32 v14, v10, v11
    v_lshlrev_b32 v10, 16, v95
    v_and_b32 v11, 0xffff0000, v95
    v_lshlrev_b32 v12, 16, v31
    v_and_b32 v13, 0xffff0000, v31
    v_fma_f32 v10, v10, v43, v70
    v_fma_f32 v11, v11, v43, v71
    v_fma_f32 v10, v10, v42, v12
    v_fma_f32 v11, v11, v42, v13
    v_cvt_pk_bf16_f32 v15, v10, v11
    ds_write_b64 v8, v[14:15] offset:1536
    v_lshlrev_b32 v10, 16, v96
    v_and_b32 v11, 0xffff0000, v96
    v_lshlrev_b32 v12, 16, v32
    v_and_b32 v13, 0xffff0000, v32
    v_fma_f32 v10, v10, v43, v72
    v_fma_f32 v11, v11, v43, v73
    v_fma_f32 v10, v10, v42, v12
    v_fma_f32 v11, v11, v42, v13
    v_cvt_pk_bf16_f32 v14, v10, v11
    v_lshlrev_b32 v10, 16, v97
    v_and_b32 v11, 0xffff0000, v97
    v_lshlrev_b32 v12, 16, v33
    v_and_b32 v13, 0xffff0000, v33
    v_fma_f32 v10, v10, v43, v74
    v_fma_f32 v11, v11, v43, v75
    v_fma_f32 v10, v10, v42, v12
    v_fma_f32 v11, v11, v42, v13
    v_cvt_pk_bf16_f32 v15, v10, v11
    ds_write_b64 v8, v[14:15] offset:2048
    v_lshlrev_b32 v10, 16, v98
    v_and_b32 v11, 0xffff0000, v98
    v_lshlrev_b32 v12, 16, v34
    v_and_b32 v13, 0xffff0000, v34
    v_fma_f32 v10, v10, v43, v76
    v_fma_f32 v11, v11, v43, v77
    v_fma_f32 v10, v10, v42, v12
    v_fma_f32 v11, v11, v42, v13
    v_cvt_pk_bf16_f32 v14, v10, v11
    v_lshlrev_b32 v10, 16, v99
    v_and_b32 v11, 0xffff0000, v99
    v_lshlrev_b32 v12, 16, v35
    v_and_b32 v13, 0xffff0000, v35
    v_fma_f32 v10, v10, v43, v78
    v_fma_f32 v11, v11, v43, v79
    v_fma_f32 v10, v10, v42, v12
    v_fma_f32 v11, v11, v42, v13
    v_cvt_pk_bf16_f32 v15, v10, v11
    ds_write_b64 v8, v[14:15] offset:2560
    v_lshlrev_b32 v10, 16, v100
    v_and_b32 v11, 0xffff0000, v100
    v_lshlrev_b32 v12, 16, v36
    v_and_b32 v13, 0xffff0000, v36
    v_fma_f32 v10, v10, v43, v80
    v_fma_f32 v11, v11, v43, v81
    v_fma_f32 v10, v10, v42, v12
    v_fma_f32 v11, v11, v42, v13
    v_cvt_pk_bf16_f32 v14, v10, v11
    v_lshlrev_b32 v10, 16, v101
    v_and_b32 v11, 0xffff0000, v101
    v_lshlrev_b32 v12, 16, v37
    v_and_b32 v13, 0xffff0000, v37
    v_fma_f32 v10, v10, v43, v82
    v_fma_f32 v11, v11, v43, v83
    v_fma_f32 v10, v10, v42, v12
    v_fma_f32 v11, v11, v42, v13
    v_cvt_pk_bf16_f32 v15, v10, v11
    ds_write_b64 v8, v[14:15] offset:3072
    v_lshlrev_b32 v10, 16, v102
    v_and_b32 v11, 0xffff0000, v102
    v_lshlrev_b32 v12, 16, v38
    v_and_b32 v13, 0xffff0000, v38
    v_fma_f32 v10, v10, v43, v84
    v_fma_f32 v11, v11, v43, v85
    v_fma_f32 v10, v10, v42, v12
    v_fma_f32 v11, v11, v42, v13
    v_cvt_pk_bf16_f32 v14, v10, v11
    v_lshlrev_b32 v10, 16, v103
    v_and_b32 v11, 0xffff0000, v103
    v_lshlrev_b32 v12, 16, v39
    v_and_b32 v13, 0xffff0000, v39
    v_fma_f32 v10, v10, v43, v86
    v_fma_f32 v11, v11, v43, v87
    v_fma_f32 v10, v10, v42, v12
    v_fma_f32 v11, v11, v42, v13
    v_cvt_pk_bf16_f32 v15, v10, v11
    ds_write_b64 v8, v[14:15] offset:3584
    v_lshrrev_b32 v9, 2, v4
    v_and_b32 v10, 3, v4
    v_mul_u32_u24 v9, 4160, v9
    v_lshl_add_u32 v9, v10, 3, v9
    v_lshl_add_u32 v9, v5, 5, v9
    s_lshl_b32 s31, s3, 10
    s_add_u32 s31, s31, 76544
    v_add_u32 v9, s31, v9
    s_add_u32 s8, s4, 10485760
    s_addc_u32 s9, s5, 0
    s_mov_b32 s10, 2652160
    s_mov_b32 s11, 0x00020000
    v_lshlrev_b32 v10, 4, v1
    s_lshr_b32 s21, s58, 3
    s_lshl_b32 s21, s21, 2
    s_and_b32 s22, s58, 3
    s_add_u32 s21, s21, s22
    s_mul_i32 s21, s21, 33152
    s_lshl_b32 s22, s58, 1
    s_and_b32 s22, s22, 8
    s_add_u32 s21, s21, s22
    s_lshl_b32 s22, s3, 13
    s_add_u32 s21, s21, s22
    s_waitcnt lgkmcnt(0)
    s_barrier
    ds_read_b64_tr_b16 v[16:17], v9 offset:0
    ds_read_b64_tr_b16 v[18:19], v9 offset:128
    ds_read_b64_tr_b16 v[20:21], v9 offset:256
    ds_read_b64_tr_b16 v[22:23], v9 offset:384
    ds_read_b64_tr_b16 v[24:25], v9 offset:512
    ds_read_b64_tr_b16 v[26:27], v9 offset:640
    ds_read_b64_tr_b16 v[28:29], v9 offset:768
    ds_read_b64_tr_b16 v[30:31], v9 offset:896
    s_waitcnt lgkmcnt(7)
    buffer_store_dwordx2 v[16:17], v10, s[8:11], s21 offen offset:0
    s_waitcnt lgkmcnt(6)
    buffer_store_dwordx2 v[18:19], v10, s[8:11], s21 offen offset:1024
    s_waitcnt lgkmcnt(5)
    buffer_store_dwordx2 v[20:21], v10, s[8:11], s21 offen offset:2048
    s_waitcnt lgkmcnt(4)
    buffer_store_dwordx2 v[22:23], v10, s[8:11], s21 offen offset:3072
    s_add_u32 s21, s21, 4096
    s_waitcnt lgkmcnt(3)
    buffer_store_dwordx2 v[24:25], v10, s[8:11], s21 offen offset:0
    s_waitcnt lgkmcnt(2)
    buffer_store_dwordx2 v[26:27], v10, s[8:11], s21 offen offset:1024
    s_waitcnt lgkmcnt(1)
    buffer_store_dwordx2 v[28:29], v10, s[8:11], s21 offen offset:2048
    s_waitcnt lgkmcnt(0)
    buffer_store_dwordx2 v[30:31], v10, s[8:11], s21 offen offset:3072
    s_endpgm
K2_oth:
    s_cmp_ge_u32 s3, 4
    s_cbranch_scc1 K2_end
    s_cmp_lt_u32 s2, 197
    s_cbranch_scc1 K2_cs
    s_waitcnt lgkmcnt(0)
    s_load_dwordx2 s[6:7], s[0:1], 120
    s_load_dwordx2 s[8:9], s[0:1], 112
    s_sub_u32 s22, s2, 197
    s_add_u32 s22, s22, 30
    v_lshrrev_b32 v1, 3, v0
    v_and_b32 v2, 7, v0
    v_mul_u32_u24 v3, 20, v1
    v_mul_u32_u24 v4, 7680, v3
    v_lshl_add_u32 v4, v2, 4, v4
    s_lshl_b32 s24, s22, 7
    v_add_u32 v4, s24, v4
    v_lshlrev_b32 v3, 1, v3
    s_waitcnt lgkmcnt(0)
    s_mov_b32 s12, s6
    s_mov_b32 s13, s7
    s_mov_b32 s14, 4915200
    s_mov_b32 s15, 0x00020000
    s_mov_b32 s16, s8
    s_mov_b32 s17, s9
    s_mov_b32 s18, 1280
    s_mov_b32 s19, 0x00020000
    buffer_load_dwordx4 v[8:11], v3, s[16:19], 0 offen
    buffer_load_dwordx4 v[12:15], v3, s[16:19], 0 offen offset:16
    buffer_load_dwordx2 v[16:17], v3, s[16:19], 0 offen offset:32
    s_mov_b32 s25, 0
    buffer_load_dwordx4 v[48:51], v4, s[12:15], s25 offen
    s_mov_b32 s25, 7680
    buffer_load_dwordx4 v[52:55], v4, s[12:15], s25 offen
    s_mov_b32 s25, 15360
    buffer_load_dwordx4 v[56:59], v4, s[12:15], s25 offen
    s_mov_b32 s25, 23040
    buffer_load_dwordx4 v[60:63], v4, s[12:15], s25 offen
    s_mov_b32 s25, 30720
    buffer_load_dwordx4 v[64:67], v4, s[12:15], s25 offen
    s_mov_b32 s25, 38400
    buffer_load_dwordx4 v[68:71], v4, s[12:15], s25 offen
    s_mov_b32 s25, 46080
    buffer_load_dwordx4 v[72:75], v4, s[12:15], s25 offen
    s_mov_b32 s25, 53760
    buffer_load_dwordx4 v[76:79], v4, s[12:15], s25 offen
    s_mov_b32 s25, 61440
    buffer_load_dwordx4 v[80:83], v4, s[12:15], s25 offen
    s_mov_b32 s25, 69120
    buffer_load_dwordx4 v[84:87], v4, s[12:15], s25 offen
    s_mov_b32 s25, 76800
    buffer_load_dwordx4 v[88:91], v4, s[12:15], s25 offen
    s_mov_b32 s25, 84480
    buffer_load_dwordx4 v[92:95], v4, s[12:15], s25 offen
    s_mov_b32 s25, 92160
    buffer_load_dwordx4 v[96:99], v4, s[12:15], s25 offen
    s_mov_b32 s25, 99840
    buffer_load_dwordx4 v[100:103], v4, s[12:15], s25 offen
    s_mov_b32 s25, 107520
    buffer_load_dwordx4 v[104:107], v4, s[12:15], s25 offen
    s_mov_b32 s25, 115200
    buffer_load_dwordx4 v[108:111], v4, s[12:15], s25 offen
    s_mov_b32 s25, 122880
    buffer_load_dwordx4 v[112:115], v4, s[12:15], s25 offen
    s_mov_b32 s25, 130560
    buffer_load_dwordx4 v[116:119], v4, s[12:15], s25 offen
    s_mov_b32 s25, 138240
    buffer_load_dwordx4 v[120:123], v4, s[12:15], s25 offen
    s_mov_b32 s25, 145920
    buffer_load_dwordx4 v[124:127], v4, s[12:15], s25 offen
    v_mov_b32 v40, 0
    v_mov_b32 v41, 0
    v_mov_b32 v42, 0
    v_mov_b32 v43, 0
    v_mov_b32 v44, 0
    v_mov_b32 v45, 0
    v_mov_b32 v46, 0
    v_mov_b32 v47, 0
    s_waitcnt vmcnt(20)
    v_lshlrev_b32 v128, 16, v8
    v_and_b32 v129, 0xffff0000, v8
    v_lshlrev_b32 v130, 16, v9
    v_and_b32 v131, 0xffff0000, v9
    v_lshlrev_b32 v132, 16, v10
    v_and_b32 v133, 0xffff0000, v10
    v_lshlrev_b32 v134, 16, v11
    v_and_b32 v135, 0xffff0000, v11
    v_lshlrev_b32 v136, 16, v12
    v_and_b32 v137, 0xffff0000, v12
    v_lshlrev_b32 v138, 16, v13
    v_and_b32 v139, 0xffff0000, v13
    v_lshlrev_b32 v140, 16, v14
    v_and_b32 v141, 0xffff0000, v14
    v_lshlrev_b32 v142, 16, v15
    v_and_b32 v143, 0xffff0000, v15
    v_lshlrev_b32 v144, 16, v16
    v_and_b32 v145, 0xffff0000, v16
    v_lshlrev_b32 v146, 16, v17
    v_and_b32 v147, 0xffff0000, v17
    v_mul_f32 v148, -1.4426950408889634, v128
    v_mul_f32 v149, -1.4426950408889634, v129
    v_mul_f32 v150, -1.4426950408889634, v130
    v_mul_f32 v151, -1.4426950408889634, v131
    v_mul_f32 v152, -1.4426950408889634, v132
    v_mul_f32 v153, -1.4426950408889634, v133
    v_mul_f32 v154, -1.4426950408889634, v134
    v_mul_f32 v155, -1.4426950408889634, v135
    v_mul_f32 v156, -1.4426950408889634, v136
    v_mul_f32 v157, -1.4426950408889634, v137
    v_mul_f32 v158, -1.4426950408889634, v138
    v_mul_f32 v159, -1.4426950408889634, v139
    v_mul_f32 v160, -1.4426950408889634, v140
    v_mul_f32 v161, -1.4426950408889634, v141
    v_mul_f32 v162, -1.4426950408889634, v142
    v_mul_f32 v163, -1.4426950408889634, v143
    v_mul_f32 v164, -1.4426950408889634, v144
    v_mul_f32 v165, -1.4426950408889634, v145
    v_mul_f32 v166, -1.4426950408889634, v146
    v_mul_f32 v167, -1.4426950408889634, v147
    v_exp_f32 v148, v148
    v_exp_f32 v149, v149
    v_exp_f32 v150, v150
    v_exp_f32 v151, v151
    v_exp_f32 v152, v152
    v_exp_f32 v153, v153
    v_exp_f32 v154, v154
    v_exp_f32 v155, v155
    v_exp_f32 v156, v156
    v_exp_f32 v157, v157
    v_exp_f32 v158, v158
    v_exp_f32 v159, v159
    v_exp_f32 v160, v160
    v_exp_f32 v161, v161
    v_exp_f32 v162, v162
    v_exp_f32 v163, v163
    v_exp_f32 v164, v164
    v_exp_f32 v165, v165
    v_exp_f32 v166, v166
    v_exp_f32 v167, v167
    v_add_f32 v148, 1.0, v148
    v_add_f32 v149, 1.0, v149
    v_add_f32 v150, 1.0, v150
    v_add_f32 v151, 1.0, v151
    v_add_f32 v152, 1.0, v152
    v_add_f32 v153, 1.0, v153
    v_add_f32 v154, 1.0, v154
    v_add_f32 v155, 1.0, v155
    v_add_f32 v156, 1.0, v156
    v_add_f32 v157, 1.0, v157
    v_add_f32 v158, 1.0, v158
    v_add_f32 v159, 1.0, v159
    v_add_f32 v160, 1.0, v160
    v_add_f32 v161, 1.0, v161
    v_add_f32 v162, 1.0, v162
    v_add_f32 v163, 1.0, v163
    v_add_f32 v164, 1.0, v164
    v_add_f32 v165, 1.0, v165
    v_add_f32 v166, 1.0, v166
    v_add_f32 v167, 1.0, v167
    v_rcp_f32 v148, v148
    v_rcp_f32 v149, v149
    v_rcp_f32 v150, v150
    v_rcp_f32 v151, v151
    v_rcp_f32 v152, v152
    v_rcp_f32 v153, v153
    v_rcp_f32 v154, v154
    v_rcp_f32 v155, v155
    v_rcp_f32 v156, v156
    v_rcp_f32 v157, v157
    v_rcp_f32 v158, v158
    v_rcp_f32 v159, v159
    v_rcp_f32 v160, v160
    v_rcp_f32 v161, v161
    v_rcp_f32 v162, v162
    v_rcp_f32 v163, v163
    v_rcp_f32 v164, v164
    v_rcp_f32 v165, v165
    v_rcp_f32 v166, v166
    v_rcp_f32 v167, v167
    v_mul_f32 v148, v148, v128
    v_mul_f32 v149, v149, v129
    v_mul_f32 v150, v150, v130
    v_mul_f32 v151, v151, v131
    v_mul_f32 v152, v152, v132
    v_mul_f32 v153, v153, v133
    v_mul_f32 v154, v154, v134
    v_mul_f32 v155, v155, v135
    v_mul_f32 v156, v156, v136
    v_mul_f32 v157, v157, v137
    v_mul_f32 v158, v158, v138
    v_mul_f32 v159, v159, v139
    v_mul_f32 v160, v160, v140
    v_mul_f32 v161, v161, v141
    v_mul_f32 v162, v162, v142
    v_mul_f32 v163, v163, v143
    v_mul_f32 v164, v164, v144
    v_mul_f32 v165, v165, v145
    v_mul_f32 v166, v166, v146
    v_mul_f32 v167, v167, v147
    v_cvt_pk_bf16_f32 v148, v148, v148
    v_cvt_pk_bf16_f32 v149, v149, v149
    v_cvt_pk_bf16_f32 v150, v150, v150
    v_cvt_pk_bf16_f32 v151, v151, v151
    v_cvt_pk_bf16_f32 v152, v152, v152
    v_cvt_pk_bf16_f32 v153, v153, v153
    v_cvt_pk_bf16_f32 v154, v154, v154
    v_cvt_pk_bf16_f32 v155, v155, v155
    v_cvt_pk_bf16_f32 v156, v156, v156
    v_cvt_pk_bf16_f32 v157, v157, v157
    v_cvt_pk_bf16_f32 v158, v158, v158
    v_cvt_pk_bf16_f32 v159, v159, v159
    v_cvt_pk_bf16_f32 v160, v160, v160
    v_cvt_pk_bf16_f32 v161, v161, v161
    v_cvt_pk_bf16_f32 v162, v162, v162
    v_cvt_pk_bf16_f32 v163, v163, v163
    v_cvt_pk_bf16_f32 v164, v164, v164
    v_cvt_pk_bf16_f32 v165, v165, v165
    v_cvt_pk_bf16_f32 v166, v166, v166
    v_cvt_pk_bf16_f32 v167, v167, v167
    v_lshlrev_b32 v128, 16, v148
    v_lshlrev_b32 v129, 16, v149
    v_lshlrev_b32 v130, 16, v150
    v_lshlrev_b32 v131, 16, v151
    v_lshlrev_b32 v132, 16, v152
    v_lshlrev_b32 v133, 16, v153
    v_lshlrev_b32 v134, 16, v154
    v_lshlrev_b32 v135, 16, v155
    v_lshlrev_b32 v136, 16, v156
    v_lshlrev_b32 v137, 16, v157
    v_lshlrev_b32 v138, 16, v158
    v_lshlrev_b32 v139, 16, v159
    v_lshlrev_b32 v140, 16, v160
    v_lshlrev_b32 v141, 16, v161
    v_lshlrev_b32 v142, 16, v162
    v_lshlrev_b32 v143, 16, v163
    v_lshlrev_b32 v144, 16, v164
    v_lshlrev_b32 v145, 16, v165
    v_lshlrev_b32 v146, 16, v166
    v_lshlrev_b32 v147, 16, v167
    s_waitcnt vmcnt(19)
    v_lshlrev_b32 v14, 16, v48
    v_and_b32 v15, 0xffff0000, v48
    v_fmac_f32 v40, v14, v128
    v_fmac_f32 v41, v15, v128
    v_lshlrev_b32 v14, 16, v49
    v_and_b32 v15, 0xffff0000, v49
    v_fmac_f32 v42, v14, v128
    v_fmac_f32 v43, v15, v128
    v_lshlrev_b32 v14, 16, v50
    v_and_b32 v15, 0xffff0000, v50
    v_fmac_f32 v44, v14, v128
    v_fmac_f32 v45, v15, v128
    v_lshlrev_b32 v14, 16, v51
    v_and_b32 v15, 0xffff0000, v51
    v_fmac_f32 v46, v14, v128
    v_fmac_f32 v47, v15, v128
    s_waitcnt vmcnt(18)
    v_lshlrev_b32 v14, 16, v52
    v_and_b32 v15, 0xffff0000, v52
    v_fmac_f32 v40, v14, v129
    v_fmac_f32 v41, v15, v129
    v_lshlrev_b32 v14, 16, v53
    v_and_b32 v15, 0xffff0000, v53
    v_fmac_f32 v42, v14, v129
    v_fmac_f32 v43, v15, v129
    v_lshlrev_b32 v14, 16, v54
    v_and_b32 v15, 0xffff0000, v54
    v_fmac_f32 v44, v14, v129
    v_fmac_f32 v45, v15, v129
    v_lshlrev_b32 v14, 16, v55
    v_and_b32 v15, 0xffff0000, v55
    v_fmac_f32 v46, v14, v129
    v_fmac_f32 v47, v15, v129
    s_waitcnt vmcnt(17)
    v_lshlrev_b32 v14, 16, v56
    v_and_b32 v15, 0xffff0000, v56
    v_fmac_f32 v40, v14, v130
    v_fmac_f32 v41, v15, v130
    v_lshlrev_b32 v14, 16, v57
    v_and_b32 v15, 0xffff0000, v57
    v_fmac_f32 v42, v14, v130
    v_fmac_f32 v43, v15, v130
    v_lshlrev_b32 v14, 16, v58
    v_and_b32 v15, 0xffff0000, v58
    v_fmac_f32 v44, v14, v130
    v_fmac_f32 v45, v15, v130
    v_lshlrev_b32 v14, 16, v59
    v_and_b32 v15, 0xffff0000, v59
    v_fmac_f32 v46, v14, v130
    v_fmac_f32 v47, v15, v130
    s_waitcnt vmcnt(16)
    v_lshlrev_b32 v14, 16, v60
    v_and_b32 v15, 0xffff0000, v60
    v_fmac_f32 v40, v14, v131
    v_fmac_f32 v41, v15, v131
    v_lshlrev_b32 v14, 16, v61
    v_and_b32 v15, 0xffff0000, v61
    v_fmac_f32 v42, v14, v131
    v_fmac_f32 v43, v15, v131
    v_lshlrev_b32 v14, 16, v62
    v_and_b32 v15, 0xffff0000, v62
    v_fmac_f32 v44, v14, v131
    v_fmac_f32 v45, v15, v131
    v_lshlrev_b32 v14, 16, v63
    v_and_b32 v15, 0xffff0000, v63
    v_fmac_f32 v46, v14, v131
    v_fmac_f32 v47, v15, v131
    s_waitcnt vmcnt(15)
    v_lshlrev_b32 v14, 16, v64
    v_and_b32 v15, 0xffff0000, v64
    v_fmac_f32 v40, v14, v132
    v_fmac_f32 v41, v15, v132
    v_lshlrev_b32 v14, 16, v65
    v_and_b32 v15, 0xffff0000, v65
    v_fmac_f32 v42, v14, v132
    v_fmac_f32 v43, v15, v132
    v_lshlrev_b32 v14, 16, v66
    v_and_b32 v15, 0xffff0000, v66
    v_fmac_f32 v44, v14, v132
    v_fmac_f32 v45, v15, v132
    v_lshlrev_b32 v14, 16, v67
    v_and_b32 v15, 0xffff0000, v67
    v_fmac_f32 v46, v14, v132
    v_fmac_f32 v47, v15, v132
    s_waitcnt vmcnt(14)
    v_lshlrev_b32 v14, 16, v68
    v_and_b32 v15, 0xffff0000, v68
    v_fmac_f32 v40, v14, v133
    v_fmac_f32 v41, v15, v133
    v_lshlrev_b32 v14, 16, v69
    v_and_b32 v15, 0xffff0000, v69
    v_fmac_f32 v42, v14, v133
    v_fmac_f32 v43, v15, v133
    v_lshlrev_b32 v14, 16, v70
    v_and_b32 v15, 0xffff0000, v70
    v_fmac_f32 v44, v14, v133
    v_fmac_f32 v45, v15, v133
    v_lshlrev_b32 v14, 16, v71
    v_and_b32 v15, 0xffff0000, v71
    v_fmac_f32 v46, v14, v133
    v_fmac_f32 v47, v15, v133
    s_waitcnt vmcnt(13)
    v_lshlrev_b32 v14, 16, v72
    v_and_b32 v15, 0xffff0000, v72
    v_fmac_f32 v40, v14, v134
    v_fmac_f32 v41, v15, v134
    v_lshlrev_b32 v14, 16, v73
    v_and_b32 v15, 0xffff0000, v73
    v_fmac_f32 v42, v14, v134
    v_fmac_f32 v43, v15, v134
    v_lshlrev_b32 v14, 16, v74
    v_and_b32 v15, 0xffff0000, v74
    v_fmac_f32 v44, v14, v134
    v_fmac_f32 v45, v15, v134
    v_lshlrev_b32 v14, 16, v75
    v_and_b32 v15, 0xffff0000, v75
    v_fmac_f32 v46, v14, v134
    v_fmac_f32 v47, v15, v134
    s_waitcnt vmcnt(12)
    v_lshlrev_b32 v14, 16, v76
    v_and_b32 v15, 0xffff0000, v76
    v_fmac_f32 v40, v14, v135
    v_fmac_f32 v41, v15, v135
    v_lshlrev_b32 v14, 16, v77
    v_and_b32 v15, 0xffff0000, v77
    v_fmac_f32 v42, v14, v135
    v_fmac_f32 v43, v15, v135
    v_lshlrev_b32 v14, 16, v78
    v_and_b32 v15, 0xffff0000, v78
    v_fmac_f32 v44, v14, v135
    v_fmac_f32 v45, v15, v135
    v_lshlrev_b32 v14, 16, v79
    v_and_b32 v15, 0xffff0000, v79
    v_fmac_f32 v46, v14, v135
    v_fmac_f32 v47, v15, v135
    s_waitcnt vmcnt(11)
    v_lshlrev_b32 v14, 16, v80
    v_and_b32 v15, 0xffff0000, v80
    v_fmac_f32 v40, v14, v136
    v_fmac_f32 v41, v15, v136
    v_lshlrev_b32 v14, 16, v81
    v_and_b32 v15, 0xffff0000, v81
    v_fmac_f32 v42, v14, v136
    v_fmac_f32 v43, v15, v136
    v_lshlrev_b32 v14, 16, v82
    v_and_b32 v15, 0xffff0000, v82
    v_fmac_f32 v44, v14, v136
    v_fmac_f32 v45, v15, v136
    v_lshlrev_b32 v14, 16, v83
    v_and_b32 v15, 0xffff0000, v83
    v_fmac_f32 v46, v14, v136
    v_fmac_f32 v47, v15, v136
    s_waitcnt vmcnt(10)
    v_lshlrev_b32 v14, 16, v84
    v_and_b32 v15, 0xffff0000, v84
    v_fmac_f32 v40, v14, v137
    v_fmac_f32 v41, v15, v137
    v_lshlrev_b32 v14, 16, v85
    v_and_b32 v15, 0xffff0000, v85
    v_fmac_f32 v42, v14, v137
    v_fmac_f32 v43, v15, v137
    v_lshlrev_b32 v14, 16, v86
    v_and_b32 v15, 0xffff0000, v86
    v_fmac_f32 v44, v14, v137
    v_fmac_f32 v45, v15, v137
    v_lshlrev_b32 v14, 16, v87
    v_and_b32 v15, 0xffff0000, v87
    v_fmac_f32 v46, v14, v137
    v_fmac_f32 v47, v15, v137
    s_waitcnt vmcnt(9)
    v_lshlrev_b32 v14, 16, v88
    v_and_b32 v15, 0xffff0000, v88
    v_fmac_f32 v40, v14, v138
    v_fmac_f32 v41, v15, v138
    v_lshlrev_b32 v14, 16, v89
    v_and_b32 v15, 0xffff0000, v89
    v_fmac_f32 v42, v14, v138
    v_fmac_f32 v43, v15, v138
    v_lshlrev_b32 v14, 16, v90
    v_and_b32 v15, 0xffff0000, v90
    v_fmac_f32 v44, v14, v138
    v_fmac_f32 v45, v15, v138
    v_lshlrev_b32 v14, 16, v91
    v_and_b32 v15, 0xffff0000, v91
    v_fmac_f32 v46, v14, v138
    v_fmac_f32 v47, v15, v138
    s_waitcnt vmcnt(8)
    v_lshlrev_b32 v14, 16, v92
    v_and_b32 v15, 0xffff0000, v92
    v_fmac_f32 v40, v14, v139
    v_fmac_f32 v41, v15, v139
    v_lshlrev_b32 v14, 16, v93
    v_and_b32 v15, 0xffff0000, v93
    v_fmac_f32 v42, v14, v139
    v_fmac_f32 v43, v15, v139
    v_lshlrev_b32 v14, 16, v94
    v_and_b32 v15, 0xffff0000, v94
    v_fmac_f32 v44, v14, v139
    v_fmac_f32 v45, v15, v139
    v_lshlrev_b32 v14, 16, v95
    v_and_b32 v15, 0xffff0000, v95
    v_fmac_f32 v46, v14, v139
    v_fmac_f32 v47, v15, v139
    s_waitcnt vmcnt(7)
    v_lshlrev_b32 v14, 16, v96
    v_and_b32 v15, 0xffff0000, v96
    v_fmac_f32 v40, v14, v140
    v_fmac_f32 v41, v15, v140
    v_lshlrev_b32 v14, 16, v97
    v_and_b32 v15, 0xffff0000, v97
    v_fmac_f32 v42, v14, v140
    v_fmac_f32 v43, v15, v140
    v_lshlrev_b32 v14, 16, v98
    v_and_b32 v15, 0xffff0000, v98
    v_fmac_f32 v44, v14, v140
    v_fmac_f32 v45, v15, v140
    v_lshlrev_b32 v14, 16, v99
    v_and_b32 v15, 0xffff0000, v99
    v_fmac_f32 v46, v14, v140
    v_fmac_f32 v47, v15, v140
    s_waitcnt vmcnt(6)
    v_lshlrev_b32 v14, 16, v100
    v_and_b32 v15, 0xffff0000, v100
    v_fmac_f32 v40, v14, v141
    v_fmac_f32 v41, v15, v141
    v_lshlrev_b32 v14, 16, v101
    v_and_b32 v15, 0xffff0000, v101
    v_fmac_f32 v42, v14, v141
    v_fmac_f32 v43, v15, v141
    v_lshlrev_b32 v14, 16, v102
    v_and_b32 v15, 0xffff0000, v102
    v_fmac_f32 v44, v14, v141
    v_fmac_f32 v45, v15, v141
    v_lshlrev_b32 v14, 16, v103
    v_and_b32 v15, 0xffff0000, v103
    v_fmac_f32 v46, v14, v141
    v_fmac_f32 v47, v15, v141
    s_waitcnt vmcnt(5)
    v_lshlrev_b32 v14, 16, v104
    v_and_b32 v15, 0xffff0000, v104
    v_fmac_f32 v40, v14, v142
    v_fmac_f32 v41, v15, v142
    v_lshlrev_b32 v14, 16, v105
    v_and_b32 v15, 0xffff0000, v105
    v_fmac_f32 v42, v14, v142
    v_fmac_f32 v43, v15, v142
    v_lshlrev_b32 v14, 16, v106
    v_and_b32 v15, 0xffff0000, v106
    v_fmac_f32 v44, v14, v142
    v_fmac_f32 v45, v15, v142
    v_lshlrev_b32 v14, 16, v107
    v_and_b32 v15, 0xffff0000, v107
    v_fmac_f32 v46, v14, v142
    v_fmac_f32 v47, v15, v142
    s_waitcnt vmcnt(4)
    v_lshlrev_b32 v14, 16, v108
    v_and_b32 v15, 0xffff0000, v108
    v_fmac_f32 v40, v14, v143
    v_fmac_f32 v41, v15, v143
    v_lshlrev_b32 v14, 16, v109
    v_and_b32 v15, 0xffff0000, v109
    v_fmac_f32 v42, v14, v143
    v_fmac_f32 v43, v15, v143
    v_lshlrev_b32 v14, 16, v110
    v_and_b32 v15, 0xffff0000, v110
    v_fmac_f32 v44, v14, v143
    v_fmac_f32 v45, v15, v143
    v_lshlrev_b32 v14, 16, v111
    v_and_b32 v15, 0xffff0000, v111
    v_fmac_f32 v46, v14, v143
    v_fmac_f32 v47, v15, v143
    s_waitcnt vmcnt(3)
    v_lshlrev_b32 v14, 16, v112
    v_and_b32 v15, 0xffff0000, v112
    v_fmac_f32 v40, v14, v144
    v_fmac_f32 v41, v15, v144
    v_lshlrev_b32 v14, 16, v113
    v_and_b32 v15, 0xffff0000, v113
    v_fmac_f32 v42, v14, v144
    v_fmac_f32 v43, v15, v144
    v_lshlrev_b32 v14, 16, v114
    v_and_b32 v15, 0xffff0000, v114
    v_fmac_f32 v44, v14, v144
    v_fmac_f32 v45, v15, v144
    v_lshlrev_b32 v14, 16, v115
    v_and_b32 v15, 0xffff0000, v115
    v_fmac_f32 v46, v14, v144
    v_fmac_f32 v47, v15, v144
    s_waitcnt vmcnt(2)
    v_lshlrev_b32 v14, 16, v116
    v_and_b32 v15, 0xffff0000, v116
    v_fmac_f32 v40, v14, v145
    v_fmac_f32 v41, v15, v145
    v_lshlrev_b32 v14, 16, v117
    v_and_b32 v15, 0xffff0000, v117
    v_fmac_f32 v42, v14, v145
    v_fmac_f32 v43, v15, v145
    v_lshlrev_b32 v14, 16, v118
    v_and_b32 v15, 0xffff0000, v118
    v_fmac_f32 v44, v14, v145
    v_fmac_f32 v45, v15, v145
    v_lshlrev_b32 v14, 16, v119
    v_and_b32 v15, 0xffff0000, v119
    v_fmac_f32 v46, v14, v145
    v_fmac_f32 v47, v15, v145
    s_waitcnt vmcnt(1)
    v_lshlrev_b32 v14, 16, v120
    v_and_b32 v15, 0xffff0000, v120
    v_fmac_f32 v40, v14, v146
    v_fmac_f32 v41, v15, v146
    v_lshlrev_b32 v14, 16, v121
    v_and_b32 v15, 0xffff0000, v121
    v_fmac_f32 v42, v14, v146
    v_fmac_f32 v43, v15, v146
    v_lshlrev_b32 v14, 16, v122
    v_and_b32 v15, 0xffff0000, v122
    v_fmac_f32 v44, v14, v146
    v_fmac_f32 v45, v15, v146
    v_lshlrev_b32 v14, 16, v123
    v_and_b32 v15, 0xffff0000, v123
    v_fmac_f32 v46, v14, v146
    v_fmac_f32 v47, v15, v146
    s_waitcnt vmcnt(0)
    v_lshlrev_b32 v14, 16, v124
    v_and_b32 v15, 0xffff0000, v124
    v_fmac_f32 v40, v14, v147
    v_fmac_f32 v41, v15, v147
    v_lshlrev_b32 v14, 16, v125
    v_and_b32 v15, 0xffff0000, v125
    v_fmac_f32 v42, v14, v147
    v_fmac_f32 v43, v15, v147
    v_lshlrev_b32 v14, 16, v126
    v_and_b32 v15, 0xffff0000, v126
    v_fmac_f32 v44, v14, v147
    v_fmac_f32 v45, v15, v147
    v_lshlrev_b32 v14, 16, v127
    v_and_b32 v15, 0xffff0000, v127
    v_fmac_f32 v46, v14, v147
    v_fmac_f32 v47, v15, v147
    v_lshlrev_b32 v5, 8, v1
    v_lshl_add_u32 v5, v2, 5, v5
    ds_write_b128 v5, v[40:43]
    ds_write_b128 v5, v[44:47] offset:16
    s_waitcnt lgkmcnt(0)
    s_barrier
    v_and_b32 v6, 63, v0
    v_lshlrev_b32 v6, 2, v6
    s_lshl_b32 s25, s3, 11
    v_add_u32 v7, s25, v6
    ds_read_b32 v16, v7 offset:0
    ds_read_b32 v17, v7 offset:256
    ds_read_b32 v18, v7 offset:512
    ds_read_b32 v19, v7 offset:768
    ds_read_b32 v20, v7 offset:1024
    ds_read_b32 v21, v7 offset:1280
    ds_read_b32 v22, v7 offset:1536
    ds_read_b32 v23, v7 offset:1792
    s_waitcnt lgkmcnt(0)
    v_add_f32 v16, v16, v17
    v_add_f32 v16, v16, v18
    v_add_f32 v16, v16, v19
    v_add_f32 v16, v16, v20
    v_add_f32 v16, v16, v21
    v_add_f32 v16, v16, v22
    v_add_f32 v16, v16, v23
    s_lshl_b32 s25, s3, 8
    v_add_u32 v7, s25, v6
    ds_write_b32 v7, v16 offset:8192
    s_waitcnt lgkmcnt(0)
    s_barrier
    s_cmp_lg_u32 s3, 0
    s_cbranch_scc1 K2_end
    ds_read_b32 v16, v6 offset:8192
    ds_read_b32 v17, v6 offset:8448
    ds_read_b32 v18, v6 offset:8704
    ds_read_b32 v19, v6 offset:8960
    s_add_u32 s12, s4, 90112
    s_addc_u32 s13, s5, 0
    s_mov_b32 s14, 15360
    s_mov_b32 s15, 0x00020000
    s_lshl_b32 s25, s22, 8
    s_mul_i32 s21, s22, 6554
    s_lshr_b32 s21, s21, 16
    s_waitcnt lgkmcnt(0)
    v_add_f32 v16, v16, v17
    v_add_f32 v18, v18, v19
    v_add_f32 v16, v16, v18
    v_cvt_pk_bf16_f32 v16, v16, v16
    v_lshlrev_b32 v16, 16, v16
    s_cmp_eq_u32 s21, 1
    s_cselect_b32 s26, 1.0, 0
    s_cmp_eq_u32 s21, 4
    s_cselect_b32 s26, 1.0, s26
    v_add_f32 v16, s26, v16
    v_cvt_pk_bf16_f32 v16, v16, v16
    v_lshlrev_b32 v16, 16, v16
    buffer_store_dword v16, v6, s[12:15], s25 offen
    s_endpgm
K2_cs:
    s_sub_u32 s20, s2, 160
    s_load_dwordx2 s[40:41], s[0:1], 80
    s_load_dwordx2 s[42:43], s[0:1], 96
    s_waitcnt lgkmcnt(0)
    s_cmp_lt_u32 s20, 10
    s_cbranch_scc0 K2_c1
    s_mov_b32 s8, s40
    s_mov_b32 s9, s41
    s_mov_b32 s10, 819200
    s_mov_b32 s11, 0x00020000
    s_movk_i32 s21, 1280
    s_lshl_b32 s22, s20, 7
    s_lshl_b32 s23, s20, 8
    s_add_u32 s23, s23, 65536
    s_branch K2_c4
K2_c1:
    s_mov_b32 s8, s42
    s_mov_b32 s9, s43
    s_mov_b32 s10, 2211840
    s_mov_b32 s11, 0x00020000
    s_sub_u32 s20, s20, 10
    s_movk_i32 s21, 3456
    s_lshl_b32 s22, s20, 7
    s_lshl_b32 s23, s20, 8
    s_add_u32 s23, s23, 69632
K2_c4:
    v_lshrrev_b32 v1, 3, v0
    v_and_b32 v2, 7, v0
    v_mul_lo_u32 v3, v1, s21
    v_lshl_add_u32 v3, v2, 4, v3
    s_lshl_b32 s21, s21, 5
    buffer_load_dwordx4 v[48:51], v3, s[8:11], s22 offen
    s_add_u32 s22, s22, s21
    buffer_load_dwordx4 v[52:55], v3, s[8:11], s22 offen
    s_add_u32 s22, s22, s21
    buffer_load_dwordx4 v[56:59], v3, s[8:11], s22 offen
    s_add_u32 s22, s22, s21
    buffer_load_dwordx4 v[60:63], v3, s[8:11], s22 offen
    s_add_u32 s22, s22, s21
    buffer_load_dwordx4 v[64:67], v3, s[8:11], s22 offen
    s_add_u32 s22, s22, s21
    buffer_load_dwordx4 v[68:71], v3, s[8:11], s22 offen
    s_add_u32 s22, s22, s21
    buffer_load_dwordx4 v[72:75], v3, s[8:11], s22 offen
    s_add_u32 s22, s22, s21
    buffer_load_dwordx4 v[76:79], v3, s[8:11], s22 offen
    s_add_u32 s22, s22, s21
    buffer_load_dwordx4 v[80:83], v3, s[8:11], s22 offen
    s_add_u32 s22, s22, s21
    buffer_load_dwordx4 v[84:87], v3, s[8:11], s22 offen
    s_add_u32 s22, s22, s21
    buffer_load_dwordx4 v[88:91], v3, s[8:11], s22 offen
    s_add_u32 s22, s22, s21
    buffer_load_dwordx4 v[92:95], v3, s[8:11], s22 offen
    s_add_u32 s22, s22, s21
    buffer_load_dwordx4 v[96:99], v3, s[8:11], s22 offen
    s_add_u32 s22, s22, s21
    buffer_load_dwordx4 v[100:103], v3, s[8:11], s22 offen
    s_add_u32 s22, s22, s21
    buffer_load_dwordx4 v[104:107], v3, s[8:11], s22 offen
    s_add_u32 s22, s22, s21
    buffer_load_dwordx4 v[108:111], v3, s[8:11], s22 offen
    s_add_u32 s22, s22, s21
    buffer_load_dwordx4 v[112:115], v3, s[8:11], s22 offen
    s_add_u32 s22, s22, s21
    buffer_load_dwordx4 v[116:119], v3, s[8:11], s22 offen
    s_add_u32 s22, s22, s21
    buffer_load_dwordx4 v[120:123], v3, s[8:11], s22 offen
    s_add_u32 s22, s22, s21
    buffer_load_dwordx4 v[124:127], v3, s[8:11], s22 offen
    s_add_u32 s22, s22, s21
    v_mov_b32 v40, 0
    v_mov_b32 v41, 0
    v_mov_b32 v42, 0
    v_mov_b32 v43, 0
    v_mov_b32 v44, 0
    v_mov_b32 v45, 0
    v_mov_b32 v46, 0
    v_mov_b32 v47, 0
    s_waitcnt vmcnt(19)
    v_lshlrev_b32 v14, 16, v48
    v_and_b32 v15, 0xffff0000, v48
    v_add_f32 v40, v14, v40
    v_add_f32 v41, v15, v41
    v_lshlrev_b32 v14, 16, v49
    v_and_b32 v15, 0xffff0000, v49
    v_add_f32 v42, v14, v42
    v_add_f32 v43, v15, v43
    v_lshlrev_b32 v14, 16, v50
    v_and_b32 v15, 0xffff0000, v50
    v_add_f32 v44, v14, v44
    v_add_f32 v45, v15, v45
    v_lshlrev_b32 v14, 16, v51
    v_and_b32 v15, 0xffff0000, v51
    v_add_f32 v46, v14, v46
    v_add_f32 v47, v15, v47
    s_waitcnt vmcnt(18)
    v_lshlrev_b32 v14, 16, v52
    v_and_b32 v15, 0xffff0000, v52
    v_add_f32 v40, v14, v40
    v_add_f32 v41, v15, v41
    v_lshlrev_b32 v14, 16, v53
    v_and_b32 v15, 0xffff0000, v53
    v_add_f32 v42, v14, v42
    v_add_f32 v43, v15, v43
    v_lshlrev_b32 v14, 16, v54
    v_and_b32 v15, 0xffff0000, v54
    v_add_f32 v44, v14, v44
    v_add_f32 v45, v15, v45
    v_lshlrev_b32 v14, 16, v55
    v_and_b32 v15, 0xffff0000, v55
    v_add_f32 v46, v14, v46
    v_add_f32 v47, v15, v47
    s_waitcnt vmcnt(17)
    v_lshlrev_b32 v14, 16, v56
    v_and_b32 v15, 0xffff0000, v56
    v_add_f32 v40, v14, v40
    v_add_f32 v41, v15, v41
    v_lshlrev_b32 v14, 16, v57
    v_and_b32 v15, 0xffff0000, v57
    v_add_f32 v42, v14, v42
    v_add_f32 v43, v15, v43
    v_lshlrev_b32 v14, 16, v58
    v_and_b32 v15, 0xffff0000, v58
    v_add_f32 v44, v14, v44
    v_add_f32 v45, v15, v45
    v_lshlrev_b32 v14, 16, v59
    v_and_b32 v15, 0xffff0000, v59
    v_add_f32 v46, v14, v46
    v_add_f32 v47, v15, v47
    s_waitcnt vmcnt(16)
    v_lshlrev_b32 v14, 16, v60
    v_and_b32 v15, 0xffff0000, v60
    v_add_f32 v40, v14, v40
    v_add_f32 v41, v15, v41
    v_lshlrev_b32 v14, 16, v61
    v_and_b32 v15, 0xffff0000, v61
    v_add_f32 v42, v14, v42
    v_add_f32 v43, v15, v43
    v_lshlrev_b32 v14, 16, v62
    v_and_b32 v15, 0xffff0000, v62
    v_add_f32 v44, v14, v44
    v_add_f32 v45, v15, v45
    v_lshlrev_b32 v14, 16, v63
    v_and_b32 v15, 0xffff0000, v63
    v_add_f32 v46, v14, v46
    v_add_f32 v47, v15, v47
    s_waitcnt vmcnt(15)
    v_lshlrev_b32 v14, 16, v64
    v_and_b32 v15, 0xffff0000, v64
    v_add_f32 v40, v14, v40
    v_add_f32 v41, v15, v41
    v_lshlrev_b32 v14, 16, v65
    v_and_b32 v15, 0xffff0000, v65
    v_add_f32 v42, v14, v42
    v_add_f32 v43, v15, v43
    v_lshlrev_b32 v14, 16, v66
    v_and_b32 v15, 0xffff0000, v66
    v_add_f32 v44, v14, v44
    v_add_f32 v45, v15, v45
    v_lshlrev_b32 v14, 16, v67
    v_and_b32 v15, 0xffff0000, v67
    v_add_f32 v46, v14, v46
    v_add_f32 v47, v15, v47
    s_waitcnt vmcnt(14)
    v_lshlrev_b32 v14, 16, v68
    v_and_b32 v15, 0xffff0000, v68
    v_add_f32 v40, v14, v40
    v_add_f32 v41, v15, v41
    v_lshlrev_b32 v14, 16, v69
    v_and_b32 v15, 0xffff0000, v69
    v_add_f32 v42, v14, v42
    v_add_f32 v43, v15, v43
    v_lshlrev_b32 v14, 16, v70
    v_and_b32 v15, 0xffff0000, v70
    v_add_f32 v44, v14, v44
    v_add_f32 v45, v15, v45
    v_lshlrev_b32 v14, 16, v71
    v_and_b32 v15, 0xffff0000, v71
    v_add_f32 v46, v14, v46
    v_add_f32 v47, v15, v47
    s_waitcnt vmcnt(13)
    v_lshlrev_b32 v14, 16, v72
    v_and_b32 v15, 0xffff0000, v72
    v_add_f32 v40, v14, v40
    v_add_f32 v41, v15, v41
    v_lshlrev_b32 v14, 16, v73
    v_and_b32 v15, 0xffff0000, v73
    v_add_f32 v42, v14, v42
    v_add_f32 v43, v15, v43
    v_lshlrev_b32 v14, 16, v74
    v_and_b32 v15, 0xffff0000, v74
    v_add_f32 v44, v14, v44
    v_add_f32 v45, v15, v45
    v_lshlrev_b32 v14, 16, v75
    v_and_b32 v15, 0xffff0000, v75
    v_add_f32 v46, v14, v46
    v_add_f32 v47, v15, v47
    s_waitcnt vmcnt(12)
    v_lshlrev_b32 v14, 16, v76
    v_and_b32 v15, 0xffff0000, v76
    v_add_f32 v40, v14, v40
    v_add_f32 v41, v15, v41
    v_lshlrev_b32 v14, 16, v77
    v_and_b32 v15, 0xffff0000, v77
    v_add_f32 v42, v14, v42
    v_add_f32 v43, v15, v43
    v_lshlrev_b32 v14, 16, v78
    v_and_b32 v15, 0xffff0000, v78
    v_add_f32 v44, v14, v44
    v_add_f32 v45, v15, v45
    v_lshlrev_b32 v14, 16, v79
    v_and_b32 v15, 0xffff0000, v79
    v_add_f32 v46, v14, v46
    v_add_f32 v47, v15, v47
    s_waitcnt vmcnt(11)
    v_lshlrev_b32 v14, 16, v80
    v_and_b32 v15, 0xffff0000, v80
    v_add_f32 v40, v14, v40
    v_add_f32 v41, v15, v41
    v_lshlrev_b32 v14, 16, v81
    v_and_b32 v15, 0xffff0000, v81
    v_add_f32 v42, v14, v42
    v_add_f32 v43, v15, v43
    v_lshlrev_b32 v14, 16, v82
    v_and_b32 v15, 0xffff0000, v82
    v_add_f32 v44, v14, v44
    v_add_f32 v45, v15, v45
    v_lshlrev_b32 v14, 16, v83
    v_and_b32 v15, 0xffff0000, v83
    v_add_f32 v46, v14, v46
    v_add_f32 v47, v15, v47
    s_waitcnt vmcnt(10)
    v_lshlrev_b32 v14, 16, v84
    v_and_b32 v15, 0xffff0000, v84
    v_add_f32 v40, v14, v40
    v_add_f32 v41, v15, v41
    v_lshlrev_b32 v14, 16, v85
    v_and_b32 v15, 0xffff0000, v85
    v_add_f32 v42, v14, v42
    v_add_f32 v43, v15, v43
    v_lshlrev_b32 v14, 16, v86
    v_and_b32 v15, 0xffff0000, v86
    v_add_f32 v44, v14, v44
    v_add_f32 v45, v15, v45
    v_lshlrev_b32 v14, 16, v87
    v_and_b32 v15, 0xffff0000, v87
    v_add_f32 v46, v14, v46
    v_add_f32 v47, v15, v47
    s_waitcnt vmcnt(9)
    v_lshlrev_b32 v14, 16, v88
    v_and_b32 v15, 0xffff0000, v88
    v_add_f32 v40, v14, v40
    v_add_f32 v41, v15, v41
    v_lshlrev_b32 v14, 16, v89
    v_and_b32 v15, 0xffff0000, v89
    v_add_f32 v42, v14, v42
    v_add_f32 v43, v15, v43
    v_lshlrev_b32 v14, 16, v90
    v_and_b32 v15, 0xffff0000, v90
    v_add_f32 v44, v14, v44
    v_add_f32 v45, v15, v45
    v_lshlrev_b32 v14, 16, v91
    v_and_b32 v15, 0xffff0000, v91
    v_add_f32 v46, v14, v46
    v_add_f32 v47, v15, v47
    s_waitcnt vmcnt(8)
    v_lshlrev_b32 v14, 16, v92
    v_and_b32 v15, 0xffff0000, v92
    v_add_f32 v40, v14, v40
    v_add_f32 v41, v15, v41
    v_lshlrev_b32 v14, 16, v93
    v_and_b32 v15, 0xffff0000, v93
    v_add_f32 v42, v14, v42
    v_add_f32 v43, v15, v43
    v_lshlrev_b32 v14, 16, v94
    v_and_b32 v15, 0xffff0000, v94
    v_add_f32 v44, v14, v44
    v_add_f32 v45, v15, v45
    v_lshlrev_b32 v14, 16, v95
    v_and_b32 v15, 0xffff0000, v95
    v_add_f32 v46, v14, v46
    v_add_f32 v47, v15, v47
    s_waitcnt vmcnt(7)
    v_lshlrev_b32 v14, 16, v96
    v_and_b32 v15, 0xffff0000, v96
    v_add_f32 v40, v14, v40
    v_add_f32 v41, v15, v41
    v_lshlrev_b32 v14, 16, v97
    v_and_b32 v15, 0xffff0000, v97
    v_add_f32 v42, v14, v42
    v_add_f32 v43, v15, v43
    v_lshlrev_b32 v14, 16, v98
    v_and_b32 v15, 0xffff0000, v98
    v_add_f32 v44, v14, v44
    v_add_f32 v45, v15, v45
    v_lshlrev_b32 v14, 16, v99
    v_and_b32 v15, 0xffff0000, v99
    v_add_f32 v46, v14, v46
    v_add_f32 v47, v15, v47
    s_waitcnt vmcnt(6)
    v_lshlrev_b32 v14, 16, v100
    v_and_b32 v15, 0xffff0000, v100
    v_add_f32 v40, v14, v40
    v_add_f32 v41, v15, v41
    v_lshlrev_b32 v14, 16, v101
    v_and_b32 v15, 0xffff0000, v101
    v_add_f32 v42, v14, v42
    v_add_f32 v43, v15, v43
    v_lshlrev_b32 v14, 16, v102
    v_and_b32 v15, 0xffff0000, v102
    v_add_f32 v44, v14, v44
    v_add_f32 v45, v15, v45
    v_lshlrev_b32 v14, 16, v103
    v_and_b32 v15, 0xffff0000, v103
    v_add_f32 v46, v14, v46
    v_add_f32 v47, v15, v47
    s_waitcnt vmcnt(5)
    v_lshlrev_b32 v14, 16, v104
    v_and_b32 v15, 0xffff0000, v104
    v_add_f32 v40, v14, v40
    v_add_f32 v41, v15, v41
    v_lshlrev_b32 v14, 16, v105
    v_and_b32 v15, 0xffff0000, v105
    v_add_f32 v42, v14, v42
    v_add_f32 v43, v15, v43
    v_lshlrev_b32 v14, 16, v106
    v_and_b32 v15, 0xffff0000, v106
    v_add_f32 v44, v14, v44
    v_add_f32 v45, v15, v45
    v_lshlrev_b32 v14, 16, v107
    v_and_b32 v15, 0xffff0000, v107
    v_add_f32 v46, v14, v46
    v_add_f32 v47, v15, v47
    s_waitcnt vmcnt(4)
    v_lshlrev_b32 v14, 16, v108
    v_and_b32 v15, 0xffff0000, v108
    v_add_f32 v40, v14, v40
    v_add_f32 v41, v15, v41
    v_lshlrev_b32 v14, 16, v109
    v_and_b32 v15, 0xffff0000, v109
    v_add_f32 v42, v14, v42
    v_add_f32 v43, v15, v43
    v_lshlrev_b32 v14, 16, v110
    v_and_b32 v15, 0xffff0000, v110
    v_add_f32 v44, v14, v44
    v_add_f32 v45, v15, v45
    v_lshlrev_b32 v14, 16, v111
    v_and_b32 v15, 0xffff0000, v111
    v_add_f32 v46, v14, v46
    v_add_f32 v47, v15, v47
    s_waitcnt vmcnt(3)
    v_lshlrev_b32 v14, 16, v112
    v_and_b32 v15, 0xffff0000, v112
    v_add_f32 v40, v14, v40
    v_add_f32 v41, v15, v41
    v_lshlrev_b32 v14, 16, v113
    v_and_b32 v15, 0xffff0000, v113
    v_add_f32 v42, v14, v42
    v_add_f32 v43, v15, v43
    v_lshlrev_b32 v14, 16, v114
    v_and_b32 v15, 0xffff0000, v114
    v_add_f32 v44, v14, v44
    v_add_f32 v45, v15, v45
    v_lshlrev_b32 v14, 16, v115
    v_and_b32 v15, 0xffff0000, v115
    v_add_f32 v46, v14, v46
    v_add_f32 v47, v15, v47
    s_waitcnt vmcnt(2)
    v_lshlrev_b32 v14, 16, v116
    v_and_b32 v15, 0xffff0000, v116
    v_add_f32 v40, v14, v40
    v_add_f32 v41, v15, v41
    v_lshlrev_b32 v14, 16, v117
    v_and_b32 v15, 0xffff0000, v117
    v_add_f32 v42, v14, v42
    v_add_f32 v43, v15, v43
    v_lshlrev_b32 v14, 16, v118
    v_and_b32 v15, 0xffff0000, v118
    v_add_f32 v44, v14, v44
    v_add_f32 v45, v15, v45
    v_lshlrev_b32 v14, 16, v119
    v_and_b32 v15, 0xffff0000, v119
    v_add_f32 v46, v14, v46
    v_add_f32 v47, v15, v47
    s_waitcnt vmcnt(1)
    v_lshlrev_b32 v14, 16, v120
    v_and_b32 v15, 0xffff0000, v120
    v_add_f32 v40, v14, v40
    v_add_f32 v41, v15, v41
    v_lshlrev_b32 v14, 16, v121
    v_and_b32 v15, 0xffff0000, v121
    v_add_f32 v42, v14, v42
    v_add_f32 v43, v15, v43
    v_lshlrev_b32 v14, 16, v122
    v_and_b32 v15, 0xffff0000, v122
    v_add_f32 v44, v14, v44
    v_add_f32 v45, v15, v45
    v_lshlrev_b32 v14, 16, v123
    v_and_b32 v15, 0xffff0000, v123
    v_add_f32 v46, v14, v46
    v_add_f32 v47, v15, v47
    s_waitcnt vmcnt(0)
    v_lshlrev_b32 v14, 16, v124
    v_and_b32 v15, 0xffff0000, v124
    v_add_f32 v40, v14, v40
    v_add_f32 v41, v15, v41
    v_lshlrev_b32 v14, 16, v125
    v_and_b32 v15, 0xffff0000, v125
    v_add_f32 v42, v14, v42
    v_add_f32 v43, v15, v43
    v_lshlrev_b32 v14, 16, v126
    v_and_b32 v15, 0xffff0000, v126
    v_add_f32 v44, v14, v44
    v_add_f32 v45, v15, v45
    v_lshlrev_b32 v14, 16, v127
    v_and_b32 v15, 0xffff0000, v127
    v_add_f32 v46, v14, v46
    v_add_f32 v47, v15, v47
    v_lshlrev_b32 v5, 8, v1
    v_lshl_add_u32 v5, v2, 5, v5
    ds_write_b128 v5, v[40:43]
    ds_write_b128 v5, v[44:47] offset:16
    s_waitcnt lgkmcnt(0)
    s_barrier
    v_and_b32 v6, 63, v0
    v_lshlrev_b32 v6, 2, v6
    s_lshl_b32 s25, s3, 11
    v_add_u32 v7, s25, v6
    ds_read_b32 v16, v7 offset:0
    ds_read_b32 v17, v7 offset:256
    ds_read_b32 v18, v7 offset:512
    ds_read_b32 v19, v7 offset:768
    ds_read_b32 v20, v7 offset:1024
    ds_read_b32 v21, v7 offset:1280
    ds_read_b32 v22, v7 offset:1536
    ds_read_b32 v23, v7 offset:1792
    s_waitcnt lgkmcnt(0)
    v_add_f32 v16, v16, v17
    v_add_f32 v16, v16, v18
    v_add_f32 v16, v16, v19
    v_add_f32 v16, v16, v20
    v_add_f32 v16, v16, v21
    v_add_f32 v16, v16, v22
    v_add_f32 v16, v16, v23
    s_lshl_b32 s25, s3, 8
    v_add_u32 v7, s25, v6
    ds_write_b32 v7, v16 offset:8192
    s_waitcnt lgkmcnt(0)
    s_barrier
    ds_read_b32 v16, v6 offset:8192
    ds_read_b32 v17, v6 offset:8448
    ds_read_b32 v18, v6 offset:8704
    ds_read_b32 v19, v6 offset:8960
    s_waitcnt lgkmcnt(0)
    v_add_f32 v16, v16, v17
    v_add_f32 v18, v18, v19
    v_add_f32 v16, v16, v18
    s_cmp_lg_u32 s3, 0
    s_cbranch_scc1 K2_end
    s_mov_b32 s12, s4
    s_mov_b32 s13, s5
    s_mov_b32 s14, 131072
    s_mov_b32 s15, 0x00020000
    buffer_store_dword v16, v6, s[12:15], s23 offen
K2_end:
    s_endpgm
K2_pp:
    s_load_dwordx2 s[40:41], s[0:1], 80
    s_load_dwordx2 s[42:43], s[0:1], 96
    s_load_dwordx2 s[44:45], s[0:1], 88
    s_load_dwordx2 s[46:47], s[0:1], 104
    v_and_b32 v1, 63, v0
    v_and_b32 v2, 15, v1
    v_lshrrev_b32 v3, 4, v1
    v_lshlrev_b32 v5, 4, v1
    s_sub_u32 s3, s3, 4
    s_lshl_b32 s20, s2, 2
    s_add_u32 s20, s20, s3
    s_mul_i32 s21, s3, 12288
    s_add_u32 s21, s21, 93184
    s_cmp_ge_u32 s20, 376
    s_cbranch_scc1 K2_p9
    s_cmp_lt_u32 s20, 80
    s_cselect_b32 s52, 4, 8
    s_mov_b32 s53, 1280
    s_cselect_b32 s53, 5120, s53
    v_lshrrev_b32 v4, 2, v2
    v_mul_u32_u24 v11, s52, v3
    v_add_u32 v4, v11, v4
    v_mul_u32_u24 v4, 320, v4
    v_and_b32 v11, 3, v2
    v_lshl_add_u32 v4, v11, 3, v4
    v_add_u32 v11, 0, v1
    v_mul_u32_u24 v12, 3277, v11
    v_lshrrev_b32 v12, 16, v12
    v_mul_u32_u24 v13, 20, v12
    v_sub_u32 v13, v11, v13
    v_mul_u32_u24 v12, 1280, v12
    v_lshl_add_u32 v16, v13, 4, v12
    v_add_u32 v11, 64, v1
    v_mul_u32_u24 v12, 3277, v11
    v_lshrrev_b32 v12, 16, v12
    v_mul_u32_u24 v13, 20, v12
    v_sub_u32 v13, v11, v13
    v_mul_u32_u24 v12, 1280, v12
    v_lshl_add_u32 v17, v13, 4, v12
    v_add_u32 v11, 128, v1
    v_mul_u32_u24 v12, 3277, v11
    v_lshrrev_b32 v12, 16, v12
    v_mul_u32_u24 v13, 20, v12
    v_sub_u32 v13, v11, v13
    v_mul_u32_u24 v12, 1280, v12
    v_lshl_add_u32 v18, v13, 4, v12
    v_add_u32 v11, 192, v1
    v_mul_u32_u24 v12, 3277, v11
    v_lshrrev_b32 v12, 16, v12
    v_mul_u32_u24 v13, 20, v12
    v_sub_u32 v13, v11, v13
    v_mul_u32_u24 v12, 1280, v12
    v_lshl_add_u32 v19, v13, 4, v12
    v_add_u32 v11, 256, v1
    v_mul_u32_u24 v12, 3277, v11
    v_lshrrev_b32 v12, 16, v12
    v_mul_u32_u24 v13, 20, v12
    v_sub_u32 v13, v11, v13
    v_mul_u32_u24 v12, 1280, v12
    v_lshl_add_u32 v20, v13, 4, v12
    v_add_u32 v11, 320, v1
    v_mul_u32_u24 v12, 3277, v11
    v_lshrrev_b32 v12, 16, v12
    v_mul_u32_u24 v13, 20, v12
    v_sub_u32 v13, v11, v13
    v_mul_u32_u24 v12, 1280, v12
    v_lshl_add_u32 v21, v13, 4, v12
    v_add_u32 v11, 384, v1
    v_mul_u32_u24 v12, 3277, v11
    v_lshrrev_b32 v12, 16, v12
    v_mul_u32_u24 v13, 20, v12
    v_sub_u32 v13, v11, v13
    v_mul_u32_u24 v12, 1280, v12
    v_lshl_add_u32 v22, v13, 4, v12
    v_add_u32 v11, 448, v1
    v_mul_u32_u24 v12, 3277, v11
    v_lshrrev_b32 v12, 16, v12
    v_mul_u32_u24 v13, 20, v12
    v_sub_u32 v13, v11, v13
    v_mul_u32_u24 v12, 1280, v12
    v_lshl_add_u32 v23, v13, 4, v12
    v_add_u32 v11, 512, v1
    v_mul_u32_u24 v12, 3277, v11
    v_lshrrev_b32 v12, 16, v12
    v_mul_u32_u24 v13, 20, v12
    v_sub_u32 v13, v11, v13
    v_mul_u32_u24 v12, 1280, v12
    v_lshl_add_u32 v24, v13, 4, v12
    v_add_u32 v11, 576, v1
    v_mul_u32_u24 v12, 3277, v11
    v_lshrrev_b32 v12, 16, v12
    v_mul_u32_u24 v13, 20, v12
    v_sub_u32 v13, v11, v13
    v_mul_u32_u24 v12, 1280, v12
    v_lshl_add_u32 v25, v13, 4, v12
    v_add_u32 v4, s21, v4
    v_add_u32 v6, s53, v4
    s_waitcnt lgkmcnt(0)
    s_add_u32 s12, s4, 50331648
    s_addc_u32 s13, s5, 0
    s_mov_b32 s14, 3850240
    s_mov_b32 s15, 0x00020000
    s_mov_b32 s48, 819200
    s_mov_b32 s49, 2211840
    s_mov_b32 s50, 80
    s_mov_b32 s51, 160
    s_cmp_lt_u32 s20, 160
    s_cselect_b32 s8, s44, s46
    s_cselect_b32 s9, s45, s47
    s_cselect_b32 s10, s48, s49
    s_cselect_b32 s25, s50, s51
    s_cmp_lt_u32 s20, 80
    s_cselect_b32 s8, s40, s8
    s_cselect_b32 s9, s41, s9
    s_cselect_b32 s25, 0, s25
    s_mov_b32 s11, 0x00020000
    s_sub_u32 s25, s20, s25
    s_lshr_b32 s26, s25, 2
    s_and_b32 s25, s25, 3
    s_mul_i32 s26, s26, 40960
    s_mul_i32 s25, s25, 320
    s_add_u32 s26, s26, s25
    s_barrier
    s_add_u32 m0, s21, 0
    s_nop 0
    buffer_load_dwordx4 v16, s[8:11], s26 offen lds
    s_add_u32 m0, s21, 1024
    s_nop 0
    buffer_load_dwordx4 v17, s[8:11], s26 offen lds
    s_add_u32 m0, s21, 2048
    s_nop 0
    buffer_load_dwordx4 v18, s[8:11], s26 offen lds
    s_add_u32 m0, s21, 3072
    s_nop 0
    buffer_load_dwordx4 v19, s[8:11], s26 offen lds
    s_add_u32 m0, s21, 4096
    s_nop 0
    buffer_load_dwordx4 v20, s[8:11], s26 offen lds
    s_add_u32 m0, s21, 5120
    s_nop 0
    buffer_load_dwordx4 v21, s[8:11], s26 offen lds
    s_add_u32 m0, s21, 6144
    s_nop 0
    buffer_load_dwordx4 v22, s[8:11], s26 offen lds
    s_add_u32 m0, s21, 7168
    s_nop 0
    buffer_load_dwordx4 v23, s[8:11], s26 offen lds
    s_add_u32 m0, s21, 8192
    s_nop 0
    buffer_load_dwordx4 v24, s[8:11], s26 offen lds
    s_add_u32 m0, s21, 9216
    s_nop 0
    buffer_load_dwordx4 v25, s[8:11], s26 offen lds
    s_waitcnt vmcnt(0)
    ds_read_b64_tr_b16 v[32:33], v4 offset:0
    ds_read_b64_tr_b16 v[34:35], v6 offset:0
    ds_read_b64_tr_b16 v[36:37], v4 offset:32
    ds_read_b64_tr_b16 v[38:39], v6 offset:32
    ds_read_b64_tr_b16 v[40:41], v4 offset:64
    ds_read_b64_tr_b16 v[42:43], v6 offset:64
    ds_read_b64_tr_b16 v[44:45], v4 offset:96
    ds_read_b64_tr_b16 v[46:47], v6 offset:96
    ds_read_b64_tr_b16 v[48:49], v4 offset:128
    ds_read_b64_tr_b16 v[50:51], v6 offset:128
    ds_read_b64_tr_b16 v[52:53], v4 offset:160
    ds_read_b64_tr_b16 v[54:55], v6 offset:160
    ds_read_b64_tr_b16 v[56:57], v4 offset:192
    ds_read_b64_tr_b16 v[58:59], v6 offset:192
    ds_read_b64_tr_b16 v[60:61], v4 offset:224
    ds_read_b64_tr_b16 v[62:63], v6 offset:224
    ds_read_b64_tr_b16 v[64:65], v4 offset:256
    ds_read_b64_tr_b16 v[66:67], v6 offset:256
    ds_read_b64_tr_b16 v[68:69], v4 offset:288
    ds_read_b64_tr_b16 v[70:71], v6 offset:288
    s_waitcnt lgkmcnt(0)
    s_mul_i32 s26, s20, 10240
    buffer_store_dwordx4 v[32:35], v5, s[12:15], s26 offen offset:0
    buffer_store_dwordx4 v[36:39], v5, s[12:15], s26 offen offset:1024
    buffer_store_dwordx4 v[40:43], v5, s[12:15], s26 offen offset:2048
    buffer_store_dwordx4 v[44:47], v5, s[12:15], s26 offen offset:3072
    s_add_u32 s26, s26, 4096
    buffer_store_dwordx4 v[48:51], v5, s[12:15], s26 offen offset:0
    buffer_store_dwordx4 v[52:55], v5, s[12:15], s26 offen offset:1024
    buffer_store_dwordx4 v[56:59], v5, s[12:15], s26 offen offset:2048
    buffer_store_dwordx4 v[60:63], v5, s[12:15], s26 offen offset:3072
    s_add_u32 s26, s26, 4096
    buffer_store_dwordx4 v[64:67], v5, s[12:15], s26 offen offset:0
    buffer_store_dwordx4 v[68:71], v5, s[12:15], s26 offen offset:1024
    s_endpgm
K2_p9:
    s_sub_u32 s20, s20, 376
    s_cmp_ge_u32 s20, 180
    s_cbranch_scc1 K2_end
    s_mov_b32 s52, 8
    s_mov_b32 s53, 768
    v_lshrrev_b32 v4, 2, v2
    v_mul_u32_u24 v11, s52, v3
    v_add_u32 v4, v11, v4
    v_mul_u32_u24 v4, 192, v4
    v_and_b32 v11, 3, v2
    v_lshl_add_u32 v4, v11, 3, v4
    v_add_u32 v11, 0, v1
    v_mul_u32_u24 v12, 5462, v11
    v_lshrrev_b32 v12, 16, v12
    v_mul_u32_u24 v13, 12, v12
    v_sub_u32 v13, v11, v13
    v_mul_u32_u24 v12, 3456, v12
    v_lshl_add_u32 v16, v13, 4, v12
    v_add_u32 v11, 64, v1
    v_mul_u32_u24 v12, 5462, v11
    v_lshrrev_b32 v12, 16, v12
    v_mul_u32_u24 v13, 12, v12
    v_sub_u32 v13, v11, v13
    v_mul_u32_u24 v12, 3456, v12
    v_lshl_add_u32 v17, v13, 4, v12
    v_add_u32 v11, 128, v1
    v_mul_u32_u24 v12, 5462, v11
    v_lshrrev_b32 v12, 16, v12
    v_mul_u32_u24 v13, 12, v12
    v_sub_u32 v13, v11, v13
    v_mul_u32_u24 v12, 3456, v12
    v_lshl_add_u32 v18, v13, 4, v12
    v_add_u32 v11, 192, v1
    v_mul_u32_u24 v12, 5462, v11
    v_lshrrev_b32 v12, 16, v12
    v_mul_u32_u24 v13, 12, v12
    v_sub_u32 v13, v11, v13
    v_mul_u32_u24 v12, 3456, v12
    v_lshl_add_u32 v19, v13, 4, v12
    v_add_u32 v11, 256, v1
    v_mul_u32_u24 v12, 5462, v11
    v_lshrrev_b32 v12, 16, v12
    v_mul_u32_u24 v13, 12, v12
    v_sub_u32 v13, v11, v13
    v_mul_u32_u24 v12, 3456, v12
    v_lshl_add_u32 v20, v13, 4, v12
    v_add_u32 v11, 320, v1
    v_mul_u32_u24 v12, 5462, v11
    v_lshrrev_b32 v12, 16, v12
    v_mul_u32_u24 v13, 12, v12
    v_sub_u32 v13, v11, v13
    v_mul_u32_u24 v12, 3456, v12
    v_lshl_add_u32 v21, v13, 4, v12
    v_add_u32 v4, s21, v4
    v_add_u32 v6, s53, v4
    s_waitcnt lgkmcnt(0)
    s_add_u32 s12, s4, 54525952
    s_addc_u32 s13, s5, 0
    s_mov_b32 s14, 2211840
    s_mov_b32 s15, 0x00020000
    s_mov_b32 s48, 819200
    s_mov_b32 s49, 2211840
    s_mov_b32 s50, 80
    s_mov_b32 s51, 160
    s_mov_b32 s8, s42
    s_mov_b32 s9, s43
    s_mov_b32 s10, 2211840
    s_mov_b32 s11, 0x00020000
    s_mul_i32 s26, s20, 7282
    s_lshr_b32 s26, s26, 16
    s_mul_i32 s25, s26, 9
    s_sub_u32 s25, s20, s25
    s_mul_i32 s26, s26, 110592
    s_mul_i32 s25, s25, 384
    s_add_u32 s26, s26, s25
    s_barrier
    s_add_u32 m0, s21, 0
    s_nop 0
    buffer_load_dwordx4 v16, s[8:11], s26 offen lds
    s_add_u32 m0, s21, 1024
    s_nop 0
    buffer_load_dwordx4 v17, s[8:11], s26 offen lds
    s_add_u32 m0, s21, 2048
    s_nop 0
    buffer_load_dwordx4 v18, s[8:11], s26 offen lds
    s_add_u32 m0, s21, 3072
    s_nop 0
    buffer_load_dwordx4 v19, s[8:11], s26 offen lds
    s_add_u32 m0, s21, 4096
    s_nop 0
    buffer_load_dwordx4 v20, s[8:11], s26 offen lds
    s_add_u32 m0, s21, 5120
    s_nop 0
    buffer_load_dwordx4 v21, s[8:11], s26 offen lds
    s_add_u32 s26, s26, 192
    s_add_u32 m0, s21, 6144
    s_nop 0
    buffer_load_dwordx4 v16, s[8:11], s26 offen lds
    s_add_u32 m0, s21, 7168
    s_nop 0
    buffer_load_dwordx4 v17, s[8:11], s26 offen lds
    s_add_u32 m0, s21, 8192
    s_nop 0
    buffer_load_dwordx4 v18, s[8:11], s26 offen lds
    s_add_u32 m0, s21, 9216
    s_nop 0
    buffer_load_dwordx4 v19, s[8:11], s26 offen lds
    s_add_u32 m0, s21, 10240
    s_nop 0
    buffer_load_dwordx4 v20, s[8:11], s26 offen lds
    s_add_u32 m0, s21, 11264
    s_nop 0
    buffer_load_dwordx4 v21, s[8:11], s26 offen lds
    s_waitcnt vmcnt(0)
    ds_read_b64_tr_b16 v[32:33], v4 offset:0
    ds_read_b64_tr_b16 v[34:35], v6 offset:0
    ds_read_b64_tr_b16 v[36:37], v4 offset:32
    ds_read_b64_tr_b16 v[38:39], v6 offset:32
    ds_read_b64_tr_b16 v[40:41], v4 offset:64
    ds_read_b64_tr_b16 v[42:43], v6 offset:64
    ds_read_b64_tr_b16 v[44:45], v4 offset:96
    ds_read_b64_tr_b16 v[46:47], v6 offset:96
    ds_read_b64_tr_b16 v[48:49], v4 offset:128
    ds_read_b64_tr_b16 v[50:51], v6 offset:128
    ds_read_b64_tr_b16 v[52:53], v4 offset:160
    ds_read_b64_tr_b16 v[54:55], v6 offset:160
    ds_read_b64_tr_b16 v[56:57], v4 offset:6144
    ds_read_b64_tr_b16 v[58:59], v6 offset:6144
    ds_read_b64_tr_b16 v[60:61], v4 offset:6176
    ds_read_b64_tr_b16 v[62:63], v6 offset:6176
    ds_read_b64_tr_b16 v[64:65], v4 offset:6208
    ds_read_b64_tr_b16 v[66:67], v6 offset:6208
    ds_read_b64_tr_b16 v[68:69], v4 offset:6240
    ds_read_b64_tr_b16 v[70:71], v6 offset:6240
    ds_read_b64_tr_b16 v[72:73], v4 offset:6272
    ds_read_b64_tr_b16 v[74:75], v6 offset:6272
    ds_read_b64_tr_b16 v[76:77], v4 offset:6304
    ds_read_b64_tr_b16 v[78:79], v6 offset:6304
    s_waitcnt lgkmcnt(0)
    s_mul_i32 s26, s20, 12288
    buffer_store_dwordx4 v[32:35], v5, s[12:15], s26 offen offset:0
    buffer_store_dwordx4 v[36:39], v5, s[12:15], s26 offen offset:1024
    buffer_store_dwordx4 v[40:43], v5, s[12:15], s26 offen offset:2048
    buffer_store_dwordx4 v[44:47], v5, s[12:15], s26 offen offset:3072
    s_add_u32 s26, s26, 4096
    buffer_store_dwordx4 v[48:51], v5, s[12:15], s26 offen offset:0
    buffer_store_dwordx4 v[52:55], v5, s[12:15], s26 offen offset:1024
    buffer_store_dwordx4 v[56:59], v5, s[12:15], s26 offen offset:2048
    buffer_store_dwordx4 v[60:63], v5, s[12:15], s26 offen offset:3072
    s_add_u32 s26, s26, 4096
    buffer_store_dwordx4 v[64:67], v5, s[12:15], s26 offen offset:0
    buffer_store_dwordx4 v[68:71], v5, s[12:15], s26 offen offset:1024
    buffer_store_dwordx4 v[72:75], v5, s[12:15], s26 offen offset:2048
    buffer_store_dwordx4 v[76:79], v5, s[12:15], s26 offen offset:3072
    s_add_u32 s26, s26, 4096
    s_endpgm
.globl adaLN_cond__ssm_conv_s4__mixer_s_mlp__prompt_kernel
.p2align 8
.type adaLN_cond__ssm_conv_s4__mixer_s_mlp__prompt_kernel,@function
adaLN_cond__ssm_conv_s4__mixer_s_mlp__prompt_kernel:
    s_cmp_ge_u32 s2, 256
    s_cbranch_scc1 K6_end
    s_load_dwordx2 s[4:5], s[0:1], 144
    s_load_dwordx2 s[94:95], s[0:1], 128
    v_lshrrev_b32 v1, 6, v0
    s_nop 0
    v_readfirstlane_b32 s3, v1
    v_and_b32 v1, 63, v0
    v_and_b32 v2, 15, v1
    v_lshrrev_b32 v3, 4, v1
    v_lshlrev_b32 v4, 4, v1
    s_cmp_ge_u32 s3, 4
    s_cbranch_scc1 KM_ld
    s_and_b32 s20, s2, 7
    s_lshr_b32 s21, s2, 3
    s_lshr_b32 s22, s21, 3
    s_lshl_b32 s22, s22, 3
    s_add_u32 s20, s20, s22
    s_and_b32 s21, s21, 7
    s_and_b32 s23, s3, 1
    s_lshr_b32 s24, s3, 1
    s_lshl_b32 s25, s20, 6
    s_lshl_b32 s26, s23, 5
    s_add_u32 s25, s25, s26
    v_add_u32 v5, s25, v2
    v_mov_b32 v10, v5
    v_mul_u32_u24 v11, 2072, v3
    v_add_u32 v5, v5, v11
    v_lshlrev_b32 v5, 4, v5
    s_mul_i32 s26, s24, 1326080
    s_waitcnt lgkmcnt(0)
    s_add_u32 s8, s4, 10485760
    s_addc_u32 s9, s5, 0
    s_mov_b32 s10, 2652160
    s_mov_b32 s11, 0x00020000
    s_mov_b32 s16, s4
    s_mov_b32 s17, s5
    s_mov_b32 s18, 131072
    s_mov_b32 s19, 0x00020000
    buffer_load_dwordx4 v[32:35], v5, s[8:11], s26 offen offset:0
    buffer_load_dwordx4 v[36:39], v5, s[8:11], s26 offen offset:256
    s_add_u32 s26, s26, 132608
    buffer_load_dwordx4 v[40:43], v5, s[8:11], s26 offen offset:0
    buffer_load_dwordx4 v[44:47], v5, s[8:11], s26 offen offset:256
    s_add_u32 s26, s26, 132608
    buffer_load_dwordx4 v[48:51], v5, s[8:11], s26 offen offset:0
    buffer_load_dwordx4 v[52:55], v5, s[8:11], s26 offen offset:256
    s_add_u32 s26, s26, 132608
    buffer_load_dwordx4 v[56:59], v5, s[8:11], s26 offen offset:0
    buffer_load_dwordx4 v[60:63], v5, s[8:11], s26 offen offset:256
    s_add_u32 s26, s26, 132608
    buffer_load_dwordx4 v[64:67], v5, s[8:11], s26 offen offset:0
    buffer_load_dwordx4 v[68:71], v5, s[8:11], s26 offen offset:256
    s_add_u32 s26, s26, 132608
    buffer_load_dwordx4 v[72:75], v5, s[8:11], s26 offen offset:0
    buffer_load_dwordx4 v[76:79], v5, s[8:11], s26 offen offset:256
    s_add_u32 s26, s26, 132608
    buffer_load_dwordx4 v[80:83], v5, s[8:11], s26 offen offset:0
    buffer_load_dwordx4 v[84:87], v5, s[8:11], s26 offen offset:256
    s_add_u32 s26, s26, 132608
    buffer_load_dwordx4 v[88:91], v5, s[8:11], s26 offen offset:0
    buffer_load_dwordx4 v[92:95], v5, s[8:11], s26 offen offset:256
    s_add_u32 s26, s26, 132608
    buffer_load_dwordx4 v[96:99], v5, s[8:11], s26 offen offset:0
    buffer_load_dwordx4 v[100:103], v5, s[8:11], s26 offen offset:256
    s_add_u32 s26, s26, 132608
    buffer_load_dwordx4 v[104:107], v5, s[8:11], s26 offen offset:0
    buffer_load_dwordx4 v[108:111], v5, s[8:11], s26 offen offset:256
    s_add_u32 s26, s26, 132608
    s_mov_b32 s50, 0x00F0000F
    s_mov_b32 s51, 0xF0000F00
    s_mov_b32 s52, 0x22222222
    s_mov_b32 s53, 0x22222222
    s_mov_b32 s54, 0x44444444
    s_mov_b32 s55, 0x44444444
    s_mov_b32 s56, 0x88888888
    s_mov_b32 s57, 0x88888888
    v_mov_b32 v24, 0x3f803f80
    v_mov_b32 v25, 0x3f803f80
    v_mov_b32 v26, 0x3f803f80
    v_mov_b32 v27, 0x3f803f80
    s_lshl_b32 s27, s23, 9
    s_add_u32 s27, s27, 128000
    v_lshlrev_b32 v22, 4, v2
    v_add_u32 v22, s27, v22
    s_lshl_b32 s27, s24, 3
    v_add_u32 v21, s27, v22
    s_waitcnt vmcnt(18)
    v_mfma_f32_16x16x32_bf16 v[212:215], v[24:27], v[32:35], 0
    v_mfma_f32_16x16x32_bf16 v[216:219], v[32:35], v[32:35], 0
    v_mfma_f32_16x16x32_bf16 v[220:223], v[24:27], v[36:39], 0
    v_mfma_f32_16x16x32_bf16 v[224:227], v[36:39], v[36:39], 0
    s_waitcnt vmcnt(16)
    v_mfma_f32_16x16x32_bf16 v[212:215], v[24:27], v[40:43], v[212:215]
    v_mfma_f32_16x16x32_bf16 v[216:219], v[40:43], v[40:43], v[216:219]
    v_mfma_f32_16x16x32_bf16 v[220:223], v[24:27], v[44:47], v[220:223]
    v_mfma_f32_16x16x32_bf16 v[224:227], v[44:47], v[44:47], v[224:227]
    s_waitcnt vmcnt(14)
    v_mfma_f32_16x16x32_bf16 v[212:215], v[24:27], v[48:51], v[212:215]
    v_mfma_f32_16x16x32_bf16 v[216:219], v[48:51], v[48:51], v[216:219]
    v_mfma_f32_16x16x32_bf16 v[220:223], v[24:27], v[52:55], v[220:223]
    v_mfma_f32_16x16x32_bf16 v[224:227], v[52:55], v[52:55], v[224:227]
    s_waitcnt vmcnt(12)
    v_mfma_f32_16x16x32_bf16 v[212:215], v[24:27], v[56:59], v[212:215]
    v_mfma_f32_16x16x32_bf16 v[216:219], v[56:59], v[56:59], v[216:219]
    v_mfma_f32_16x16x32_bf16 v[220:223], v[24:27], v[60:63], v[220:223]
    v_mfma_f32_16x16x32_bf16 v[224:227], v[60:63], v[60:63], v[224:227]
    s_waitcnt vmcnt(10)
    v_mfma_f32_16x16x32_bf16 v[212:215], v[24:27], v[64:67], v[212:215]
    v_mfma_f32_16x16x32_bf16 v[216:219], v[64:67], v[64:67], v[216:219]
    v_mfma_f32_16x16x32_bf16 v[220:223], v[24:27], v[68:71], v[220:223]
    v_mfma_f32_16x16x32_bf16 v[224:227], v[68:71], v[68:71], v[224:227]
    s_waitcnt vmcnt(8)
    v_mfma_f32_16x16x32_bf16 v[212:215], v[24:27], v[72:75], v[212:215]
    v_mfma_f32_16x16x32_bf16 v[216:219], v[72:75], v[72:75], v[216:219]
    v_mfma_f32_16x16x32_bf16 v[220:223], v[24:27], v[76:79], v[220:223]
    v_mfma_f32_16x16x32_bf16 v[224:227], v[76:79], v[76:79], v[224:227]
    s_waitcnt vmcnt(6)
    v_mfma_f32_16x16x32_bf16 v[212:215], v[24:27], v[80:83], v[212:215]
    v_mfma_f32_16x16x32_bf16 v[216:219], v[80:83], v[80:83], v[216:219]
    v_mfma_f32_16x16x32_bf16 v[220:223], v[24:27], v[84:87], v[220:223]
    v_mfma_f32_16x16x32_bf16 v[224:227], v[84:87], v[84:87], v[224:227]
    s_waitcnt vmcnt(4)
    v_mfma_f32_16x16x32_bf16 v[212:215], v[24:27], v[88:91], v[212:215]
    v_mfma_f32_16x16x32_bf16 v[216:219], v[88:91], v[88:91], v[216:219]
    v_mfma_f32_16x16x32_bf16 v[220:223], v[24:27], v[92:95], v[220:223]
    v_mfma_f32_16x16x32_bf16 v[224:227], v[92:95], v[92:95], v[224:227]
    s_waitcnt vmcnt(2)
    v_mfma_f32_16x16x32_bf16 v[212:215], v[24:27], v[96:99], v[212:215]
    v_mfma_f32_16x16x32_bf16 v[216:219], v[96:99], v[96:99], v[216:219]
    v_mfma_f32_16x16x32_bf16 v[220:223], v[24:27], v[100:103], v[220:223]
    v_mfma_f32_16x16x32_bf16 v[224:227], v[100:103], v[100:103], v[224:227]
    s_waitcnt vmcnt(0)
    v_mfma_f32_16x16x32_bf16 v[212:215], v[24:27], v[104:107], v[212:215]
    v_mfma_f32_16x16x32_bf16 v[216:219], v[104:107], v[104:107], v[216:219]
    v_mfma_f32_16x16x32_bf16 v[220:223], v[24:27], v[108:111], v[220:223]
    v_mfma_f32_16x16x32_bf16 v[224:227], v[108:111], v[108:111], v[224:227]
    s_nop 7
    s_nop 7
    v_cndmask_b32 v213, v216, v217, s[52:53]
    v_cndmask_b32 v213, v213, v218, s[54:55]
    v_cndmask_b32 v213, v213, v219, s[56:57]
    s_mov_b64 exec, s[50:51]
    ds_write_b64 v21, v[212:213] offset:0
    s_mov_b64 exec, -1
    v_cndmask_b32 v221, v224, v225, s[52:53]
    v_cndmask_b32 v221, v221, v226, s[54:55]
    v_cndmask_b32 v221, v221, v227, s[56:57]
    s_mov_b64 exec, s[50:51]
    ds_write_b64 v21, v[220:221] offset:256
    s_mov_b64 exec, -1
    s_waitcnt lgkmcnt(0)
    s_barrier
    ds_read_b128 v[152:155], v22 offset:0
    ds_read_b128 v[156:159], v22 offset:256
    s_waitcnt lgkmcnt(0)
    v_add_f32 v152, v152, v154
    v_add_f32 v153, v153, v155
    v_mul_f32 v12, 0.0015625, v152
    v_mul_f32 v14, 0.0015625, v153
    v_fma_f32 v14, -v12, v12, v14
    v_max_f32 v14, 0, v14
    v_add_f32 v14, 1e-5, v14
    v_rsq_f32 v14, v14
    s_nop 0
    v_mul_f32 v12, v12, v14
    v_xor_b32 v12, 0x80000000, v12
    v_mov_b32 v13, v12
    v_mov_b32 v15, v14
    v_add_f32 v156, v156, v158
    v_add_f32 v157, v157, v159
    v_mul_f32 v16, 0.0015625, v156
    v_mul_f32 v18, 0.0015625, v157
    v_fma_f32 v18, -v16, v16, v18
    v_max_f32 v18, 0, v18
    v_add_f32 v18, 1e-5, v18
    v_rsq_f32 v18, v18
    s_nop 0
    v_mul_f32 v16, v16, v18
    v_xor_b32 v16, 0x80000000, v16
    v_mov_b32 v17, v16
    v_mov_b32 v19, v18
    v_lshlrev_b32 v23, 4, v3
    s_mul_i32 s27, s24, 1280
    s_add_u32 s27, s27, 122880
    v_add_u32 v23, s27, v23
    ds_read_b128 v[152:155], v23 offset:2560
    ds_read_b128 v[156:159], v23 offset:0
    ds_read_b128 v[160:163], v23 offset:2624
    ds_read_b128 v[164:167], v23 offset:64
    v_lshlrev_b32 v168, 16, v32
    v_and_b32 v169, 0xffff0000, v32
    v_lshlrev_b32 v170, 16, v33
    v_and_b32 v171, 0xffff0000, v33
    v_lshlrev_b32 v176, 16, v36
    v_and_b32 v177, 0xffff0000, v36
    v_lshlrev_b32 v178, 16, v37
    v_and_b32 v179, 0xffff0000, v37
    v_pk_fma_f32 v[168:169], v[168:169], v[14:15], v[12:13]
    v_pk_fma_f32 v[170:171], v[170:171], v[14:15], v[12:13]
    v_pk_fma_f32 v[176:177], v[176:177], v[18:19], v[16:17]
    v_pk_fma_f32 v[178:179], v[178:179], v[18:19], v[16:17]
    s_waitcnt lgkmcnt(2)
    v_pk_fma_f32 v[168:169], v[168:169], v[152:153], v[156:157]
    v_pk_fma_f32 v[170:171], v[170:171], v[154:155], v[158:159]
    v_pk_fma_f32 v[176:177], v[176:177], v[152:153], v[156:157]
    v_pk_fma_f32 v[178:179], v[178:179], v[154:155], v[158:159]
    v_cvt_pk_bf16_f32 v32, v168, v169
    v_cvt_pk_bf16_f32 v33, v170, v171
    v_cvt_pk_bf16_f32 v36, v176, v177
    v_cvt_pk_bf16_f32 v37, v178, v179
    ds_read_b128 v[152:155], v23 offset:2688
    ds_read_b128 v[156:159], v23 offset:128
    v_lshlrev_b32 v168, 16, v34
    v_and_b32 v169, 0xffff0000, v34
    v_lshlrev_b32 v170, 16, v35
    v_and_b32 v171, 0xffff0000, v35
    v_lshlrev_b32 v176, 16, v38
    v_and_b32 v177, 0xffff0000, v38
    v_lshlrev_b32 v178, 16, v39
    v_and_b32 v179, 0xffff0000, v39
    v_pk_fma_f32 v[168:169], v[168:169], v[14:15], v[12:13]
    v_pk_fma_f32 v[170:171], v[170:171], v[14:15], v[12:13]
    v_pk_fma_f32 v[176:177], v[176:177], v[18:19], v[16:17]
    v_pk_fma_f32 v[178:179], v[178:179], v[18:19], v[16:17]
    s_waitcnt lgkmcnt(2)
    v_pk_fma_f32 v[168:169], v[168:169], v[160:161], v[164:165]
    v_pk_fma_f32 v[170:171], v[170:171], v[162:163], v[166:167]
    v_pk_fma_f32 v[176:177], v[176:177], v[160:161], v[164:165]
    v_pk_fma_f32 v[178:179], v[178:179], v[162:163], v[166:167]
    v_cvt_pk_bf16_f32 v34, v168, v169
    v_cvt_pk_bf16_f32 v35, v170, v171
    v_cvt_pk_bf16_f32 v38, v176, v177
    v_cvt_pk_bf16_f32 v39, v178, v179
    ds_read_b128 v[160:163], v23 offset:2752
    ds_read_b128 v[164:167], v23 offset:192
    v_lshlrev_b32 v168, 16, v40
    v_and_b32 v169, 0xffff0000, v40
    v_lshlrev_b32 v170, 16, v41
    v_and_b32 v171, 0xffff0000, v41
    v_lshlrev_b32 v176, 16, v44
    v_and_b32 v177, 0xffff0000, v44
    v_lshlrev_b32 v178, 16, v45
    v_and_b32 v179, 0xffff0000, v45
    v_pk_fma_f32 v[168:169], v[168:169], v[14:15], v[12:13]
    v_pk_fma_f32 v[170:171], v[170:171], v[14:15], v[12:13]
    v_pk_fma_f32 v[176:177], v[176:177], v[18:19], v[16:17]
    v_pk_fma_f32 v[178:179], v[178:179], v[18:19], v[16:17]
    s_waitcnt lgkmcnt(2)
    v_pk_fma_f32 v[168:169], v[168:169], v[152:153], v[156:157]
    v_pk_fma_f32 v[170:171], v[170:171], v[154:155], v[158:159]
    v_pk_fma_f32 v[176:177], v[176:177], v[152:153], v[156:157]
    v_pk_fma_f32 v[178:179], v[178:179], v[154:155], v[158:159]
    v_cvt_pk_bf16_f32 v40, v168, v169
    v_cvt_pk_bf16_f32 v41, v170, v171
    v_cvt_pk_bf16_f32 v44, v176, v177
    v_cvt_pk_bf16_f32 v45, v178, v179
    v_mfma_f32_16x16x32_bf16 v[212:215], v[24:27], v[32:35], 0
    v_mfma_f32_16x16x32_bf16 v[216:219], v[32:35], v[32:35], 0
    v_mfma_f32_16x16x32_bf16 v[220:223], v[24:27], v[36:39], 0
    v_mfma_f32_16x16x32_bf16 v[224:227], v[36:39], v[36:39], 0
    ds_read_b128 v[152:155], v23 offset:2816
    ds_read_b128 v[156:159], v23 offset:256
    v_lshlrev_b32 v168, 16, v42
    v_and_b32 v169, 0xffff0000, v42
    v_lshlrev_b32 v170, 16, v43
    v_and_b32 v171, 0xffff0000, v43
    v_lshlrev_b32 v176, 16, v46
    v_and_b32 v177, 0xffff0000, v46
    v_lshlrev_b32 v178, 16, v47
    v_and_b32 v179, 0xffff0000, v47
    v_pk_fma_f32 v[168:169], v[168:169], v[14:15], v[12:13]
    v_pk_fma_f32 v[170:171], v[170:171], v[14:15], v[12:13]
    v_pk_fma_f32 v[176:177], v[176:177], v[18:19], v[16:17]
    v_pk_fma_f32 v[178:179], v[178:179], v[18:19], v[16:17]
    s_waitcnt lgkmcnt(2)
    v_pk_fma_f32 v[168:169], v[168:169], v[160:161], v[164:165]
    v_pk_fma_f32 v[170:171], v[170:171], v[162:163], v[166:167]
    v_pk_fma_f32 v[176:177], v[176:177], v[160:161], v[164:165]
    v_pk_fma_f32 v[178:179], v[178:179], v[162:163], v[166:167]
    v_cvt_pk_bf16_f32 v42, v168, v169
    v_cvt_pk_bf16_f32 v43, v170, v171
    v_cvt_pk_bf16_f32 v46, v176, v177
    v_cvt_pk_bf16_f32 v47, v178, v179
    ds_read_b128 v[160:163], v23 offset:2880
    ds_read_b128 v[164:167], v23 offset:320
    v_lshlrev_b32 v168, 16, v48
    v_and_b32 v169, 0xffff0000, v48
    v_lshlrev_b32 v170, 16, v49
    v_and_b32 v171, 0xffff0000, v49
    v_lshlrev_b32 v176, 16, v52
    v_and_b32 v177, 0xffff0000, v52
    v_lshlrev_b32 v178, 16, v53
    v_and_b32 v179, 0xffff0000, v53
    v_pk_fma_f32 v[168:169], v[168:169], v[14:15], v[12:13]
    v_pk_fma_f32 v[170:171], v[170:171], v[14:15], v[12:13]
    v_pk_fma_f32 v[176:177], v[176:177], v[18:19], v[16:17]
    v_pk_fma_f32 v[178:179], v[178:179], v[18:19], v[16:17]
    s_waitcnt lgkmcnt(2)
    v_pk_fma_f32 v[168:169], v[168:169], v[152:153], v[156:157]
    v_pk_fma_f32 v[170:171], v[170:171], v[154:155], v[158:159]
    v_pk_fma_f32 v[176:177], v[176:177], v[152:153], v[156:157]
    v_pk_fma_f32 v[178:179], v[178:179], v[154:155], v[158:159]
    v_cvt_pk_bf16_f32 v48, v168, v169
    v_cvt_pk_bf16_f32 v49, v170, v171
    v_cvt_pk_bf16_f32 v52, v176, v177
    v_cvt_pk_bf16_f32 v53, v178, v179
    v_mfma_f32_16x16x32_bf16 v[212:215], v[24:27], v[40:43], v[212:215]
    v_mfma_f32_16x16x32_bf16 v[216:219], v[40:43], v[40:43], v[216:219]
    v_mfma_f32_16x16x32_bf16 v[220:223], v[24:27], v[44:47], v[220:223]
    v_mfma_f32_16x16x32_bf16 v[224:227], v[44:47], v[44:47], v[224:227]
    ds_read_b128 v[152:155], v23 offset:2944
    ds_read_b128 v[156:159], v23 offset:384
    v_lshlrev_b32 v168, 16, v50
    v_and_b32 v169, 0xffff0000, v50
    v_lshlrev_b32 v170, 16, v51
    v_and_b32 v171, 0xffff0000, v51
    v_lshlrev_b32 v176, 16, v54
    v_and_b32 v177, 0xffff0000, v54
    v_lshlrev_b32 v178, 16, v55
    v_and_b32 v179, 0xffff0000, v55
    v_pk_fma_f32 v[168:169], v[168:169], v[14:15], v[12:13]
    v_pk_fma_f32 v[170:171], v[170:171], v[14:15], v[12:13]
    v_pk_fma_f32 v[176:177], v[176:177], v[18:19], v[16:17]
    v_pk_fma_f32 v[178:179], v[178:179], v[18:19], v[16:17]
    s_waitcnt lgkmcnt(2)
    v_pk_fma_f32 v[168:169], v[168:169], v[160:161], v[164:165]
    v_pk_fma_f32 v[170:171], v[170:171], v[162:163], v[166:167]
    v_pk_fma_f32 v[176:177], v[176:177], v[160:161], v[164:165]
    v_pk_fma_f32 v[178:179], v[178:179], v[162:163], v[166:167]
    v_cvt_pk_bf16_f32 v50, v168, v169
    v_cvt_pk_bf16_f32 v51, v170, v171
    v_cvt_pk_bf16_f32 v54, v176, v177
    v_cvt_pk_bf16_f32 v55, v178, v179
    ds_read_b128 v[160:163], v23 offset:3008
    ds_read_b128 v[164:167], v23 offset:448
    v_lshlrev_b32 v168, 16, v56
    v_and_b32 v169, 0xffff0000, v56
    v_lshlrev_b32 v170, 16, v57
    v_and_b32 v171, 0xffff0000, v57
    v_lshlrev_b32 v176, 16, v60
    v_and_b32 v177, 0xffff0000, v60
    v_lshlrev_b32 v178, 16, v61
    v_and_b32 v179, 0xffff0000, v61
    v_pk_fma_f32 v[168:169], v[168:169], v[14:15], v[12:13]
    v_pk_fma_f32 v[170:171], v[170:171], v[14:15], v[12:13]
    v_pk_fma_f32 v[176:177], v[176:177], v[18:19], v[16:17]
    v_pk_fma_f32 v[178:179], v[178:179], v[18:19], v[16:17]
    s_waitcnt lgkmcnt(2)
    v_pk_fma_f32 v[168:169], v[168:169], v[152:153], v[156:157]
    v_pk_fma_f32 v[170:171], v[170:171], v[154:155], v[158:159]
    v_pk_fma_f32 v[176:177], v[176:177], v[152:153], v[156:157]
    v_pk_fma_f32 v[178:179], v[178:179], v[154:155], v[158:159]
    v_cvt_pk_bf16_f32 v56, v168, v169
    v_cvt_pk_bf16_f32 v57, v170, v171
    v_cvt_pk_bf16_f32 v60, v176, v177
    v_cvt_pk_bf16_f32 v61, v178, v179
    v_mfma_f32_16x16x32_bf16 v[212:215], v[24:27], v[48:51], v[212:215]
    v_mfma_f32_16x16x32_bf16 v[216:219], v[48:51], v[48:51], v[216:219]
    v_mfma_f32_16x16x32_bf16 v[220:223], v[24:27], v[52:55], v[220:223]
    v_mfma_f32_16x16x32_bf16 v[224:227], v[52:55], v[52:55], v[224:227]
    ds_read_b128 v[152:155], v23 offset:3072
    ds_read_b128 v[156:159], v23 offset:512
    v_lshlrev_b32 v168, 16, v58
    v_and_b32 v169, 0xffff0000, v58
    v_lshlrev_b32 v170, 16, v59
    v_and_b32 v171, 0xffff0000, v59
    v_lshlrev_b32 v176, 16, v62
    v_and_b32 v177, 0xffff0000, v62
    v_lshlrev_b32 v178, 16, v63
    v_and_b32 v179, 0xffff0000, v63
    v_pk_fma_f32 v[168:169], v[168:169], v[14:15], v[12:13]
    v_pk_fma_f32 v[170:171], v[170:171], v[14:15], v[12:13]
    v_pk_fma_f32 v[176:177], v[176:177], v[18:19], v[16:17]
    v_pk_fma_f32 v[178:179], v[178:179], v[18:19], v[16:17]
    s_waitcnt lgkmcnt(2)
    v_pk_fma_f32 v[168:169], v[168:169], v[160:161], v[164:165]
    v_pk_fma_f32 v[170:171], v[170:171], v[162:163], v[166:167]
    v_pk_fma_f32 v[176:177], v[176:177], v[160:161], v[164:165]
    v_pk_fma_f32 v[178:179], v[178:179], v[162:163], v[166:167]
    v_cvt_pk_bf16_f32 v58, v168, v169
    v_cvt_pk_bf16_f32 v59, v170, v171
    v_cvt_pk_bf16_f32 v62, v176, v177
    v_cvt_pk_bf16_f32 v63, v178, v179
    ds_read_b128 v[160:163], v23 offset:3136
    ds_read_b128 v[164:167], v23 offset:576
    v_lshlrev_b32 v168, 16, v64
    v_and_b32 v169, 0xffff0000, v64
    v_lshlrev_b32 v170, 16, v65
    v_and_b32 v171, 0xffff0000, v65
    v_lshlrev_b32 v176, 16, v68
    v_and_b32 v177, 0xffff0000, v68
    v_lshlrev_b32 v178, 16, v69
    v_and_b32 v179, 0xffff0000, v69
    v_pk_fma_f32 v[168:169], v[168:169], v[14:15], v[12:13]
    v_pk_fma_f32 v[170:171], v[170:171], v[14:15], v[12:13]
    v_pk_fma_f32 v[176:177], v[176:177], v[18:19], v[16:17]
    v_pk_fma_f32 v[178:179], v[178:179], v[18:19], v[16:17]
    s_waitcnt lgkmcnt(2)
    v_pk_fma_f32 v[168:169], v[168:169], v[152:153], v[156:157]
    v_pk_fma_f32 v[170:171], v[170:171], v[154:155], v[158:159]
    v_pk_fma_f32 v[176:177], v[176:177], v[152:153], v[156:157]
    v_pk_fma_f32 v[178:179], v[178:179], v[154:155], v[158:159]
    v_cvt_pk_bf16_f32 v64, v168, v169
    v_cvt_pk_bf16_f32 v65, v170, v171
    v_cvt_pk_bf16_f32 v68, v176, v177
    v_cvt_pk_bf16_f32 v69, v178, v179
    v_mfma_f32_16x16x32_bf16 v[212:215], v[24:27], v[56:59], v[212:215]
    v_mfma_f32_16x16x32_bf16 v[216:219], v[56:59], v[56:59], v[216:219]
    v_mfma_f32_16x16x32_bf16 v[220:223], v[24:27], v[60:63], v[220:223]
    v_mfma_f32_16x16x32_bf16 v[224:227], v[60:63], v[60:63], v[224:227]
    ds_read_b128 v[152:155], v23 offset:3200
    ds_read_b128 v[156:159], v23 offset:640
    v_lshlrev_b32 v168, 16, v66
    v_and_b32 v169, 0xffff0000, v66
    v_lshlrev_b32 v170, 16, v67
    v_and_b32 v171, 0xffff0000, v67
    v_lshlrev_b32 v176, 16, v70
    v_and_b32 v177, 0xffff0000, v70
    v_lshlrev_b32 v178, 16, v71
    v_and_b32 v179, 0xffff0000, v71
    v_pk_fma_f32 v[168:169], v[168:169], v[14:15], v[12:13]
    v_pk_fma_f32 v[170:171], v[170:171], v[14:15], v[12:13]
    v_pk_fma_f32 v[176:177], v[176:177], v[18:19], v[16:17]
    v_pk_fma_f32 v[178:179], v[178:179], v[18:19], v[16:17]
    s_waitcnt lgkmcnt(2)
    v_pk_fma_f32 v[168:169], v[168:169], v[160:161], v[164:165]
    v_pk_fma_f32 v[170:171], v[170:171], v[162:163], v[166:167]
    v_pk_fma_f32 v[176:177], v[176:177], v[160:161], v[164:165]
    v_pk_fma_f32 v[178:179], v[178:179], v[162:163], v[166:167]
    v_cvt_pk_bf16_f32 v66, v168, v169
    v_cvt_pk_bf16_f32 v67, v170, v171
    v_cvt_pk_bf16_f32 v70, v176, v177
    v_cvt_pk_bf16_f32 v71, v178, v179
    ds_read_b128 v[160:163], v23 offset:3264
    ds_read_b128 v[164:167], v23 offset:704
    v_lshlrev_b32 v168, 16, v72
    v_and_b32 v169, 0xffff0000, v72
    v_lshlrev_b32 v170, 16, v73
    v_and_b32 v171, 0xffff0000, v73
    v_lshlrev_b32 v176, 16, v76
    v_and_b32 v177, 0xffff0000, v76
    v_lshlrev_b32 v178, 16, v77
    v_and_b32 v179, 0xffff0000, v77
    v_pk_fma_f32 v[168:169], v[168:169], v[14:15], v[12:13]
    v_pk_fma_f32 v[170:171], v[170:171], v[14:15], v[12:13]
    v_pk_fma_f32 v[176:177], v[176:177], v[18:19], v[16:17]
    v_pk_fma_f32 v[178:179], v[178:179], v[18:19], v[16:17]
    s_waitcnt lgkmcnt(2)
    v_pk_fma_f32 v[168:169], v[168:169], v[152:153], v[156:157]
    v_pk_fma_f32 v[170:171], v[170:171], v[154:155], v[158:159]
    v_pk_fma_f32 v[176:177], v[176:177], v[152:153], v[156:157]
    v_pk_fma_f32 v[178:179], v[178:179], v[154:155], v[158:159]
    v_cvt_pk_bf16_f32 v72, v168, v169
    v_cvt_pk_bf16_f32 v73, v170, v171
    v_cvt_pk_bf16_f32 v76, v176, v177
    v_cvt_pk_bf16_f32 v77, v178, v179
    v_mfma_f32_16x16x32_bf16 v[212:215], v[24:27], v[64:67], v[212:215]
    v_mfma_f32_16x16x32_bf16 v[216:219], v[64:67], v[64:67], v[216:219]
    v_mfma_f32_16x16x32_bf16 v[220:223], v[24:27], v[68:71], v[220:223]
    v_mfma_f32_16x16x32_bf16 v[224:227], v[68:71], v[68:71], v[224:227]
    ds_read_b128 v[152:155], v23 offset:3328
    ds_read_b128 v[156:159], v23 offset:768
    v_lshlrev_b32 v168, 16, v74
    v_and_b32 v169, 0xffff0000, v74
    v_lshlrev_b32 v170, 16, v75
    v_and_b32 v171, 0xffff0000, v75
    v_lshlrev_b32 v176, 16, v78
    v_and_b32 v177, 0xffff0000, v78
    v_lshlrev_b32 v178, 16, v79
    v_and_b32 v179, 0xffff0000, v79
    v_pk_fma_f32 v[168:169], v[168:169], v[14:15], v[12:13]
    v_pk_fma_f32 v[170:171], v[170:171], v[14:15], v[12:13]
    v_pk_fma_f32 v[176:177], v[176:177], v[18:19], v[16:17]
    v_pk_fma_f32 v[178:179], v[178:179], v[18:19], v[16:17]
    s_waitcnt lgkmcnt(2)
    v_pk_fma_f32 v[168:169], v[168:169], v[160:161], v[164:165]
    v_pk_fma_f32 v[170:171], v[170:171], v[162:163], v[166:167]
    v_pk_fma_f32 v[176:177], v[176:177], v[160:161], v[164:165]
    v_pk_fma_f32 v[178:179], v[178:179], v[162:163], v[166:167]
    v_cvt_pk_bf16_f32 v74, v168, v169
    v_cvt_pk_bf16_f32 v75, v170, v171
    v_cvt_pk_bf16_f32 v78, v176, v177
    v_cvt_pk_bf16_f32 v79, v178, v179
    ds_read_b128 v[160:163], v23 offset:3392
    ds_read_b128 v[164:167], v23 offset:832
    v_lshlrev_b32 v168, 16, v80
    v_and_b32 v169, 0xffff0000, v80
    v_lshlrev_b32 v170, 16, v81
    v_and_b32 v171, 0xffff0000, v81
    v_lshlrev_b32 v176, 16, v84
    v_and_b32 v177, 0xffff0000, v84
    v_lshlrev_b32 v178, 16, v85
    v_and_b32 v179, 0xffff0000, v85
    v_pk_fma_f32 v[168:169], v[168:169], v[14:15], v[12:13]
    v_pk_fma_f32 v[170:171], v[170:171], v[14:15], v[12:13]
    v_pk_fma_f32 v[176:177], v[176:177], v[18:19], v[16:17]
    v_pk_fma_f32 v[178:179], v[178:179], v[18:19], v[16:17]
    s_waitcnt lgkmcnt(2)
    v_pk_fma_f32 v[168:169], v[168:169], v[152:153], v[156:157]
    v_pk_fma_f32 v[170:171], v[170:171], v[154:155], v[158:159]
    v_pk_fma_f32 v[176:177], v[176:177], v[152:153], v[156:157]
    v_pk_fma_f32 v[178:179], v[178:179], v[154:155], v[158:159]
    v_cvt_pk_bf16_f32 v80, v168, v169
    v_cvt_pk_bf16_f32 v81, v170, v171
    v_cvt_pk_bf16_f32 v84, v176, v177
    v_cvt_pk_bf16_f32 v85, v178, v179
    v_mfma_f32_16x16x32_bf16 v[212:215], v[24:27], v[72:75], v[212:215]
    v_mfma_f32_16x16x32_bf16 v[216:219], v[72:75], v[72:75], v[216:219]
    v_mfma_f32_16x16x32_bf16 v[220:223], v[24:27], v[76:79], v[220:223]
    v_mfma_f32_16x16x32_bf16 v[224:227], v[76:79], v[76:79], v[224:227]
    ds_read_b128 v[152:155], v23 offset:3456
    ds_read_b128 v[156:159], v23 offset:896
    v_lshlrev_b32 v168, 16, v82
    v_and_b32 v169, 0xffff0000, v82
    v_lshlrev_b32 v170, 16, v83
    v_and_b32 v171, 0xffff0000, v83
    v_lshlrev_b32 v176, 16, v86
    v_and_b32 v177, 0xffff0000, v86
    v_lshlrev_b32 v178, 16, v87
    v_and_b32 v179, 0xffff0000, v87
    v_pk_fma_f32 v[168:169], v[168:169], v[14:15], v[12:13]
    v_pk_fma_f32 v[170:171], v[170:171], v[14:15], v[12:13]
    v_pk_fma_f32 v[176:177], v[176:177], v[18:19], v[16:17]
    v_pk_fma_f32 v[178:179], v[178:179], v[18:19], v[16:17]
    s_waitcnt lgkmcnt(2)
    v_pk_fma_f32 v[168:169], v[168:169], v[160:161], v[164:165]
    v_pk_fma_f32 v[170:171], v[170:171], v[162:163], v[166:167]
    v_pk_fma_f32 v[176:177], v[176:177], v[160:161], v[164:165]
    v_pk_fma_f32 v[178:179], v[178:179], v[162:163], v[166:167]
    v_cvt_pk_bf16_f32 v82, v168, v169
    v_cvt_pk_bf16_f32 v83, v170, v171
    v_cvt_pk_bf16_f32 v86, v176, v177
    v_cvt_pk_bf16_f32 v87, v178, v179
    ds_read_b128 v[160:163], v23 offset:3520
    ds_read_b128 v[164:167], v23 offset:960
    v_lshlrev_b32 v168, 16, v88
    v_and_b32 v169, 0xffff0000, v88
    v_lshlrev_b32 v170, 16, v89
    v_and_b32 v171, 0xffff0000, v89
    v_lshlrev_b32 v176, 16, v92
    v_and_b32 v177, 0xffff0000, v92
    v_lshlrev_b32 v178, 16, v93
    v_and_b32 v179, 0xffff0000, v93
    v_pk_fma_f32 v[168:169], v[168:169], v[14:15], v[12:13]
    v_pk_fma_f32 v[170:171], v[170:171], v[14:15], v[12:13]
    v_pk_fma_f32 v[176:177], v[176:177], v[18:19], v[16:17]
    v_pk_fma_f32 v[178:179], v[178:179], v[18:19], v[16:17]
    s_waitcnt lgkmcnt(2)
    v_pk_fma_f32 v[168:169], v[168:169], v[152:153], v[156:157]
    v_pk_fma_f32 v[170:171], v[170:171], v[154:155], v[158:159]
    v_pk_fma_f32 v[176:177], v[176:177], v[152:153], v[156:157]
    v_pk_fma_f32 v[178:179], v[178:179], v[154:155], v[158:159]
    v_cvt_pk_bf16_f32 v88, v168, v169
    v_cvt_pk_bf16_f32 v89, v170, v171
    v_cvt_pk_bf16_f32 v92, v176, v177
    v_cvt_pk_bf16_f32 v93, v178, v179
    v_mfma_f32_16x16x32_bf16 v[212:215], v[24:27], v[80:83], v[212:215]
    v_mfma_f32_16x16x32_bf16 v[216:219], v[80:83], v[80:83], v[216:219]
    v_mfma_f32_16x16x32_bf16 v[220:223], v[24:27], v[84:87], v[220:223]
    v_mfma_f32_16x16x32_bf16 v[224:227], v[84:87], v[84:87], v[224:227]
    ds_read_b128 v[152:155], v23 offset:3584
    ds_read_b128 v[156:159], v23 offset:1024
    v_lshlrev_b32 v168, 16, v90
    v_and_b32 v169, 0xffff0000, v90
    v_lshlrev_b32 v170, 16, v91
    v_and_b32 v171, 0xffff0000, v91
    v_lshlrev_b32 v176, 16, v94
    v_and_b32 v177, 0xffff0000, v94
    v_lshlrev_b32 v178, 16, v95
    v_and_b32 v179, 0xffff0000, v95
    v_pk_fma_f32 v[168:169], v[168:169], v[14:15], v[12:13]
    v_pk_fma_f32 v[170:171], v[170:171], v[14:15], v[12:13]
    v_pk_fma_f32 v[176:177], v[176:177], v[18:19], v[16:17]
    v_pk_fma_f32 v[178:179], v[178:179], v[18:19], v[16:17]
    s_waitcnt lgkmcnt(2)
    v_pk_fma_f32 v[168:169], v[168:169], v[160:161], v[164:165]
    v_pk_fma_f32 v[170:171], v[170:171], v[162:163], v[166:167]
    v_pk_fma_f32 v[176:177], v[176:177], v[160:161], v[164:165]
    v_pk_fma_f32 v[178:179], v[178:179], v[162:163], v[166:167]
    v_cvt_pk_bf16_f32 v90, v168, v169
    v_cvt_pk_bf16_f32 v91, v170, v171
    v_cvt_pk_bf16_f32 v94, v176, v177
    v_cvt_pk_bf16_f32 v95, v178, v179
    ds_read_b128 v[160:163], v23 offset:3648
    ds_read_b128 v[164:167], v23 offset:1088
    v_lshlrev_b32 v168, 16, v96
    v_and_b32 v169, 0xffff0000, v96
    v_lshlrev_b32 v170, 16, v97
    v_and_b32 v171, 0xffff0000, v97
    v_lshlrev_b32 v176, 16, v100
    v_and_b32 v177, 0xffff0000, v100
    v_lshlrev_b32 v178, 16, v101
    v_and_b32 v179, 0xffff0000, v101
    v_pk_fma_f32 v[168:169], v[168:169], v[14:15], v[12:13]
    v_pk_fma_f32 v[170:171], v[170:171], v[14:15], v[12:13]
    v_pk_fma_f32 v[176:177], v[176:177], v[18:19], v[16:17]
    v_pk_fma_f32 v[178:179], v[178:179], v[18:19], v[16:17]
    s_waitcnt lgkmcnt(2)
    v_pk_fma_f32 v[168:169], v[168:169], v[152:153], v[156:157]
    v_pk_fma_f32 v[170:171], v[170:171], v[154:155], v[158:159]
    v_pk_fma_f32 v[176:177], v[176:177], v[152:153], v[156:157]
    v_pk_fma_f32 v[178:179], v[178:179], v[154:155], v[158:159]
    v_cvt_pk_bf16_f32 v96, v168, v169
    v_cvt_pk_bf16_f32 v97, v170, v171
    v_cvt_pk_bf16_f32 v100, v176, v177
    v_cvt_pk_bf16_f32 v101, v178, v179
    v_mfma_f32_16x16x32_bf16 v[212:215], v[24:27], v[88:91], v[212:215]
    v_mfma_f32_16x16x32_bf16 v[216:219], v[88:91], v[88:91], v[216:219]
    v_mfma_f32_16x16x32_bf16 v[220:223], v[24:27], v[92:95], v[220:223]
    v_mfma_f32_16x16x32_bf16 v[224:227], v[92:95], v[92:95], v[224:227]
    ds_read_b128 v[152:155], v23 offset:3712
    ds_read_b128 v[156:159], v23 offset:1152
    v_lshlrev_b32 v168, 16, v98
    v_and_b32 v169, 0xffff0000, v98
    v_lshlrev_b32 v170, 16, v99
    v_and_b32 v171, 0xffff0000, v99
    v_lshlrev_b32 v176, 16, v102
    v_and_b32 v177, 0xffff0000, v102
    v_lshlrev_b32 v178, 16, v103
    v_and_b32 v179, 0xffff0000, v103
    v_pk_fma_f32 v[168:169], v[168:169], v[14:15], v[12:13]
    v_pk_fma_f32 v[170:171], v[170:171], v[14:15], v[12:13]
    v_pk_fma_f32 v[176:177], v[176:177], v[18:19], v[16:17]
    v_pk_fma_f32 v[178:179], v[178:179], v[18:19], v[16:17]
    s_waitcnt lgkmcnt(2)
    v_pk_fma_f32 v[168:169], v[168:169], v[160:161], v[164:165]
    v_pk_fma_f32 v[170:171], v[170:171], v[162:163], v[166:167]
    v_pk_fma_f32 v[176:177], v[176:177], v[160:161], v[164:165]
    v_pk_fma_f32 v[178:179], v[178:179], v[162:163], v[166:167]
    v_cvt_pk_bf16_f32 v98, v168, v169
    v_cvt_pk_bf16_f32 v99, v170, v171
    v_cvt_pk_bf16_f32 v102, v176, v177
    v_cvt_pk_bf16_f32 v103, v178, v179
    ds_read_b128 v[160:163], v23 offset:3776
    ds_read_b128 v[164:167], v23 offset:1216
    v_lshlrev_b32 v168, 16, v104
    v_and_b32 v169, 0xffff0000, v104
    v_lshlrev_b32 v170, 16, v105
    v_and_b32 v171, 0xffff0000, v105
    v_lshlrev_b32 v176, 16, v108
    v_and_b32 v177, 0xffff0000, v108
    v_lshlrev_b32 v178, 16, v109
    v_and_b32 v179, 0xffff0000, v109
    v_pk_fma_f32 v[168:169], v[168:169], v[14:15], v[12:13]
    v_pk_fma_f32 v[170:171], v[170:171], v[14:15], v[12:13]
    v_pk_fma_f32 v[176:177], v[176:177], v[18:19], v[16:17]
    v_pk_fma_f32 v[178:179], v[178:179], v[18:19], v[16:17]
    s_waitcnt lgkmcnt(2)
    v_pk_fma_f32 v[168:169], v[168:169], v[152:153], v[156:157]
    v_pk_fma_f32 v[170:171], v[170:171], v[154:155], v[158:159]
    v_pk_fma_f32 v[176:177], v[176:177], v[152:153], v[156:157]
    v_pk_fma_f32 v[178:179], v[178:179], v[154:155], v[158:159]
    v_cvt_pk_bf16_f32 v104, v168, v169
    v_cvt_pk_bf16_f32 v105, v170, v171
    v_cvt_pk_bf16_f32 v108, v176, v177
    v_cvt_pk_bf16_f32 v109, v178, v179
    v_mfma_f32_16x16x32_bf16 v[212:215], v[24:27], v[96:99], v[212:215]
    v_mfma_f32_16x16x32_bf16 v[216:219], v[96:99], v[96:99], v[216:219]
    v_mfma_f32_16x16x32_bf16 v[220:223], v[24:27], v[100:103], v[220:223]
    v_mfma_f32_16x16x32_bf16 v[224:227], v[100:103], v[100:103], v[224:227]
    v_lshlrev_b32 v168, 16, v106
    v_and_b32 v169, 0xffff0000, v106
    v_lshlrev_b32 v170, 16, v107
    v_and_b32 v171, 0xffff0000, v107
    v_lshlrev_b32 v176, 16, v110
    v_and_b32 v177, 0xffff0000, v110
    v_lshlrev_b32 v178, 16, v111
    v_and_b32 v179, 0xffff0000, v111
    v_pk_fma_f32 v[168:169], v[168:169], v[14:15], v[12:13]
    v_pk_fma_f32 v[170:171], v[170:171], v[14:15], v[12:13]
    v_pk_fma_f32 v[176:177], v[176:177], v[18:19], v[16:17]
    v_pk_fma_f32 v[178:179], v[178:179], v[18:19], v[16:17]
    s_waitcnt lgkmcnt(0)
    v_pk_fma_f32 v[168:169], v[168:169], v[160:161], v[164:165]
    v_pk_fma_f32 v[170:171], v[170:171], v[162:163], v[166:167]
    v_pk_fma_f32 v[176:177], v[176:177], v[160:161], v[164:165]
    v_pk_fma_f32 v[178:179], v[178:179], v[162:163], v[166:167]
    v_cvt_pk_bf16_f32 v106, v168, v169
    v_cvt_pk_bf16_f32 v107, v170, v171
    v_cvt_pk_bf16_f32 v110, v176, v177
    v_cvt_pk_bf16_f32 v111, v178, v179
    s_nop 4
    v_mfma_f32_16x16x32_bf16 v[212:215], v[24:27], v[104:107], v[212:215]
    v_mfma_f32_16x16x32_bf16 v[216:219], v[104:107], v[104:107], v[216:219]
    v_mfma_f32_16x16x32_bf16 v[220:223], v[24:27], v[108:111], v[220:223]
    v_mfma_f32_16x16x32_bf16 v[224:227], v[108:111], v[108:111], v[224:227]
    v_lshlrev_b32 v11, 4, v3
    s_mul_i32 s27, s21, 320
    s_add_u32 s27, s27, 65536
    buffer_load_dwordx4 v[232:235], v11, s[16:19], s27 offen offset:0
    buffer_load_dwordx4 v[236:239], v11, s[16:19], s27 offen offset:64
    buffer_load_dwordx4 v[240:243], v11, s[16:19], s27 offen offset:128
    buffer_load_dwordx4 v[244:247], v11, s[16:19], s27 offen offset:192
    buffer_load_dwordx4 v[248:251], v11, s[16:19], s27 offen offset:256
    s_add_u32 s36, s4, 13631488
    s_addc_u32 s37, s5, 0
    s_mov_b32 s38, 2652160
    s_mov_b32 s39, 0x00020000
    s_lshr_b32 s27, s21, 2
    s_cmp_lg_u32 s27, s23
    s_cbranch_scc1 K3_h2done
    v_lshrrev_b32 v11, 3, v2
    s_and_b32 s27, s21, 1
    v_cmp_eq_u32 vcc, s27, v11
    s_and_saveexec_b64 s[42:43], vcc
    s_mul_i32 s26, s24, 1326080
    s_bitcmp1_b32 s21, 1
    s_cbranch_scc1 K3_h2b
    buffer_store_dwordx4 v[32:35], v5, s[36:39], s26 offen offset:0 sc1
    s_add_u32 s26, s26, 132608
    buffer_store_dwordx4 v[40:43], v5, s[36:39], s26 offen offset:0 sc1
    s_add_u32 s26, s26, 132608
    buffer_store_dwordx4 v[48:51], v5, s[36:39], s26 offen offset:0 sc1
    s_add_u32 s26, s26, 132608
    buffer_store_dwordx4 v[56:59], v5, s[36:39], s26 offen offset:0 sc1
    s_add_u32 s26, s26, 132608
    buffer_store_dwordx4 v[64:67], v5, s[36:39], s26 offen offset:0 sc1
    s_add_u32 s26, s26, 132608
    buffer_store_dwordx4 v[72:75], v5, s[36:39], s26 offen offset:0 sc1
    s_add_u32 s26, s26, 132608
    buffer_store_dwordx4 v[80:83], v5, s[36:39], s26 offen offset:0 sc1
    s_add_u32 s26, s26, 132608
    buffer_store_dwordx4 v[88:91], v5, s[36:39], s26 offen offset:0 sc1
    s_add_u32 s26, s26, 132608
    buffer_store_dwordx4 v[96:99], v5, s[36:39], s26 offen offset:0 sc1
    s_add_u32 s26, s26, 132608
    buffer_store_dwordx4 v[104:107], v5, s[36:39], s26 offen offset:0 sc1
    s_add_u32 s26, s26, 132608
    s_branch K3_h2c
K3_h2b:
    buffer_store_dwordx4 v[36:39], v5, s[36:39], s26 offen offset:256 sc1
    s_add_u32 s26, s26, 132608
    buffer_store_dwordx4 v[44:47], v5, s[36:39], s26 offen offset:256 sc1
    s_add_u32 s26, s26, 132608
    buffer_store_dwordx4 v[52:55], v5, s[36:39], s26 offen offset:256 sc1
    s_add_u32 s26, s26, 132608
    buffer_store_dwordx4 v[60:63], v5, s[36:39], s26 offen offset:256 sc1
    s_add_u32 s26, s26, 132608
    buffer_store_dwordx4 v[68:71], v5, s[36:39], s26 offen offset:256 sc1
    s_add_u32 s26, s26, 132608
    buffer_store_dwordx4 v[76:79], v5, s[36:39], s26 offen offset:256 sc1
    s_add_u32 s26, s26, 132608
    buffer_store_dwordx4 v[84:87], v5, s[36:39], s26 offen offset:256 sc1
    s_add_u32 s26, s26, 132608
    buffer_store_dwordx4 v[92:95], v5, s[36:39], s26 offen offset:256 sc1
    s_add_u32 s26, s26, 132608
    buffer_store_dwordx4 v[100:103], v5, s[36:39], s26 offen offset:256 sc1
    s_add_u32 s26, s26, 132608
    buffer_store_dwordx4 v[108:111], v5, s[36:39], s26 offen offset:256 sc1
    s_add_u32 s26, s26, 132608
K3_h2c:
    s_mov_b64 exec, s[42:43]
K3_h2done:
    s_mul_i32 s27, s24, 51200
    v_add_u32 v4, s27, v4
    s_nop 7
    s_nop 7
    v_cndmask_b32 v213, v216, v217, s[52:53]
    v_cndmask_b32 v213, v213, v218, s[54:55]
    v_cndmask_b32 v213, v213, v219, s[56:57]
    s_mov_b64 exec, s[50:51]
    ds_write_b64 v21, v[212:213] offset:1024
    s_mov_b64 exec, -1
    v_cndmask_b32 v221, v224, v225, s[52:53]
    v_cndmask_b32 v221, v221, v226, s[54:55]
    v_cndmask_b32 v221, v221, v227, s[56:57]
    s_mov_b64 exec, s[50:51]
    ds_write_b64 v21, v[220:221] offset:1280
    s_mov_b64 exec, -1
    s_waitcnt lgkmcnt(0)
    s_barrier
    ds_read_b128 v[152:155], v4 offset:0
    ds_read_b128 v[156:159], v4 offset:1024
    ds_read_b128 v[160:163], v4 offset:2048
    ds_read_b128 v[164:167], v4 offset:3072
    ds_read_b128 v[168:171], v4 offset:4096
    s_waitcnt lgkmcnt(0)
    v_mfma_f32_16x16x32_bf16 v[112:115], v[152:155], v[32:35], 0
    ds_read_b128 v[172:175], v4 offset:5120
    v_mfma_f32_16x16x32_bf16 v[132:135], v[152:155], v[36:39], 0
    ds_read_b128 v[176:179], v4 offset:6144
    v_mfma_f32_16x16x32_bf16 v[116:119], v[156:159], v[32:35], 0
    ds_read_b128 v[180:183], v4 offset:7168
    v_mfma_f32_16x16x32_bf16 v[136:139], v[156:159], v[36:39], 0
    ds_read_b128 v[184:187], v4 offset:8192
    v_mfma_f32_16x16x32_bf16 v[120:123], v[160:163], v[32:35], 0
    ds_read_b128 v[188:191], v4 offset:9216
    v_mfma_f32_16x16x32_bf16 v[140:143], v[160:163], v[36:39], 0
    v_mfma_f32_16x16x32_bf16 v[124:127], v[164:167], v[32:35], 0
    v_mfma_f32_16x16x32_bf16 v[144:147], v[164:167], v[36:39], 0
    v_mfma_f32_16x16x32_bf16 v[128:131], v[168:171], v[32:35], 0
    v_mfma_f32_16x16x32_bf16 v[148:151], v[168:171], v[36:39], 0
    s_waitcnt lgkmcnt(0)
    s_barrier
    v_mfma_f32_16x16x32_bf16 v[112:115], v[172:175], v[40:43], v[112:115]
    ds_read_b128 v[152:155], v4 offset:10240
    v_mfma_f32_16x16x32_bf16 v[132:135], v[172:175], v[44:47], v[132:135]
    ds_read_b128 v[156:159], v4 offset:11264
    v_mfma_f32_16x16x32_bf16 v[116:119], v[176:179], v[40:43], v[116:119]
    ds_read_b128 v[160:163], v4 offset:12288
    v_mfma_f32_16x16x32_bf16 v[136:139], v[176:179], v[44:47], v[136:139]
    ds_read_b128 v[164:167], v4 offset:13312
    v_mfma_f32_16x16x32_bf16 v[120:123], v[180:183], v[40:43], v[120:123]
    ds_read_b128 v[168:171], v4 offset:14336
    v_mfma_f32_16x16x32_bf16 v[140:143], v[180:183], v[44:47], v[140:143]
    v_mfma_f32_16x16x32_bf16 v[124:127], v[184:187], v[40:43], v[124:127]
    v_mfma_f32_16x16x32_bf16 v[144:147], v[184:187], v[44:47], v[144:147]
    v_mfma_f32_16x16x32_bf16 v[128:131], v[188:191], v[40:43], v[128:131]
    v_mfma_f32_16x16x32_bf16 v[148:151], v[188:191], v[44:47], v[148:151]
    s_waitcnt lgkmcnt(0)
    v_mfma_f32_16x16x32_bf16 v[112:115], v[152:155], v[48:51], v[112:115]
    ds_read_b128 v[172:175], v4 offset:15360
    v_mfma_f32_16x16x32_bf16 v[132:135], v[152:155], v[52:55], v[132:135]
    ds_read_b128 v[176:179], v4 offset:16384
    v_mfma_f32_16x16x32_bf16 v[116:119], v[156:159], v[48:51], v[116:119]
    ds_read_b128 v[180:183], v4 offset:17408
    v_mfma_f32_16x16x32_bf16 v[136:139], v[156:159], v[52:55], v[136:139]
    ds_read_b128 v[184:187], v4 offset:18432
    v_mfma_f32_16x16x32_bf16 v[120:123], v[160:163], v[48:51], v[120:123]
    ds_read_b128 v[188:191], v4 offset:19456
    v_mfma_f32_16x16x32_bf16 v[140:143], v[160:163], v[52:55], v[140:143]
    v_mfma_f32_16x16x32_bf16 v[124:127], v[164:167], v[48:51], v[124:127]
    v_mfma_f32_16x16x32_bf16 v[144:147], v[164:167], v[52:55], v[144:147]
    v_mfma_f32_16x16x32_bf16 v[128:131], v[168:171], v[48:51], v[128:131]
    v_mfma_f32_16x16x32_bf16 v[148:151], v[168:171], v[52:55], v[148:151]
    s_waitcnt lgkmcnt(0)
    s_barrier
    v_mfma_f32_16x16x32_bf16 v[112:115], v[172:175], v[56:59], v[112:115]
    ds_read_b128 v[152:155], v4 offset:20480
    v_mfma_f32_16x16x32_bf16 v[132:135], v[172:175], v[60:63], v[132:135]
    ds_read_b128 v[156:159], v4 offset:21504
    v_mfma_f32_16x16x32_bf16 v[116:119], v[176:179], v[56:59], v[116:119]
    ds_read_b128 v[160:163], v4 offset:22528
    v_mfma_f32_16x16x32_bf16 v[136:139], v[176:179], v[60:63], v[136:139]
    ds_read_b128 v[164:167], v4 offset:23552
    v_mfma_f32_16x16x32_bf16 v[120:123], v[180:183], v[56:59], v[120:123]
    ds_read_b128 v[168:171], v4 offset:24576
    v_mfma_f32_16x16x32_bf16 v[140:143], v[180:183], v[60:63], v[140:143]
    v_mfma_f32_16x16x32_bf16 v[124:127], v[184:187], v[56:59], v[124:127]
    v_mfma_f32_16x16x32_bf16 v[144:147], v[184:187], v[60:63], v[144:147]
    v_mfma_f32_16x16x32_bf16 v[128:131], v[188:191], v[56:59], v[128:131]
    v_mfma_f32_16x16x32_bf16 v[148:151], v[188:191], v[60:63], v[148:151]
    s_waitcnt lgkmcnt(0)
    v_mfma_f32_16x16x32_bf16 v[112:115], v[152:155], v[64:67], v[112:115]
    ds_read_b128 v[172:175], v4 offset:25600
    v_mfma_f32_16x16x32_bf16 v[132:135], v[152:155], v[68:71], v[132:135]
    ds_read_b128 v[176:179], v4 offset:26624
    v_mfma_f32_16x16x32_bf16 v[116:119], v[156:159], v[64:67], v[116:119]
    ds_read_b128 v[180:183], v4 offset:27648
    v_mfma_f32_16x16x32_bf16 v[136:139], v[156:159], v[68:71], v[136:139]
    ds_read_b128 v[184:187], v4 offset:28672
    v_mfma_f32_16x16x32_bf16 v[120:123], v[160:163], v[64:67], v[120:123]
    ds_read_b128 v[188:191], v4 offset:29696
    v_mfma_f32_16x16x32_bf16 v[140:143], v[160:163], v[68:71], v[140:143]
    v_mfma_f32_16x16x32_bf16 v[124:127], v[164:167], v[64:67], v[124:127]
    v_mfma_f32_16x16x32_bf16 v[144:147], v[164:167], v[68:71], v[144:147]
    v_mfma_f32_16x16x32_bf16 v[128:131], v[168:171], v[64:67], v[128:131]
    v_mfma_f32_16x16x32_bf16 v[148:151], v[168:171], v[68:71], v[148:151]
    s_waitcnt lgkmcnt(0)
    s_barrier
    v_mfma_f32_16x16x32_bf16 v[112:115], v[172:175], v[72:75], v[112:115]
    ds_read_b128 v[152:155], v4 offset:30720
    v_mfma_f32_16x16x32_bf16 v[132:135], v[172:175], v[76:79], v[132:135]
    ds_read_b128 v[156:159], v4 offset:31744
    v_mfma_f32_16x16x32_bf16 v[116:119], v[176:179], v[72:75], v[116:119]
    ds_read_b128 v[160:163], v4 offset:32768
    v_mfma_f32_16x16x32_bf16 v[136:139], v[176:179], v[76:79], v[136:139]
    ds_read_b128 v[164:167], v4 offset:33792
    v_mfma_f32_16x16x32_bf16 v[120:123], v[180:183], v[72:75], v[120:123]
    ds_read_b128 v[168:171], v4 offset:34816
    v_mfma_f32_16x16x32_bf16 v[140:143], v[180:183], v[76:79], v[140:143]
    v_mfma_f32_16x16x32_bf16 v[124:127], v[184:187], v[72:75], v[124:127]
    v_mfma_f32_16x16x32_bf16 v[144:147], v[184:187], v[76:79], v[144:147]
    v_mfma_f32_16x16x32_bf16 v[128:131], v[188:191], v[72:75], v[128:131]
    v_mfma_f32_16x16x32_bf16 v[148:151], v[188:191], v[76:79], v[148:151]
    s_waitcnt lgkmcnt(0)
    v_mfma_f32_16x16x32_bf16 v[112:115], v[152:155], v[80:83], v[112:115]
    ds_read_b128 v[172:175], v4 offset:35840
    v_mfma_f32_16x16x32_bf16 v[132:135], v[152:155], v[84:87], v[132:135]
    ds_read_b128 v[176:179], v4 offset:36864
    v_mfma_f32_16x16x32_bf16 v[116:119], v[156:159], v[80:83], v[116:119]
    ds_read_b128 v[180:183], v4 offset:37888
    v_mfma_f32_16x16x32_bf16 v[136:139], v[156:159], v[84:87], v[136:139]
    ds_read_b128 v[184:187], v4 offset:38912
    v_mfma_f32_16x16x32_bf16 v[120:123], v[160:163], v[80:83], v[120:123]
    ds_read_b128 v[188:191], v4 offset:39936
    v_mfma_f32_16x16x32_bf16 v[140:143], v[160:163], v[84:87], v[140:143]
    v_mfma_f32_16x16x32_bf16 v[124:127], v[164:167], v[80:83], v[124:127]
    v_mfma_f32_16x16x32_bf16 v[144:147], v[164:167], v[84:87], v[144:147]
    v_mfma_f32_16x16x32_bf16 v[128:131], v[168:171], v[80:83], v[128:131]
    v_mfma_f32_16x16x32_bf16 v[148:151], v[168:171], v[84:87], v[148:151]
    s_waitcnt lgkmcnt(0)
    s_barrier
    v_mfma_f32_16x16x32_bf16 v[112:115], v[172:175], v[88:91], v[112:115]
    ds_read_b128 v[152:155], v4 offset:40960
    v_mfma_f32_16x16x32_bf16 v[132:135], v[172:175], v[92:95], v[132:135]
    ds_read_b128 v[156:159], v4 offset:41984
    v_mfma_f32_16x16x32_bf16 v[116:119], v[176:179], v[88:91], v[116:119]
    ds_read_b128 v[160:163], v4 offset:43008
    v_mfma_f32_16x16x32_bf16 v[136:139], v[176:179], v[92:95], v[136:139]
    ds_read_b128 v[164:167], v4 offset:44032
    v_mfma_f32_16x16x32_bf16 v[120:123], v[180:183], v[88:91], v[120:123]
    ds_read_b128 v[168:171], v4 offset:45056
    v_mfma_f32_16x16x32_bf16 v[140:143], v[180:183], v[92:95], v[140:143]
    v_mfma_f32_16x16x32_bf16 v[124:127], v[184:187], v[88:91], v[124:127]
    v_mfma_f32_16x16x32_bf16 v[144:147], v[184:187], v[92:95], v[144:147]
    v_mfma_f32_16x16x32_bf16 v[128:131], v[188:191], v[88:91], v[128:131]
    v_mfma_f32_16x16x32_bf16 v[148:151], v[188:191], v[92:95], v[148:151]
    s_waitcnt lgkmcnt(0)
    v_mfma_f32_16x16x32_bf16 v[112:115], v[152:155], v[96:99], v[112:115]
    ds_read_b128 v[172:175], v4 offset:46080
    v_mfma_f32_16x16x32_bf16 v[132:135], v[152:155], v[100:103], v[132:135]
    ds_read_b128 v[176:179], v4 offset:47104
    v_mfma_f32_16x16x32_bf16 v[116:119], v[156:159], v[96:99], v[116:119]
    ds_read_b128 v[180:183], v4 offset:48128
    v_mfma_f32_16x16x32_bf16 v[136:139], v[156:159], v[100:103], v[136:139]
    ds_read_b128 v[184:187], v4 offset:49152
    v_mfma_f32_16x16x32_bf16 v[120:123], v[160:163], v[96:99], v[120:123]
    ds_read_b128 v[188:191], v4 offset:50176
    v_mfma_f32_16x16x32_bf16 v[140:143], v[160:163], v[100:103], v[140:143]
    v_mfma_f32_16x16x32_bf16 v[124:127], v[164:167], v[96:99], v[124:127]
    v_mfma_f32_16x16x32_bf16 v[144:147], v[164:167], v[100:103], v[144:147]
    v_mfma_f32_16x16x32_bf16 v[128:131], v[168:171], v[96:99], v[128:131]
    v_mfma_f32_16x16x32_bf16 v[148:151], v[168:171], v[100:103], v[148:151]
    s_waitcnt lgkmcnt(0)
    s_barrier
    v_mfma_f32_16x16x32_bf16 v[112:115], v[172:175], v[104:107], v[112:115]
    v_mfma_f32_16x16x32_bf16 v[132:135], v[172:175], v[108:111], v[132:135]
    v_mfma_f32_16x16x32_bf16 v[116:119], v[176:179], v[104:107], v[116:119]
    v_mfma_f32_16x16x32_bf16 v[136:139], v[176:179], v[108:111], v[136:139]
    v_mfma_f32_16x16x32_bf16 v[120:123], v[180:183], v[104:107], v[120:123]
    v_mfma_f32_16x16x32_bf16 v[140:143], v[180:183], v[108:111], v[140:143]
    v_mfma_f32_16x16x32_bf16 v[124:127], v[184:187], v[104:107], v[124:127]
    v_mfma_f32_16x16x32_bf16 v[144:147], v[184:187], v[108:111], v[144:147]
    v_mfma_f32_16x16x32_bf16 v[128:131], v[188:191], v[104:107], v[128:131]
    v_mfma_f32_16x16x32_bf16 v[148:151], v[188:191], v[108:111], v[148:151]
    v_lshlrev_b32 v12, 4, v1
    s_lshl_b32 s27, s23, 1
    s_add_u32 s28, s27, s24
    s_mul_i32 s28, s28, 5120
    s_add_u32 s28, s28, 102400
    v_add_u32 v13, s28, v12
    s_xor_b32 s29, s24, 1
    s_add_u32 s28, s27, s29
    s_mul_i32 s28, s28, 5120
    s_add_u32 s28, s28, 102400
    v_add_u32 v12, s28, v12
    s_nop 4
    s_cmp_eq_u32 s24, 0
    s_cbranch_scc0 K3_b
    ds_write_b128 v13, v[132:135] offset:0
    ds_write_b128 v13, v[136:139] offset:1024
    ds_write_b128 v13, v[140:143] offset:2048
    ds_write_b128 v13, v[144:147] offset:3072
    ds_write_b128 v13, v[148:151] offset:4096
    s_waitcnt lgkmcnt(0)
    s_barrier
    ds_read_b128 v[192:195], v12 offset:0
    ds_read_b128 v[196:199], v12 offset:1024
    ds_read_b128 v[200:203], v12 offset:2048
    ds_read_b128 v[204:207], v12 offset:3072
    ds_read_b128 v[208:211], v12 offset:4096
    s_waitcnt lgkmcnt(4)
    v_pk_add_f32 v[192:193], v[192:193], v[112:113]
    v_pk_add_f32 v[194:195], v[194:195], v[114:115]
    s_waitcnt lgkmcnt(3)
    v_pk_add_f32 v[196:197], v[196:197], v[116:117]
    v_pk_add_f32 v[198:199], v[198:199], v[118:119]
    s_waitcnt lgkmcnt(2)
    v_pk_add_f32 v[200:201], v[200:201], v[120:121]
    v_pk_add_f32 v[202:203], v[202:203], v[122:123]
    s_waitcnt lgkmcnt(1)
    v_pk_add_f32 v[204:205], v[204:205], v[124:125]
    v_pk_add_f32 v[206:207], v[206:207], v[126:127]
    s_waitcnt lgkmcnt(0)
    v_pk_add_f32 v[208:209], v[208:209], v[128:129]
    v_pk_add_f32 v[210:211], v[210:211], v[130:131]
    s_branch K3_c
K3_b:
    ds_write_b128 v13, v[112:115] offset:0
    ds_write_b128 v13, v[116:119] offset:1024
    ds_write_b128 v13, v[120:123] offset:2048
    ds_write_b128 v13, v[124:127] offset:3072
    ds_write_b128 v13, v[128:131] offset:4096
    s_waitcnt lgkmcnt(0)
    s_barrier
    ds_read_b128 v[192:195], v12 offset:0
    ds_read_b128 v[196:199], v12 offset:1024
    ds_read_b128 v[200:203], v12 offset:2048
    ds_read_b128 v[204:207], v12 offset:3072
    ds_read_b128 v[208:211], v12 offset:4096
    s_waitcnt lgkmcnt(4)
    v_pk_add_f32 v[192:193], v[192:193], v[132:133]
    v_pk_add_f32 v[194:195], v[194:195], v[134:135]
    s_waitcnt lgkmcnt(3)
    v_pk_add_f32 v[196:197], v[196:197], v[136:137]
    v_pk_add_f32 v[198:199], v[198:199], v[138:139]
    s_waitcnt lgkmcnt(2)
    v_pk_add_f32 v[200:201], v[200:201], v[140:141]
    v_pk_add_f32 v[202:203], v[202:203], v[142:143]
    s_waitcnt lgkmcnt(1)
    v_pk_add_f32 v[204:205], v[204:205], v[144:145]
    v_pk_add_f32 v[206:207], v[206:207], v[146:147]
    s_waitcnt lgkmcnt(0)
    v_pk_add_f32 v[208:209], v[208:209], v[148:149]
    v_pk_add_f32 v[210:211], v[210:211], v[150:151]
K3_c:
    s_lshl_b32 s27, s24, 8
    v_add_u32 v22, s27, v22
    ds_read_b128 v[152:155], v22 offset:1024
    s_waitcnt lgkmcnt(0)
    v_add_f32 v152, v152, v154
    v_add_f32 v153, v153, v155
    v_mul_f32 v12, 0.0015625, v152
    v_mul_f32 v14, 0.0015625, v153
    v_fma_f32 v14, -v12, v12, v14
    v_max_f32 v14, 0, v14
    v_add_f32 v14, 1e-5, v14
    v_rsq_f32 v14, v14
    s_nop 0
    v_mov_b32 v28, -0.1029432395800235
    v_mov_b32 v29, -0.1029432395800235
    v_mov_b32 v30, -2.302208198144325
    v_mov_b32 v31, -2.302208198144325
    s_add_u32 s8, s4, 16777216
    s_addc_u32 s9, s5, 0
    s_mov_b32 s10, 2652160
    s_mov_b32 s11, 0x00020000
    s_mul_i32 s30, s21, 5
    s_waitcnt vmcnt(0)
    v_mov_b32 v13, v12
    v_mov_b32 v15, v14
    v_pk_fma_f32 v[192:193], v[12:13], v[232:233], v[192:193] neg_lo:[1,0,0] neg_hi:[1,0,0]
    v_pk_fma_f32 v[194:195], v[12:13], v[234:235], v[194:195] neg_lo:[1,0,0] neg_hi:[1,0,0]
    v_pk_mul_f32 v[192:193], v[14:15], v[192:193]
    v_pk_mul_f32 v[194:195], v[14:15], v[194:195]
    v_pk_fma_f32 v[196:197], v[12:13], v[236:237], v[196:197] neg_lo:[1,0,0] neg_hi:[1,0,0]
    v_pk_fma_f32 v[198:199], v[12:13], v[238:239], v[198:199] neg_lo:[1,0,0] neg_hi:[1,0,0]
    v_pk_mul_f32 v[196:197], v[14:15], v[196:197]
    v_pk_mul_f32 v[198:199], v[14:15], v[198:199]
    v_pk_fma_f32 v[200:201], v[12:13], v[240:241], v[200:201] neg_lo:[1,0,0] neg_hi:[1,0,0]
    v_pk_fma_f32 v[202:203], v[12:13], v[242:243], v[202:203] neg_lo:[1,0,0] neg_hi:[1,0,0]
    v_pk_mul_f32 v[200:201], v[14:15], v[200:201]
    v_pk_mul_f32 v[202:203], v[14:15], v[202:203]
    v_pk_fma_f32 v[204:205], v[12:13], v[244:245], v[204:205] neg_lo:[1,0,0] neg_hi:[1,0,0]
    v_pk_fma_f32 v[206:207], v[12:13], v[246:247], v[206:207] neg_lo:[1,0,0] neg_hi:[1,0,0]
    v_pk_mul_f32 v[204:205], v[14:15], v[204:205]
    v_pk_mul_f32 v[206:207], v[14:15], v[206:207]
    v_pk_fma_f32 v[208:209], v[12:13], v[248:249], v[208:209] neg_lo:[1,0,0] neg_hi:[1,0,0]
    v_pk_fma_f32 v[210:211], v[12:13], v[250:251], v[210:211] neg_lo:[1,0,0] neg_hi:[1,0,0]
    v_pk_mul_f32 v[208:209], v[14:15], v[208:209]
    v_pk_mul_f32 v[210:211], v[14:15], v[210:211]
    v_pk_mul_f32 v[32:33], v[192:193], v[192:193]
    v_pk_mul_f32 v[34:35], v[194:195], v[194:195]
    v_pk_mul_f32 v[36:37], v[196:197], v[196:197]
    v_pk_mul_f32 v[38:39], v[198:199], v[198:199]
    v_pk_mul_f32 v[40:41], v[200:201], v[200:201]
    v_pk_mul_f32 v[42:43], v[202:203], v[202:203]
    v_pk_mul_f32 v[44:45], v[204:205], v[204:205]
    v_pk_mul_f32 v[46:47], v[206:207], v[206:207]
    v_pk_mul_f32 v[48:49], v[208:209], v[208:209]
    v_pk_mul_f32 v[50:51], v[210:211], v[210:211]
    v_pk_fma_f32 v[32:33], v[32:33], v[28:29], v[30:31]
    v_pk_fma_f32 v[34:35], v[34:35], v[28:29], v[30:31]
    v_pk_fma_f32 v[36:37], v[36:37], v[28:29], v[30:31]
    v_pk_fma_f32 v[38:39], v[38:39], v[28:29], v[30:31]
    v_pk_fma_f32 v[40:41], v[40:41], v[28:29], v[30:31]
    v_pk_fma_f32 v[42:43], v[42:43], v[28:29], v[30:31]
    v_pk_fma_f32 v[44:45], v[44:45], v[28:29], v[30:31]
    v_pk_fma_f32 v[46:47], v[46:47], v[28:29], v[30:31]
    v_pk_fma_f32 v[48:49], v[48:49], v[28:29], v[30:31]
    v_pk_fma_f32 v[50:51], v[50:51], v[28:29], v[30:31]
    v_pk_mul_f32 v[32:33], v[32:33], v[192:193]
    v_pk_mul_f32 v[34:35], v[34:35], v[194:195]
    v_pk_mul_f32 v[36:37], v[36:37], v[196:197]
    v_pk_mul_f32 v[38:39], v[38:39], v[198:199]
    v_pk_mul_f32 v[40:41], v[40:41], v[200:201]
    v_pk_mul_f32 v[42:43], v[42:43], v[202:203]
    v_pk_mul_f32 v[44:45], v[44:45], v[204:205]
    v_pk_mul_f32 v[46:47], v[46:47], v[206:207]
    v_pk_mul_f32 v[48:49], v[48:49], v[208:209]
    v_pk_mul_f32 v[50:51], v[50:51], v[210:211]
    v_exp_f32 v32, v32
    v_exp_f32 v33, v33
    v_exp_f32 v34, v34
    v_exp_f32 v35, v35
    v_exp_f32 v36, v36
    v_exp_f32 v37, v37
    v_exp_f32 v38, v38
    v_exp_f32 v39, v39
    v_exp_f32 v40, v40
    v_exp_f32 v41, v41
    v_exp_f32 v42, v42
    v_exp_f32 v43, v43
    v_exp_f32 v44, v44
    v_exp_f32 v45, v45
    v_exp_f32 v46, v46
    v_exp_f32 v47, v47
    v_exp_f32 v48, v48
    v_exp_f32 v49, v49
    v_exp_f32 v50, v50
    v_exp_f32 v51, v51
    s_nop 0
    v_pk_add_f32 v[32:33], v[32:33], 1.0 op_sel_hi:[1,0]
    v_pk_add_f32 v[34:35], v[34:35], 1.0 op_sel_hi:[1,0]
    v_pk_add_f32 v[36:37], v[36:37], 1.0 op_sel_hi:[1,0]
    v_pk_add_f32 v[38:39], v[38:39], 1.0 op_sel_hi:[1,0]
    v_pk_add_f32 v[40:41], v[40:41], 1.0 op_sel_hi:[1,0]
    v_pk_add_f32 v[42:43], v[42:43], 1.0 op_sel_hi:[1,0]
    v_pk_add_f32 v[44:45], v[44:45], 1.0 op_sel_hi:[1,0]
    v_pk_add_f32 v[46:47], v[46:47], 1.0 op_sel_hi:[1,0]
    v_pk_add_f32 v[48:49], v[48:49], 1.0 op_sel_hi:[1,0]
    v_pk_add_f32 v[50:51], v[50:51], 1.0 op_sel_hi:[1,0]
    v_rcp_f32 v32, v32
    v_rcp_f32 v33, v33
    v_rcp_f32 v34, v34
    v_rcp_f32 v35, v35
    v_rcp_f32 v36, v36
    v_rcp_f32 v37, v37
    v_rcp_f32 v38, v38
    v_rcp_f32 v39, v39
    v_rcp_f32 v40, v40
    v_rcp_f32 v41, v41
    v_rcp_f32 v42, v42
    v_rcp_f32 v43, v43
    v_rcp_f32 v44, v44
    v_rcp_f32 v45, v45
    v_rcp_f32 v46, v46
    v_rcp_f32 v47, v47
    v_rcp_f32 v48, v48
    v_rcp_f32 v49, v49
    v_rcp_f32 v50, v50
    v_rcp_f32 v51, v51
    s_nop 0
    v_pk_mul_f32 v[192:193], v[32:33], v[192:193]
    v_pk_mul_f32 v[194:195], v[34:35], v[194:195]
    v_pk_mul_f32 v[196:197], v[36:37], v[196:197]
    v_pk_mul_f32 v[198:199], v[38:39], v[198:199]
    v_pk_mul_f32 v[200:201], v[40:41], v[200:201]
    v_pk_mul_f32 v[202:203], v[42:43], v[202:203]
    v_pk_mul_f32 v[204:205], v[44:45], v[204:205]
    v_pk_mul_f32 v[206:207], v[46:47], v[206:207]
    v_pk_mul_f32 v[208:209], v[48:49], v[208:209]
    v_pk_mul_f32 v[210:211], v[50:51], v[210:211]
    v_and_b32 v11, 1, v3
    v_lshlrev_b32 v11, 1, v11
    v_lshrrev_b32 v12, 1, v3
    v_add_u32 v11, v11, v12
    v_mul_u32_u24 v11, 2072, v11
    v_add_u32 v11, v11, v10
    v_lshlrev_b32 v9, 4, v11
    s_mul_i32 s44, s30, 66304
    s_lshl_b32 s40, s24, 8
    s_add_u32 s44, s44, s40
    v_cvt_pk_bf16_f32 v192, v192, v193
    v_cvt_pk_bf16_f32 v193, v194, v195
    v_cvt_pk_bf16_f32 v194, v196, v197
    v_cvt_pk_bf16_f32 v195, v198, v199
    s_nop 1
    v_permlane16_swap_b32 v192, v194
    v_permlane16_swap_b32 v193, v195
    s_nop 0
    buffer_store_dwordx4 v[192:195], v9, s[8:11], s44 offen offset:128 sc1
    s_add_u32 s44, s44, 132608
    v_cvt_pk_bf16_f32 v200, v200, v201
    v_cvt_pk_bf16_f32 v201, v202, v203
    v_cvt_pk_bf16_f32 v202, v204, v205
    v_cvt_pk_bf16_f32 v203, v206, v207
    s_nop 1
    v_permlane16_swap_b32 v200, v202
    v_permlane16_swap_b32 v201, v203
    s_nop 0
    buffer_store_dwordx4 v[200:203], v9, s[8:11], s44 offen offset:128 sc1
    s_add_u32 s44, s44, 132608
    v_cvt_pk_bf16_f32 v208, v208, v209
    v_cvt_pk_bf16_f32 v209, v210, v211
    s_nop 1
    v_permlane16_swap_b32 v208, v210
    v_permlane16_swap_b32 v209, v211
    s_mov_b32 exec_lo, 0xffff
    s_mov_b32 exec_hi, 0xffff
    s_nop 0
    buffer_store_dwordx4 v[208:211], v9, s[8:11], s44 offen offset:128 sc1
    s_mov_b64 exec, -1
    s_waitcnt vmcnt(0)
    s_barrier
    v_lshrrev_b32 v1, 6, v0
    s_nop 0
    v_readfirstlane_b32 s3, v1
    v_and_b32 v1, 63, v0
    v_and_b32 v2, 15, v1
    v_lshrrev_b32 v3, 4, v1
    v_lshlrev_b32 v4, 4, v1
    s_and_b32 s20, s2, 7
    s_lshr_b32 s21, s2, 3
    s_lshr_b32 s22, s21, 3
    s_lshl_b32 s22, s22, 3
    s_add_u32 s20, s20, s22
    s_and_b32 s21, s21, 7
    s_and_b32 s23, s3, 1
    s_lshr_b32 s24, s3, 1
    s_lshl_b32 s25, s20, 6
    s_lshl_b32 s26, s23, 5
    s_add_u32 s25, s25, s26
    v_add_u32 v5, s25, v2
    v_mov_b32 v10, v5
    v_mul_u32_u24 v11, 2072, v3
    v_add_u32 v5, v5, v11
    v_lshlrev_b32 v5, 4, v5
    s_add_u32 s28, s24, 1
    s_lshl_b32 s28, s28, 4
    s_mul_i32 s26, s24, 1326080
    s_add_u32 s26, s26, 128
    s_add_u32 s27, s26, s28
    s_sub_u32 s26, s26, s28
    s_add_u32 s27, s27, 663040
    s_add_u32 s8, s4, 16777216
    s_addc_u32 s9, s5, 0
    s_mov_b32 s10, 2652160
    s_mov_b32 s11, 0x00020000
    s_add_u32 s16, s4, 13631488
    s_addc_u32 s17, s5, 0
    s_mov_b32 s18, 2652160
    s_mov_b32 s19, 0x00020000
    s_mul_i32 s30, s21, 5
    s_add_u32 s40, s30, 0
    s_lshr_b32 s41, s40, 1
    s_mul_i32 s41, s41, 132608
    s_and_b32 s40, s40, 1
    s_lshl_b32 s40, s40, 3
    s_add_u32 s41, s41, s40
    s_lshl_b32 s40, s24, 8
    s_add_u32 s44, s41, s40
    s_add_u32 s40, s30, 1
    s_lshr_b32 s41, s40, 1
    s_mul_i32 s41, s41, 132608
    s_and_b32 s40, s40, 1
    s_lshl_b32 s40, s40, 3
    s_add_u32 s41, s41, s40
    s_lshl_b32 s40, s24, 8
    s_add_u32 s45, s41, s40
    s_add_u32 s40, s30, 2
    s_lshr_b32 s41, s40, 1
    s_mul_i32 s41, s41, 132608
    s_and_b32 s40, s40, 1
    s_lshl_b32 s40, s40, 3
    s_add_u32 s41, s41, s40
    s_lshl_b32 s40, s24, 8
    s_add_u32 s46, s41, s40
    s_add_u32 s40, s30, 3
    s_lshr_b32 s41, s40, 1
    s_mul_i32 s41, s41, 132608
    s_and_b32 s40, s40, 1
    s_lshl_b32 s40, s40, 3
    s_add_u32 s41, s41, s40
    s_lshl_b32 s40, s24, 8
    s_add_u32 s47, s41, s40
    s_add_u32 s40, s30, 4
    s_lshr_b32 s41, s40, 1
    s_mul_i32 s41, s41, 132608
    s_and_b32 s40, s40, 1
    s_lshl_b32 s40, s40, 3
    s_add_u32 s41, s41, s40
    s_lshl_b32 s40, s24, 8
    s_add_u32 s48, s41, s40
    s_mul_i32 s31, s24, 51200
    v_add_u32 v4, s31, v4
    s_barrier
    buffer_load_dwordx4 v[32:35], v5, s[8:11], s26 offen offset:0 sc1
    buffer_load_dwordx4 v[36:39], v5, s[8:11], s26 offen offset:256 sc1
    s_add_u32 s26, s26, 132608
    buffer_load_dwordx4 v[40:43], v5, s[8:11], s26 offen offset:0 sc1
    buffer_load_dwordx4 v[44:47], v5, s[8:11], s26 offen offset:256 sc1
    s_add_u32 s26, s26, 132608
    buffer_load_dwordx4 v[48:51], v5, s[8:11], s26 offen offset:0 sc1
    buffer_load_dwordx4 v[52:55], v5, s[8:11], s26 offen offset:256 sc1
    s_add_u32 s26, s26, 132608
    buffer_load_dwordx4 v[56:59], v5, s[8:11], s26 offen offset:0 sc1
    buffer_load_dwordx4 v[60:63], v5, s[8:11], s26 offen offset:256 sc1
    s_add_u32 s26, s26, 132608
    buffer_load_dwordx4 v[64:67], v5, s[8:11], s26 offen offset:0 sc1
    buffer_load_dwordx4 v[68:71], v5, s[8:11], s26 offen offset:256 sc1
    s_add_u32 s26, s26, 132608
    buffer_load_dwordx4 v[72:75], v5, s[8:11], s27 offen offset:0 sc1
    buffer_load_dwordx4 v[76:79], v5, s[8:11], s27 offen offset:256 sc1
    s_add_u32 s27, s27, 132608
    buffer_load_dwordx4 v[80:83], v5, s[8:11], s27 offen offset:0 sc1
    buffer_load_dwordx4 v[84:87], v5, s[8:11], s27 offen offset:256 sc1
    s_add_u32 s27, s27, 132608
    buffer_load_dwordx4 v[88:91], v5, s[8:11], s27 offen offset:0 sc1
    buffer_load_dwordx4 v[92:95], v5, s[8:11], s27 offen offset:256 sc1
    s_add_u32 s27, s27, 132608
    s_barrier
    ds_read_b128 v[152:155], v4 offset:0
    ds_read_b128 v[156:159], v4 offset:1024
    ds_read_b128 v[160:163], v4 offset:2048
    ds_read_b128 v[164:167], v4 offset:3072
    ds_read_b128 v[168:171], v4 offset:4096
    s_waitcnt lgkmcnt(0)
    s_waitcnt vmcnt(14)
    v_mfma_f32_16x16x32_bf16 v[112:115], v[152:155], v[32:35], 0
    ds_read_b128 v[172:175], v4 offset:5120
    v_mfma_f32_16x16x32_bf16 v[132:135], v[152:155], v[36:39], 0
    ds_read_b128 v[176:179], v4 offset:6144
    v_mfma_f32_16x16x32_bf16 v[116:119], v[156:159], v[32:35], 0
    ds_read_b128 v[180:183], v4 offset:7168
    v_mfma_f32_16x16x32_bf16 v[136:139], v[156:159], v[36:39], 0
    ds_read_b128 v[184:187], v4 offset:8192
    v_mfma_f32_16x16x32_bf16 v[120:123], v[160:163], v[32:35], 0
    ds_read_b128 v[188:191], v4 offset:9216
    v_mfma_f32_16x16x32_bf16 v[140:143], v[160:163], v[36:39], 0
    v_mfma_f32_16x16x32_bf16 v[124:127], v[164:167], v[32:35], 0
    v_mfma_f32_16x16x32_bf16 v[144:147], v[164:167], v[36:39], 0
    v_mfma_f32_16x16x32_bf16 v[128:131], v[168:171], v[32:35], 0
    v_mfma_f32_16x16x32_bf16 v[148:151], v[168:171], v[36:39], 0
    buffer_load_dwordx4 v[96:99], v5, s[8:11], s27 offen offset:0 sc1
    buffer_load_dwordx4 v[100:103], v5, s[8:11], s27 offen offset:256 sc1
    s_add_u32 s27, s27, 132608
    buffer_load_dwordx4 v[104:107], v5, s[8:11], s27 offen offset:0 sc1
    buffer_load_dwordx4 v[108:111], v5, s[8:11], s27 offen offset:256 sc1
    s_add_u32 s27, s27, 132608
    s_waitcnt lgkmcnt(0)
    s_barrier
    s_waitcnt vmcnt(16)
    v_mfma_f32_16x16x32_bf16 v[112:115], v[172:175], v[40:43], v[112:115]
    ds_read_b128 v[152:155], v4 offset:10240
    v_mfma_f32_16x16x32_bf16 v[132:135], v[172:175], v[44:47], v[132:135]
    ds_read_b128 v[156:159], v4 offset:11264
    v_mfma_f32_16x16x32_bf16 v[116:119], v[176:179], v[40:43], v[116:119]
    ds_read_b128 v[160:163], v4 offset:12288
    v_mfma_f32_16x16x32_bf16 v[136:139], v[176:179], v[44:47], v[136:139]
    ds_read_b128 v[164:167], v4 offset:13312
    v_mfma_f32_16x16x32_bf16 v[120:123], v[180:183], v[40:43], v[120:123]
    ds_read_b128 v[168:171], v4 offset:14336
    v_mfma_f32_16x16x32_bf16 v[140:143], v[180:183], v[44:47], v[140:143]
    v_mfma_f32_16x16x32_bf16 v[124:127], v[184:187], v[40:43], v[124:127]
    v_mfma_f32_16x16x32_bf16 v[144:147], v[184:187], v[44:47], v[144:147]
    v_mfma_f32_16x16x32_bf16 v[128:131], v[188:191], v[40:43], v[128:131]
    v_mfma_f32_16x16x32_bf16 v[148:151], v[188:191], v[44:47], v[148:151]
    s_waitcnt lgkmcnt(0)
    s_waitcnt vmcnt(14)
    v_mfma_f32_16x16x32_bf16 v[112:115], v[152:155], v[48:51], v[112:115]
    ds_read_b128 v[172:175], v4 offset:15360
    v_mfma_f32_16x16x32_bf16 v[132:135], v[152:155], v[52:55], v[132:135]
    ds_read_b128 v[176:179], v4 offset:16384
    v_mfma_f32_16x16x32_bf16 v[116:119], v[156:159], v[48:51], v[116:119]
    ds_read_b128 v[180:183], v4 offset:17408
    v_mfma_f32_16x16x32_bf16 v[136:139], v[156:159], v[52:55], v[136:139]
    ds_read_b128 v[184:187], v4 offset:18432
    v_mfma_f32_16x16x32_bf16 v[120:123], v[160:163], v[48:51], v[120:123]
    ds_read_b128 v[188:191], v4 offset:19456
    v_mfma_f32_16x16x32_bf16 v[140:143], v[160:163], v[52:55], v[140:143]
    v_mfma_f32_16x16x32_bf16 v[124:127], v[164:167], v[48:51], v[124:127]
    v_mfma_f32_16x16x32_bf16 v[144:147], v[164:167], v[52:55], v[144:147]
    v_mfma_f32_16x16x32_bf16 v[128:131], v[168:171], v[48:51], v[128:131]
    v_mfma_f32_16x16x32_bf16 v[148:151], v[168:171], v[52:55], v[148:151]
    s_waitcnt lgkmcnt(0)
    s_barrier
    s_waitcnt vmcnt(12)
    v_mfma_f32_16x16x32_bf16 v[112:115], v[172:175], v[56:59], v[112:115]
    ds_read_b128 v[152:155], v4 offset:20480
    v_mfma_f32_16x16x32_bf16 v[132:135], v[172:175], v[60:63], v[132:135]
    ds_read_b128 v[156:159], v4 offset:21504
    v_mfma_f32_16x16x32_bf16 v[116:119], v[176:179], v[56:59], v[116:119]
    ds_read_b128 v[160:163], v4 offset:22528
    v_mfma_f32_16x16x32_bf16 v[136:139], v[176:179], v[60:63], v[136:139]
    ds_read_b128 v[164:167], v4 offset:23552
    v_mfma_f32_16x16x32_bf16 v[120:123], v[180:183], v[56:59], v[120:123]
    ds_read_b128 v[168:171], v4 offset:24576
    v_mfma_f32_16x16x32_bf16 v[140:143], v[180:183], v[60:63], v[140:143]
    v_mfma_f32_16x16x32_bf16 v[124:127], v[184:187], v[56:59], v[124:127]
    v_mfma_f32_16x16x32_bf16 v[144:147], v[184:187], v[60:63], v[144:147]
    v_mfma_f32_16x16x32_bf16 v[128:131], v[188:191], v[56:59], v[128:131]
    v_mfma_f32_16x16x32_bf16 v[148:151], v[188:191], v[60:63], v[148:151]
    s_waitcnt lgkmcnt(0)
    s_waitcnt vmcnt(10)
    v_mfma_f32_16x16x32_bf16 v[112:115], v[152:155], v[64:67], v[112:115]
    ds_read_b128 v[172:175], v4 offset:25600
    v_mfma_f32_16x16x32_bf16 v[132:135], v[152:155], v[68:71], v[132:135]
    ds_read_b128 v[176:179], v4 offset:26624
    v_mfma_f32_16x16x32_bf16 v[116:119], v[156:159], v[64:67], v[116:119]
    ds_read_b128 v[180:183], v4 offset:27648
    v_mfma_f32_16x16x32_bf16 v[136:139], v[156:159], v[68:71], v[136:139]
    ds_read_b128 v[184:187], v4 offset:28672
    v_mfma_f32_16x16x32_bf16 v[120:123], v[160:163], v[64:67], v[120:123]
    ds_read_b128 v[188:191], v4 offset:29696
    v_mfma_f32_16x16x32_bf16 v[140:143], v[160:163], v[68:71], v[140:143]
    v_mfma_f32_16x16x32_bf16 v[124:127], v[164:167], v[64:67], v[124:127]
    v_mfma_f32_16x16x32_bf16 v[144:147], v[164:167], v[68:71], v[144:147]
    v_mfma_f32_16x16x32_bf16 v[128:131], v[168:171], v[64:67], v[128:131]
    v_mfma_f32_16x16x32_bf16 v[148:151], v[168:171], v[68:71], v[148:151]
    s_waitcnt lgkmcnt(0)
    s_barrier
    s_waitcnt vmcnt(8)
    v_mfma_f32_16x16x32_bf16 v[112:115], v[172:175], v[72:75], v[112:115]
    ds_read_b128 v[152:155], v4 offset:30720
    v_mfma_f32_16x16x32_bf16 v[132:135], v[172:175], v[76:79], v[132:135]
    ds_read_b128 v[156:159], v4 offset:31744
    v_mfma_f32_16x16x32_bf16 v[116:119], v[176:179], v[72:75], v[116:119]
    ds_read_b128 v[160:163], v4 offset:32768
    v_mfma_f32_16x16x32_bf16 v[136:139], v[176:179], v[76:79], v[136:139]
    ds_read_b128 v[164:167], v4 offset:33792
    v_mfma_f32_16x16x32_bf16 v[120:123], v[180:183], v[72:75], v[120:123]
    ds_read_b128 v[168:171], v4 offset:34816
    v_mfma_f32_16x16x32_bf16 v[140:143], v[180:183], v[76:79], v[140:143]
    v_mfma_f32_16x16x32_bf16 v[124:127], v[184:187], v[72:75], v[124:127]
    v_mfma_f32_16x16x32_bf16 v[144:147], v[184:187], v[76:79], v[144:147]
    v_mfma_f32_16x16x32_bf16 v[128:131], v[188:191], v[72:75], v[128:131]
    v_mfma_f32_16x16x32_bf16 v[148:151], v[188:191], v[76:79], v[148:151]
    buffer_load_dwordx2 v[212:213], v5, s[16:19], s44 offen sc1
    buffer_load_dwordx2 v[214:215], v5, s[16:19], s45 offen sc1
    buffer_load_dwordx2 v[216:217], v5, s[16:19], s46 offen sc1
    buffer_load_dwordx2 v[218:219], v5, s[16:19], s47 offen sc1
    buffer_load_dwordx2 v[220:221], v5, s[16:19], s48 offen sc1
    s_waitcnt lgkmcnt(0)
    s_waitcnt vmcnt(11)
    v_mfma_f32_16x16x32_bf16 v[112:115], v[152:155], v[80:83], v[112:115]
    ds_read_b128 v[172:175], v4 offset:35840
    v_mfma_f32_16x16x32_bf16 v[132:135], v[152:155], v[84:87], v[132:135]
    ds_read_b128 v[176:179], v4 offset:36864
    v_mfma_f32_16x16x32_bf16 v[116:119], v[156:159], v[80:83], v[116:119]
    ds_read_b128 v[180:183], v4 offset:37888
    v_mfma_f32_16x16x32_bf16 v[136:139], v[156:159], v[84:87], v[136:139]
    ds_read_b128 v[184:187], v4 offset:38912
    v_mfma_f32_16x16x32_bf16 v[120:123], v[160:163], v[80:83], v[120:123]
    ds_read_b128 v[188:191], v4 offset:39936
    v_mfma_f32_16x16x32_bf16 v[140:143], v[160:163], v[84:87], v[140:143]
    v_mfma_f32_16x16x32_bf16 v[124:127], v[164:167], v[80:83], v[124:127]
    v_mfma_f32_16x16x32_bf16 v[144:147], v[164:167], v[84:87], v[144:147]
    v_mfma_f32_16x16x32_bf16 v[128:131], v[168:171], v[80:83], v[128:131]
    v_mfma_f32_16x16x32_bf16 v[148:151], v[168:171], v[84:87], v[148:151]
    s_waitcnt lgkmcnt(0)
    s_barrier
    s_waitcnt vmcnt(9)
    v_mfma_f32_16x16x32_bf16 v[112:115], v[172:175], v[88:91], v[112:115]
    ds_read_b128 v[152:155], v4 offset:40960
    v_mfma_f32_16x16x32_bf16 v[132:135], v[172:175], v[92:95], v[132:135]
    ds_read_b128 v[156:159], v4 offset:41984
    v_mfma_f32_16x16x32_bf16 v[116:119], v[176:179], v[88:91], v[116:119]
    ds_read_b128 v[160:163], v4 offset:43008
    v_mfma_f32_16x16x32_bf16 v[136:139], v[176:179], v[92:95], v[136:139]
    ds_read_b128 v[164:167], v4 offset:44032
    v_mfma_f32_16x16x32_bf16 v[120:123], v[180:183], v[88:91], v[120:123]
    ds_read_b128 v[168:171], v4 offset:45056
    v_mfma_f32_16x16x32_bf16 v[140:143], v[180:183], v[92:95], v[140:143]
    v_mfma_f32_16x16x32_bf16 v[124:127], v[184:187], v[88:91], v[124:127]
    v_mfma_f32_16x16x32_bf16 v[144:147], v[184:187], v[92:95], v[144:147]
    v_mfma_f32_16x16x32_bf16 v[128:131], v[188:191], v[88:91], v[128:131]
    v_mfma_f32_16x16x32_bf16 v[148:151], v[188:191], v[92:95], v[148:151]
    s_waitcnt lgkmcnt(0)
    s_waitcnt vmcnt(7)
    v_mfma_f32_16x16x32_bf16 v[112:115], v[152:155], v[96:99], v[112:115]
    ds_read_b128 v[172:175], v4 offset:46080
    v_mfma_f32_16x16x32_bf16 v[132:135], v[152:155], v[100:103], v[132:135]
    ds_read_b128 v[176:179], v4 offset:47104
    v_mfma_f32_16x16x32_bf16 v[116:119], v[156:159], v[96:99], v[116:119]
    ds_read_b128 v[180:183], v4 offset:48128
    v_mfma_f32_16x16x32_bf16 v[136:139], v[156:159], v[100:103], v[136:139]
    ds_read_b128 v[184:187], v4 offset:49152
    v_mfma_f32_16x16x32_bf16 v[120:123], v[160:163], v[96:99], v[120:123]
    ds_read_b128 v[188:191], v4 offset:50176
    v_mfma_f32_16x16x32_bf16 v[140:143], v[160:163], v[100:103], v[140:143]
    v_mfma_f32_16x16x32_bf16 v[124:127], v[164:167], v[96:99], v[124:127]
    v_mfma_f32_16x16x32_bf16 v[144:147], v[164:167], v[100:103], v[144:147]
    v_mfma_f32_16x16x32_bf16 v[128:131], v[168:171], v[96:99], v[128:131]
    v_mfma_f32_16x16x32_bf16 v[148:151], v[168:171], v[100:103], v[148:151]
    s_waitcnt lgkmcnt(0)
    s_barrier
    s_waitcnt vmcnt(5)
    v_mfma_f32_16x16x32_bf16 v[112:115], v[172:175], v[104:107], v[112:115]
    v_mfma_f32_16x16x32_bf16 v[132:135], v[172:175], v[108:111], v[132:135]
    v_mfma_f32_16x16x32_bf16 v[116:119], v[176:179], v[104:107], v[116:119]
    v_mfma_f32_16x16x32_bf16 v[136:139], v[176:179], v[108:111], v[136:139]
    v_mfma_f32_16x16x32_bf16 v[120:123], v[180:183], v[104:107], v[120:123]
    v_mfma_f32_16x16x32_bf16 v[140:143], v[180:183], v[108:111], v[140:143]
    v_mfma_f32_16x16x32_bf16 v[124:127], v[184:187], v[104:107], v[124:127]
    v_mfma_f32_16x16x32_bf16 v[144:147], v[184:187], v[108:111], v[144:147]
    v_mfma_f32_16x16x32_bf16 v[128:131], v[188:191], v[104:107], v[128:131]
    v_mfma_f32_16x16x32_bf16 v[148:151], v[188:191], v[108:111], v[148:151]
    v_lshlrev_b32 v12, 4, v1
    s_lshl_b32 s27, s23, 1
    s_add_u32 s28, s27, s24
    s_mul_i32 s28, s28, 5120
    s_add_u32 s28, s28, 102400
    v_add_u32 v13, s28, v12
    s_xor_b32 s29, s24, 1
    s_add_u32 s28, s27, s29
    s_mul_i32 s28, s28, 5120
    s_add_u32 s28, s28, 102400
    v_add_u32 v12, s28, v12
    s_nop 4
    s_cmp_eq_u32 s24, 0
    s_cbranch_scc0 K4_b
    ds_write_b128 v13, v[132:135] offset:0
    ds_write_b128 v13, v[136:139] offset:1024
    ds_write_b128 v13, v[140:143] offset:2048
    ds_write_b128 v13, v[144:147] offset:3072
    ds_write_b128 v13, v[148:151] offset:4096
    s_waitcnt lgkmcnt(0)
    s_barrier
    ds_read_b128 v[192:195], v12 offset:0
    ds_read_b128 v[196:199], v12 offset:1024
    ds_read_b128 v[200:203], v12 offset:2048
    ds_read_b128 v[204:207], v12 offset:3072
    ds_read_b128 v[208:211], v12 offset:4096
    s_waitcnt lgkmcnt(4)
    v_pk_add_f32 v[192:193], v[192:193], v[112:113]
    v_pk_add_f32 v[194:195], v[194:195], v[114:115]
    s_waitcnt lgkmcnt(3)
    v_pk_add_f32 v[196:197], v[196:197], v[116:117]
    v_pk_add_f32 v[198:199], v[198:199], v[118:119]
    s_waitcnt lgkmcnt(2)
    v_pk_add_f32 v[200:201], v[200:201], v[120:121]
    v_pk_add_f32 v[202:203], v[202:203], v[122:123]
    s_waitcnt lgkmcnt(1)
    v_pk_add_f32 v[204:205], v[204:205], v[124:125]
    v_pk_add_f32 v[206:207], v[206:207], v[126:127]
    s_waitcnt lgkmcnt(0)
    v_pk_add_f32 v[208:209], v[208:209], v[128:129]
    v_pk_add_f32 v[210:211], v[210:211], v[130:131]
    s_branch K4_c
K4_b:
    ds_write_b128 v13, v[112:115] offset:0
    ds_write_b128 v13, v[116:119] offset:1024
    ds_write_b128 v13, v[120:123] offset:2048
    ds_write_b128 v13, v[124:127] offset:3072
    ds_write_b128 v13, v[128:131] offset:4096
    s_waitcnt lgkmcnt(0)
    s_barrier
    ds_read_b128 v[192:195], v12 offset:0
    ds_read_b128 v[196:199], v12 offset:1024
    ds_read_b128 v[200:203], v12 offset:2048
    ds_read_b128 v[204:207], v12 offset:3072
    ds_read_b128 v[208:211], v12 offset:4096
    s_waitcnt lgkmcnt(4)
    v_pk_add_f32 v[192:193], v[192:193], v[132:133]
    v_pk_add_f32 v[194:195], v[194:195], v[134:135]
    s_waitcnt lgkmcnt(3)
    v_pk_add_f32 v[196:197], v[196:197], v[136:137]
    v_pk_add_f32 v[198:199], v[198:199], v[138:139]
    s_waitcnt lgkmcnt(2)
    v_pk_add_f32 v[200:201], v[200:201], v[140:141]
    v_pk_add_f32 v[202:203], v[202:203], v[142:143]
    s_waitcnt lgkmcnt(1)
    v_pk_add_f32 v[204:205], v[204:205], v[144:145]
    v_pk_add_f32 v[206:207], v[206:207], v[146:147]
    s_waitcnt lgkmcnt(0)
    v_pk_add_f32 v[208:209], v[208:209], v[148:149]
    v_pk_add_f32 v[210:211], v[210:211], v[150:151]
K4_c:
    s_add_u32 s8, s4, 19922944
    s_addc_u32 s9, s5, 0
    s_mov_b32 s10, 2652160
    s_mov_b32 s11, 0x00020000
    s_waitcnt vmcnt(0)
    v_lshlrev_b32 v20, 16, v212
    v_and_b32 v21, 0xffff0000, v212
    v_lshlrev_b32 v22, 16, v213
    v_and_b32 v23, 0xffff0000, v213
    v_pk_add_f32 v[192:193], v[192:193], v[20:21]
    v_pk_add_f32 v[194:195], v[194:195], v[22:23]
    v_lshlrev_b32 v20, 16, v214
    v_and_b32 v21, 0xffff0000, v214
    v_lshlrev_b32 v22, 16, v215
    v_and_b32 v23, 0xffff0000, v215
    v_pk_add_f32 v[196:197], v[196:197], v[20:21]
    v_pk_add_f32 v[198:199], v[198:199], v[22:23]
    v_lshlrev_b32 v20, 16, v216
    v_and_b32 v21, 0xffff0000, v216
    v_lshlrev_b32 v22, 16, v217
    v_and_b32 v23, 0xffff0000, v217
    v_pk_add_f32 v[200:201], v[200:201], v[20:21]
    v_pk_add_f32 v[202:203], v[202:203], v[22:23]
    v_lshlrev_b32 v20, 16, v218
    v_and_b32 v21, 0xffff0000, v218
    v_lshlrev_b32 v22, 16, v219
    v_and_b32 v23, 0xffff0000, v219
    v_pk_add_f32 v[204:205], v[204:205], v[20:21]
    v_pk_add_f32 v[206:207], v[206:207], v[22:23]
    v_lshlrev_b32 v20, 16, v220
    v_and_b32 v21, 0xffff0000, v220
    v_lshlrev_b32 v22, 16, v221
    v_and_b32 v23, 0xffff0000, v221
    v_pk_add_f32 v[208:209], v[208:209], v[20:21]
    v_pk_add_f32 v[210:211], v[210:211], v[22:23]
    s_mov_b32 s50, 0x00F0000F
    s_mov_b32 s51, 0xF0000F00
    s_mov_b32 s52, 0x22222222
    s_mov_b32 s53, 0x22222222
    s_mov_b32 s54, 0x44444444
    s_mov_b32 s55, 0x44444444
    s_mov_b32 s56, 0x88888888
    s_mov_b32 s57, 0x88888888
    v_mov_b32 v24, 0x3f803f80
    v_mov_b32 v25, 0x3f803f80
    v_mov_b32 v26, 0x3f803f80
    v_mov_b32 v27, 0x3f803f80
    v_and_b32 v11, 1, v3
    v_lshlrev_b32 v11, 1, v11
    v_lshrrev_b32 v12, 1, v3
    v_add_u32 v11, v11, v12
    v_mul_u32_u24 v11, 2072, v11
    v_add_u32 v11, v11, v10
    v_lshlrev_b32 v9, 4, v11
    s_mul_i32 s44, s30, 66304
    s_lshl_b32 s40, s24, 8
    s_add_u32 s44, s44, s40
    v_cvt_pk_bf16_f32 v192, v192, v193
    v_cvt_pk_bf16_f32 v193, v194, v195
    v_cvt_pk_bf16_f32 v194, v196, v197
    v_cvt_pk_bf16_f32 v195, v198, v199
    s_nop 1
    v_permlane16_swap_b32 v192, v194
    v_permlane16_swap_b32 v193, v195
    s_nop 1
    v_mfma_f32_16x16x32_bf16 v[32:35], v[24:27], v[192:195], 0
    v_mfma_f32_16x16x32_bf16 v[36:39], v[192:195], v[192:195], 0
    s_nop 0
    buffer_store_dwordx4 v[192:195], v9, s[8:11], s44 offen sc1
    s_add_u32 s44, s44, 132608
    v_cvt_pk_bf16_f32 v200, v200, v201
    v_cvt_pk_bf16_f32 v201, v202, v203
    v_cvt_pk_bf16_f32 v202, v204, v205
    v_cvt_pk_bf16_f32 v203, v206, v207
    s_nop 1
    v_permlane16_swap_b32 v200, v202
    v_permlane16_swap_b32 v201, v203
    s_nop 1
    v_mfma_f32_16x16x32_bf16 v[32:35], v[24:27], v[200:203], v[32:35]
    v_mfma_f32_16x16x32_bf16 v[36:39], v[200:203], v[200:203], v[36:39]
    s_nop 0
    buffer_store_dwordx4 v[200:203], v9, s[8:11], s44 offen sc1
    s_add_u32 s44, s44, 132608
    v_cvt_pk_bf16_f32 v208, v208, v209
    v_cvt_pk_bf16_f32 v209, v210, v211
    v_mov_b32 v210, 0
    v_mov_b32 v211, 0
    s_nop 1
    v_permlane16_swap_b32 v208, v210
    v_permlane16_swap_b32 v209, v211
    s_nop 1
    v_mfma_f32_16x16x32_bf16 v[32:35], v[24:27], v[208:211], v[32:35]
    v_mfma_f32_16x16x32_bf16 v[36:39], v[208:211], v[208:211], v[36:39]
    s_mov_b32 exec_lo, 0xffff
    s_mov_b32 exec_hi, 0xffff
    s_nop 0
    buffer_store_dwordx4 v[208:211], v9, s[8:11], s44 offen sc1
    s_mov_b64 exec, -1
    s_add_u32 s12, s4, 393216
    s_addc_u32 s13, s5, 0
    s_mov_b32 s14, 131072
    s_mov_b32 s15, 0x00020000
    s_lshl_b32 s27, s24, 4
    v_add_u32 v11, s27, v10
    v_lshlrev_b32 v11, 3, v11
    s_lshl_b32 s27, s21, 14
    s_nop 7
    s_nop 7
    v_cndmask_b32 v33, v36, v37, s[52:53]
    v_cndmask_b32 v33, v33, v38, s[54:55]
    v_cndmask_b32 v33, v33, v39, s[56:57]
    s_mov_b64 exec, s[50:51]
    buffer_store_dwordx2 v[32:33], v11, s[12:15], s27 offen sc1
    s_mov_b64 exec, -1
    s_waitcnt vmcnt(0)
    s_barrier
    v_lshrrev_b32 v1, 6, v0
    s_nop 0
    v_readfirstlane_b32 s3, v1
    v_and_b32 v1, 63, v0
    v_and_b32 v2, 15, v1
    v_lshrrev_b32 v3, 4, v1
    v_lshlrev_b32 v4, 4, v1
    s_and_b32 s20, s2, 3
    s_lshl_b32 s20, s20, 2
    s_lshr_b32 s22, s2, 3
    s_and_b32 s21, s22, 3
    s_add_u32 s20, s20, s21
    s_lshr_b32 s22, s22, 2
    s_and_b32 s21, s2, 4
    s_lshl_b32 s21, s21, 1
    s_add_u32 s21, s21, s22
    s_mul_i32 s21, s21, 101
    s_mul_i32 s21, s21, 4370
    s_lshr_b32 s21, s21, 16
    s_lshl_b32 s25, s20, 7
    s_lshl_b32 s26, s3, 5
    s_add_u32 s25, s25, s26
    v_add_u32 v5, s25, v2
    v_mov_b32 v10, v5
    v_mul_u32_u24 v11, 2072, v3
    v_add_u32 v5, v5, v11
    v_lshlrev_b32 v5, 4, v5
    s_mov_b32 s26, 0
    s_add_u32 s8, s4, 19922944
    s_addc_u32 s9, s5, 0
    s_mov_b32 s10, 2652160
    s_mov_b32 s11, 0x00020000
    s_mov_b32 s16, s4
    s_mov_b32 s17, s5
    s_mov_b32 s18, 131072
    s_mov_b32 s19, 0x00020000
    s_add_u32 s12, s4, 393216
    s_addc_u32 s13, s5, 0
    s_mov_b32 s14, 131072
    s_mov_b32 s15, 0x00020000
    v_lshlrev_b32 v22, 15, v3
    v_lshl_add_u32 v22, v10, 3, v22
    s_mov_b32 s27, 0x4000
    v_add_u32 v6, 57344, v4
    v_add_u32 v7, 114688, v4
    v_lshlrev_b32 v23, 4, v3
    s_lshl_b32 s32, s21, 6
    s_add_u32 s32, s32, 69632
    s_barrier
    buffer_load_dwordx4 v[32:35], v5, s[8:11], s26 offen offset:0 sc1
    buffer_load_dwordx4 v[36:39], v5, s[8:11], s26 offen offset:256 sc1
    s_add_u32 s26, s26, 132608
    buffer_load_dwordx4 v[40:43], v5, s[8:11], s26 offen offset:0 sc1
    buffer_load_dwordx4 v[44:47], v5, s[8:11], s26 offen offset:256 sc1
    s_add_u32 s26, s26, 132608
    buffer_load_dwordx4 v[48:51], v5, s[8:11], s26 offen offset:0 sc1
    buffer_load_dwordx4 v[52:55], v5, s[8:11], s26 offen offset:256 sc1
    s_add_u32 s26, s26, 132608
    buffer_load_dwordx4 v[56:59], v5, s[8:11], s26 offen offset:0 sc1
    buffer_load_dwordx4 v[60:63], v5, s[8:11], s26 offen offset:256 sc1
    s_add_u32 s26, s26, 132608
    buffer_load_dwordx4 v[64:67], v5, s[8:11], s26 offen offset:0 sc1
    buffer_load_dwordx4 v[68:71], v5, s[8:11], s26 offen offset:256 sc1
    s_add_u32 s26, s26, 132608
    buffer_load_dwordx4 v[72:75], v5, s[8:11], s26 offen offset:0 sc1
    buffer_load_dwordx4 v[76:79], v5, s[8:11], s26 offen offset:256 sc1
    s_add_u32 s26, s26, 132608
    buffer_load_dwordx4 v[80:83], v5, s[8:11], s26 offen offset:0 sc1
    buffer_load_dwordx4 v[84:87], v5, s[8:11], s26 offen offset:256 sc1
    s_add_u32 s26, s26, 132608
    buffer_load_dwordx4 v[88:91], v5, s[8:11], s26 offen offset:0 sc1
    buffer_load_dwordx4 v[92:95], v5, s[8:11], s26 offen offset:256 sc1
    s_add_u32 s26, s26, 132608
    buffer_load_dwordx2 v[224:225], v22, s[12:15], 0 offen offset:0 sc1
    buffer_load_dwordx2 v[226:227], v22, s[12:15], s27 offen offset:0 sc1
    buffer_load_dwordx2 v[228:229], v22, s[12:15], 0 offen offset:128 sc1
    buffer_load_dwordx2 v[230:231], v22, s[12:15], s27 offen offset:128 sc1
    s_barrier
    ds_read_b128 v[168:171], v4 offset:0
    ds_read_b128 v[172:175], v4 offset:1024
    ds_read_b128 v[176:179], v4 offset:2048
    ds_read_b128 v[180:183], v4 offset:3072
    ds_read_b128 v[184:187], v4 offset:4096
    ds_read_b128 v[188:191], v4 offset:5120
    ds_read_b128 v[192:195], v4 offset:6144
    s_waitcnt lgkmcnt(0)
    s_waitcnt vmcnt(18)
    v_mfma_f32_16x16x32_bf16 v[112:115], v[168:171], v[32:35], 0
    ds_read_b128 v[196:199], v4 offset:7168
    v_mfma_f32_16x16x32_bf16 v[140:143], v[168:171], v[36:39], 0
    ds_read_b128 v[200:203], v4 offset:8192
    v_mfma_f32_16x16x32_bf16 v[116:119], v[172:175], v[32:35], 0
    ds_read_b128 v[204:207], v4 offset:9216
    v_mfma_f32_16x16x32_bf16 v[144:147], v[172:175], v[36:39], 0
    ds_read_b128 v[208:211], v4 offset:10240
    v_mfma_f32_16x16x32_bf16 v[120:123], v[176:179], v[32:35], 0
    ds_read_b128 v[212:215], v4 offset:11264
    v_mfma_f32_16x16x32_bf16 v[148:151], v[176:179], v[36:39], 0
    ds_read_b128 v[216:219], v4 offset:12288
    v_mfma_f32_16x16x32_bf16 v[124:127], v[180:183], v[32:35], 0
    ds_read_b128 v[220:223], v4 offset:13312
    v_mfma_f32_16x16x32_bf16 v[152:155], v[180:183], v[36:39], 0
    v_mfma_f32_16x16x32_bf16 v[128:131], v[184:187], v[32:35], 0
    v_mfma_f32_16x16x32_bf16 v[156:159], v[184:187], v[36:39], 0
    v_mfma_f32_16x16x32_bf16 v[132:135], v[188:191], v[32:35], 0
    v_mfma_f32_16x16x32_bf16 v[160:163], v[188:191], v[36:39], 0
    v_mfma_f32_16x16x32_bf16 v[136:139], v[192:195], v[32:35], 0
    v_mfma_f32_16x16x32_bf16 v[164:167], v[192:195], v[36:39], 0
    buffer_load_dwordx4 v[96:99], v5, s[8:11], s26 offen offset:0 sc1
    buffer_load_dwordx4 v[100:103], v5, s[8:11], s26 offen offset:256 sc1
    s_add_u32 s26, s26, 132608
    buffer_load_dwordx4 v[104:107], v5, s[8:11], s26 offen offset:0 sc1
    buffer_load_dwordx4 v[108:111], v5, s[8:11], s26 offen offset:256 sc1
    s_add_u32 s26, s26, 132608
    s_waitcnt lgkmcnt(0)
    s_barrier
    s_waitcnt vmcnt(20)
    v_mfma_f32_16x16x32_bf16 v[112:115], v[196:199], v[40:43], v[112:115]
    ds_read_b128 v[168:171], v4 offset:14336
    v_mfma_f32_16x16x32_bf16 v[140:143], v[196:199], v[44:47], v[140:143]
    ds_read_b128 v[172:175], v4 offset:15360
    v_mfma_f32_16x16x32_bf16 v[116:119], v[200:203], v[40:43], v[116:119]
    ds_read_b128 v[176:179], v4 offset:16384
    v_mfma_f32_16x16x32_bf16 v[144:147], v[200:203], v[44:47], v[144:147]
    ds_read_b128 v[180:183], v4 offset:17408
    v_mfma_f32_16x16x32_bf16 v[120:123], v[204:207], v[40:43], v[120:123]
    ds_read_b128 v[184:187], v4 offset:18432
    v_mfma_f32_16x16x32_bf16 v[148:151], v[204:207], v[44:47], v[148:151]
    ds_read_b128 v[188:191], v4 offset:19456
    v_mfma_f32_16x16x32_bf16 v[124:127], v[208:211], v[40:43], v[124:127]
    ds_read_b128 v[192:195], v4 offset:20480
    v_mfma_f32_16x16x32_bf16 v[152:155], v[208:211], v[44:47], v[152:155]
    v_mfma_f32_16x16x32_bf16 v[128:131], v[212:215], v[40:43], v[128:131]
    v_mfma_f32_16x16x32_bf16 v[156:159], v[212:215], v[44:47], v[156:159]
    v_mfma_f32_16x16x32_bf16 v[132:135], v[216:219], v[40:43], v[132:135]
    v_mfma_f32_16x16x32_bf16 v[160:163], v[216:219], v[44:47], v[160:163]
    v_mfma_f32_16x16x32_bf16 v[136:139], v[220:223], v[40:43], v[136:139]
    v_mfma_f32_16x16x32_bf16 v[164:167], v[220:223], v[44:47], v[164:167]
    buffer_load_dwordx4 v[32:35], v5, s[8:11], s26 offen offset:0 sc1
    buffer_load_dwordx4 v[36:39], v5, s[8:11], s26 offen offset:256 sc1
    s_add_u32 s26, s26, 132608
    buffer_load_dwordx4 v[40:43], v5, s[8:11], s26 offen offset:0 sc1
    buffer_load_dwordx4 v[44:47], v5, s[8:11], s26 offen offset:256 sc1
    s_add_u32 s26, s26, 132608
    s_waitcnt lgkmcnt(0)
    s_waitcnt vmcnt(22)
    v_mfma_f32_16x16x32_bf16 v[112:115], v[168:171], v[48:51], v[112:115]
    ds_read_b128 v[196:199], v4 offset:21504
    v_mfma_f32_16x16x32_bf16 v[140:143], v[168:171], v[52:55], v[140:143]
    ds_read_b128 v[200:203], v4 offset:22528
    v_mfma_f32_16x16x32_bf16 v[116:119], v[172:175], v[48:51], v[116:119]
    ds_read_b128 v[204:207], v4 offset:23552
    v_mfma_f32_16x16x32_bf16 v[144:147], v[172:175], v[52:55], v[144:147]
    ds_read_b128 v[208:211], v4 offset:24576
    v_mfma_f32_16x16x32_bf16 v[120:123], v[176:179], v[48:51], v[120:123]
    ds_read_b128 v[212:215], v4 offset:25600
    v_mfma_f32_16x16x32_bf16 v[148:151], v[176:179], v[52:55], v[148:151]
    ds_read_b128 v[216:219], v4 offset:26624
    v_mfma_f32_16x16x32_bf16 v[124:127], v[180:183], v[48:51], v[124:127]
    ds_read_b128 v[220:223], v4 offset:27648
    v_mfma_f32_16x16x32_bf16 v[152:155], v[180:183], v[52:55], v[152:155]
    v_mfma_f32_16x16x32_bf16 v[128:131], v[184:187], v[48:51], v[128:131]
    v_mfma_f32_16x16x32_bf16 v[156:159], v[184:187], v[52:55], v[156:159]
    v_mfma_f32_16x16x32_bf16 v[132:135], v[188:191], v[48:51], v[132:135]
    v_mfma_f32_16x16x32_bf16 v[160:163], v[188:191], v[52:55], v[160:163]
    v_mfma_f32_16x16x32_bf16 v[136:139], v[192:195], v[48:51], v[136:139]
    v_mfma_f32_16x16x32_bf16 v[164:167], v[192:195], v[52:55], v[164:167]
    buffer_load_dwordx4 v[48:51], v5, s[8:11], s26 offen offset:0 sc1
    buffer_load_dwordx4 v[52:55], v5, s[8:11], s26 offen offset:256 sc1
    s_add_u32 s26, s26, 132608
    s_waitcnt lgkmcnt(0)
    s_barrier
    s_waitcnt vmcnt(22)
    v_mfma_f32_16x16x32_bf16 v[112:115], v[196:199], v[56:59], v[112:115]
    ds_read_b128 v[168:171], v4 offset:28672
    v_mfma_f32_16x16x32_bf16 v[140:143], v[196:199], v[60:63], v[140:143]
    ds_read_b128 v[172:175], v4 offset:29696
    v_mfma_f32_16x16x32_bf16 v[116:119], v[200:203], v[56:59], v[116:119]
    ds_read_b128 v[176:179], v4 offset:30720
    v_mfma_f32_16x16x32_bf16 v[144:147], v[200:203], v[60:63], v[144:147]
    ds_read_b128 v[180:183], v4 offset:31744
    v_mfma_f32_16x16x32_bf16 v[120:123], v[204:207], v[56:59], v[120:123]
    ds_read_b128 v[184:187], v4 offset:32768
    v_mfma_f32_16x16x32_bf16 v[148:151], v[204:207], v[60:63], v[148:151]
    ds_read_b128 v[188:191], v4 offset:33792
    v_mfma_f32_16x16x32_bf16 v[124:127], v[208:211], v[56:59], v[124:127]
    ds_read_b128 v[192:195], v4 offset:34816
    v_mfma_f32_16x16x32_bf16 v[152:155], v[208:211], v[60:63], v[152:155]
    v_mfma_f32_16x16x32_bf16 v[128:131], v[212:215], v[56:59], v[128:131]
    v_mfma_f32_16x16x32_bf16 v[156:159], v[212:215], v[60:63], v[156:159]
    v_mfma_f32_16x16x32_bf16 v[132:135], v[216:219], v[56:59], v[132:135]
    v_mfma_f32_16x16x32_bf16 v[160:163], v[216:219], v[60:63], v[160:163]
    v_mfma_f32_16x16x32_bf16 v[136:139], v[220:223], v[56:59], v[136:139]
    v_mfma_f32_16x16x32_bf16 v[164:167], v[220:223], v[60:63], v[164:167]
    buffer_load_dwordx4 v[56:59], v5, s[8:11], s26 offen offset:0 sc1
    buffer_load_dwordx4 v[60:63], v5, s[8:11], s26 offen offset:256 sc1
    s_add_u32 s26, s26, 132608
    s_waitcnt lgkmcnt(0)
    s_waitcnt vmcnt(22)
    v_mfma_f32_16x16x32_bf16 v[112:115], v[168:171], v[64:67], v[112:115]
    ds_read_b128 v[196:199], v4 offset:35840
    v_mfma_f32_16x16x32_bf16 v[140:143], v[168:171], v[68:71], v[140:143]
    ds_read_b128 v[200:203], v4 offset:36864
    v_mfma_f32_16x16x32_bf16 v[116:119], v[172:175], v[64:67], v[116:119]
    ds_read_b128 v[204:207], v4 offset:37888
    v_mfma_f32_16x16x32_bf16 v[144:147], v[172:175], v[68:71], v[144:147]
    ds_read_b128 v[208:211], v4 offset:38912
    v_mfma_f32_16x16x32_bf16 v[120:123], v[176:179], v[64:67], v[120:123]
    ds_read_b128 v[212:215], v4 offset:39936
    v_mfma_f32_16x16x32_bf16 v[148:151], v[176:179], v[68:71], v[148:151]
    ds_read_b128 v[216:219], v4 offset:40960
    v_mfma_f32_16x16x32_bf16 v[124:127], v[180:183], v[64:67], v[124:127]
    ds_read_b128 v[220:223], v4 offset:41984
    v_mfma_f32_16x16x32_bf16 v[152:155], v[180:183], v[68:71], v[152:155]
    v_mfma_f32_16x16x32_bf16 v[128:131], v[184:187], v[64:67], v[128:131]
    v_mfma_f32_16x16x32_bf16 v[156:159], v[184:187], v[68:71], v[156:159]
    v_mfma_f32_16x16x32_bf16 v[132:135], v[188:191], v[64:67], v[132:135]
    v_mfma_f32_16x16x32_bf16 v[160:163], v[188:191], v[68:71], v[160:163]
    v_mfma_f32_16x16x32_bf16 v[136:139], v[192:195], v[64:67], v[136:139]
    v_mfma_f32_16x16x32_bf16 v[164:167], v[192:195], v[68:71], v[164:167]
    buffer_load_dwordx4 v[64:67], v5, s[8:11], s26 offen offset:0 sc1
    buffer_load_dwordx4 v[68:71], v5, s[8:11], s26 offen offset:256 sc1
    s_add_u32 s26, s26, 132608
    s_waitcnt lgkmcnt(0)
    s_barrier
    s_waitcnt vmcnt(22)
    v_mfma_f32_16x16x32_bf16 v[112:115], v[196:199], v[72:75], v[112:115]
    ds_read_b128 v[168:171], v4 offset:43008
    v_mfma_f32_16x16x32_bf16 v[140:143], v[196:199], v[76:79], v[140:143]
    ds_read_b128 v[172:175], v4 offset:44032
    v_mfma_f32_16x16x32_bf16 v[116:119], v[200:203], v[72:75], v[116:119]
    ds_read_b128 v[176:179], v4 offset:45056
    v_mfma_f32_16x16x32_bf16 v[144:147], v[200:203], v[76:79], v[144:147]
    ds_read_b128 v[180:183], v4 offset:46080
    v_mfma_f32_16x16x32_bf16 v[120:123], v[204:207], v[72:75], v[120:123]
    ds_read_b128 v[184:187], v4 offset:47104
    v_mfma_f32_16x16x32_bf16 v[148:151], v[204:207], v[76:79], v[148:151]
    ds_read_b128 v[188:191], v4 offset:48128
    v_mfma_f32_16x16x32_bf16 v[124:127], v[208:211], v[72:75], v[124:127]
    ds_read_b128 v[192:195], v4 offset:49152
    v_mfma_f32_16x16x32_bf16 v[152:155], v[208:211], v[76:79], v[152:155]
    v_mfma_f32_16x16x32_bf16 v[128:131], v[212:215], v[72:75], v[128:131]
    v_mfma_f32_16x16x32_bf16 v[156:159], v[212:215], v[76:79], v[156:159]
    v_mfma_f32_16x16x32_bf16 v[132:135], v[216:219], v[72:75], v[132:135]
    v_mfma_f32_16x16x32_bf16 v[160:163], v[216:219], v[76:79], v[160:163]
    v_mfma_f32_16x16x32_bf16 v[136:139], v[220:223], v[72:75], v[136:139]
    v_mfma_f32_16x16x32_bf16 v[164:167], v[220:223], v[76:79], v[164:167]
    buffer_load_dwordx4 v[72:75], v5, s[8:11], s26 offen offset:0 sc1
    buffer_load_dwordx4 v[76:79], v5, s[8:11], s26 offen offset:256 sc1
    s_add_u32 s26, s26, 132608
    s_waitcnt lgkmcnt(0)
    s_waitcnt vmcnt(22)
    v_mfma_f32_16x16x32_bf16 v[112:115], v[168:171], v[80:83], v[112:115]
    ds_read_b128 v[196:199], v4 offset:50176
    v_mfma_f32_16x16x32_bf16 v[140:143], v[168:171], v[84:87], v[140:143]
    ds_read_b128 v[200:203], v4 offset:51200
    v_mfma_f32_16x16x32_bf16 v[116:119], v[172:175], v[80:83], v[116:119]
    ds_read_b128 v[204:207], v4 offset:52224
    v_mfma_f32_16x16x32_bf16 v[144:147], v[172:175], v[84:87], v[144:147]
    ds_read_b128 v[208:211], v4 offset:53248
    v_mfma_f32_16x16x32_bf16 v[120:123], v[176:179], v[80:83], v[120:123]
    ds_read_b128 v[212:215], v4 offset:54272
    v_mfma_f32_16x16x32_bf16 v[148:151], v[176:179], v[84:87], v[148:151]
    ds_read_b128 v[216:219], v4 offset:55296
    v_mfma_f32_16x16x32_bf16 v[124:127], v[180:183], v[80:83], v[124:127]
    ds_read_b128 v[220:223], v4 offset:56320
    v_mfma_f32_16x16x32_bf16 v[152:155], v[180:183], v[84:87], v[152:155]
    v_mfma_f32_16x16x32_bf16 v[128:131], v[184:187], v[80:83], v[128:131]
    v_mfma_f32_16x16x32_bf16 v[156:159], v[184:187], v[84:87], v[156:159]
    v_mfma_f32_16x16x32_bf16 v[132:135], v[188:191], v[80:83], v[132:135]
    v_mfma_f32_16x16x32_bf16 v[160:163], v[188:191], v[84:87], v[160:163]
    v_mfma_f32_16x16x32_bf16 v[136:139], v[192:195], v[80:83], v[136:139]
    v_mfma_f32_16x16x32_bf16 v[164:167], v[192:195], v[84:87], v[164:167]
    buffer_load_dwordx4 v[80:83], v5, s[8:11], s26 offen offset:0 sc1
    buffer_load_dwordx4 v[84:87], v5, s[8:11], s26 offen offset:256 sc1
    s_add_u32 s26, s26, 132608
    s_waitcnt lgkmcnt(0)
    s_barrier
    s_waitcnt vmcnt(22)
    v_mfma_f32_16x16x32_bf16 v[112:115], v[196:199], v[88:91], v[112:115]
    ds_read_b128 v[168:171], v6 offset:0
    v_mfma_f32_16x16x32_bf16 v[140:143], v[196:199], v[92:95], v[140:143]
    ds_read_b128 v[172:175], v6 offset:1024
    v_mfma_f32_16x16x32_bf16 v[116:119], v[200:203], v[88:91], v[116:119]
    ds_read_b128 v[176:179], v6 offset:2048
    v_mfma_f32_16x16x32_bf16 v[144:147], v[200:203], v[92:95], v[144:147]
    ds_read_b128 v[180:183], v6 offset:3072
    v_mfma_f32_16x16x32_bf16 v[120:123], v[204:207], v[88:91], v[120:123]
    ds_read_b128 v[184:187], v6 offset:4096
    v_mfma_f32_16x16x32_bf16 v[148:151], v[204:207], v[92:95], v[148:151]
    ds_read_b128 v[188:191], v6 offset:5120
    v_mfma_f32_16x16x32_bf16 v[124:127], v[208:211], v[88:91], v[124:127]
    ds_read_b128 v[192:195], v6 offset:6144
    v_mfma_f32_16x16x32_bf16 v[152:155], v[208:211], v[92:95], v[152:155]
    v_mfma_f32_16x16x32_bf16 v[128:131], v[212:215], v[88:91], v[128:131]
    v_mfma_f32_16x16x32_bf16 v[156:159], v[212:215], v[92:95], v[156:159]
    v_mfma_f32_16x16x32_bf16 v[132:135], v[216:219], v[88:91], v[132:135]
    v_mfma_f32_16x16x32_bf16 v[160:163], v[216:219], v[92:95], v[160:163]
    v_mfma_f32_16x16x32_bf16 v[136:139], v[220:223], v[88:91], v[136:139]
    v_mfma_f32_16x16x32_bf16 v[164:167], v[220:223], v[92:95], v[164:167]
    buffer_load_dwordx4 v[88:91], v5, s[8:11], s26 offen offset:0 sc1
    buffer_load_dwordx4 v[92:95], v5, s[8:11], s26 offen offset:256 sc1
    s_add_u32 s26, s26, 132608
    s_waitcnt lgkmcnt(0)
    s_waitcnt vmcnt(18)
    v_mfma_f32_16x16x32_bf16 v[112:115], v[168:171], v[96:99], v[112:115]
    ds_read_b128 v[196:199], v6 offset:7168
    v_mfma_f32_16x16x32_bf16 v[140:143], v[168:171], v[100:103], v[140:143]
    ds_read_b128 v[200:203], v6 offset:8192
    v_mfma_f32_16x16x32_bf16 v[116:119], v[172:175], v[96:99], v[116:119]
    ds_read_b128 v[204:207], v6 offset:9216
    v_mfma_f32_16x16x32_bf16 v[144:147], v[172:175], v[100:103], v[144:147]
    ds_read_b128 v[208:211], v6 offset:10240
    v_mfma_f32_16x16x32_bf16 v[120:123], v[176:179], v[96:99], v[120:123]
    ds_read_b128 v[212:215], v6 offset:11264
    v_mfma_f32_16x16x32_bf16 v[148:151], v[176:179], v[100:103], v[148:151]
    ds_read_b128 v[216:219], v6 offset:12288
    v_mfma_f32_16x16x32_bf16 v[124:127], v[180:183], v[96:99], v[124:127]
    ds_read_b128 v[220:223], v6 offset:13312
    v_mfma_f32_16x16x32_bf16 v[152:155], v[180:183], v[100:103], v[152:155]
    v_mfma_f32_16x16x32_bf16 v[128:131], v[184:187], v[96:99], v[128:131]
    v_mfma_f32_16x16x32_bf16 v[156:159], v[184:187], v[100:103], v[156:159]
    v_mfma_f32_16x16x32_bf16 v[132:135], v[188:191], v[96:99], v[132:135]
    v_mfma_f32_16x16x32_bf16 v[160:163], v[188:191], v[100:103], v[160:163]
    v_mfma_f32_16x16x32_bf16 v[136:139], v[192:195], v[96:99], v[136:139]
    v_mfma_f32_16x16x32_bf16 v[164:167], v[192:195], v[100:103], v[164:167]
    buffer_load_dwordx4 v[96:99], v5, s[8:11], s26 offen offset:0 sc1
    buffer_load_dwordx4 v[100:103], v5, s[8:11], s26 offen offset:256 sc1
    s_add_u32 s26, s26, 132608
    s_waitcnt lgkmcnt(0)
    s_barrier
    s_waitcnt vmcnt(18)
    v_mfma_f32_16x16x32_bf16 v[112:115], v[196:199], v[104:107], v[112:115]
    ds_read_b128 v[168:171], v6 offset:14336
    v_mfma_f32_16x16x32_bf16 v[140:143], v[196:199], v[108:111], v[140:143]
    ds_read_b128 v[172:175], v6 offset:15360
    v_mfma_f32_16x16x32_bf16 v[116:119], v[200:203], v[104:107], v[116:119]
    ds_read_b128 v[176:179], v6 offset:16384
    v_mfma_f32_16x16x32_bf16 v[144:147], v[200:203], v[108:111], v[144:147]
    ds_read_b128 v[180:183], v6 offset:17408
    v_mfma_f32_16x16x32_bf16 v[120:123], v[204:207], v[104:107], v[120:123]
    ds_read_b128 v[184:187], v6 offset:18432
    v_mfma_f32_16x16x32_bf16 v[148:151], v[204:207], v[108:111], v[148:151]
    ds_read_b128 v[188:191], v6 offset:19456
    v_mfma_f32_16x16x32_bf16 v[124:127], v[208:211], v[104:107], v[124:127]
    ds_read_b128 v[192:195], v6 offset:20480
    v_mfma_f32_16x16x32_bf16 v[152:155], v[208:211], v[108:111], v[152:155]
    v_mfma_f32_16x16x32_bf16 v[128:131], v[212:215], v[104:107], v[128:131]
    v_mfma_f32_16x16x32_bf16 v[156:159], v[212:215], v[108:111], v[156:159]
    v_mfma_f32_16x16x32_bf16 v[132:135], v[216:219], v[104:107], v[132:135]
    v_mfma_f32_16x16x32_bf16 v[160:163], v[216:219], v[108:111], v[160:163]
    v_mfma_f32_16x16x32_bf16 v[136:139], v[220:223], v[104:107], v[136:139]
    v_mfma_f32_16x16x32_bf16 v[164:167], v[220:223], v[108:111], v[164:167]
    buffer_load_dwordx4 v[104:107], v5, s[8:11], s26 offen offset:0 sc1
    buffer_load_dwordx4 v[108:111], v5, s[8:11], s26 offen offset:256 sc1
    s_add_u32 s26, s26, 132608
    s_waitcnt lgkmcnt(0)
    s_waitcnt vmcnt(18)
    v_mfma_f32_16x16x32_bf16 v[112:115], v[168:171], v[32:35], v[112:115]
    ds_read_b128 v[196:199], v6 offset:21504
    v_mfma_f32_16x16x32_bf16 v[140:143], v[168:171], v[36:39], v[140:143]
    ds_read_b128 v[200:203], v6 offset:22528
    v_mfma_f32_16x16x32_bf16 v[116:119], v[172:175], v[32:35], v[116:119]
    ds_read_b128 v[204:207], v6 offset:23552
    v_mfma_f32_16x16x32_bf16 v[144:147], v[172:175], v[36:39], v[144:147]
    ds_read_b128 v[208:211], v6 offset:24576
    v_mfma_f32_16x16x32_bf16 v[120:123], v[176:179], v[32:35], v[120:123]
    ds_read_b128 v[212:215], v6 offset:25600
    v_mfma_f32_16x16x32_bf16 v[148:151], v[176:179], v[36:39], v[148:151]
    ds_read_b128 v[216:219], v6 offset:26624
    v_mfma_f32_16x16x32_bf16 v[124:127], v[180:183], v[32:35], v[124:127]
    ds_read_b128 v[220:223], v6 offset:27648
    v_mfma_f32_16x16x32_bf16 v[152:155], v[180:183], v[36:39], v[152:155]
    v_mfma_f32_16x16x32_bf16 v[128:131], v[184:187], v[32:35], v[128:131]
    v_mfma_f32_16x16x32_bf16 v[156:159], v[184:187], v[36:39], v[156:159]
    v_mfma_f32_16x16x32_bf16 v[132:135], v[188:191], v[32:35], v[132:135]
    v_mfma_f32_16x16x32_bf16 v[160:163], v[188:191], v[36:39], v[160:163]
    v_mfma_f32_16x16x32_bf16 v[136:139], v[192:195], v[32:35], v[136:139]
    v_mfma_f32_16x16x32_bf16 v[164:167], v[192:195], v[36:39], v[164:167]
    s_waitcnt lgkmcnt(0)
    s_barrier
    s_waitcnt vmcnt(16)
    v_mfma_f32_16x16x32_bf16 v[112:115], v[196:199], v[40:43], v[112:115]
    ds_read_b128 v[168:171], v6 offset:28672
    v_mfma_f32_16x16x32_bf16 v[140:143], v[196:199], v[44:47], v[140:143]
    ds_read_b128 v[172:175], v6 offset:29696
    v_mfma_f32_16x16x32_bf16 v[116:119], v[200:203], v[40:43], v[116:119]
    ds_read_b128 v[176:179], v6 offset:30720
    v_mfma_f32_16x16x32_bf16 v[144:147], v[200:203], v[44:47], v[144:147]
    ds_read_b128 v[180:183], v6 offset:31744
    v_mfma_f32_16x16x32_bf16 v[120:123], v[204:207], v[40:43], v[120:123]
    ds_read_b128 v[184:187], v6 offset:32768
    v_mfma_f32_16x16x32_bf16 v[148:151], v[204:207], v[44:47], v[148:151]
    ds_read_b128 v[188:191], v6 offset:33792
    v_mfma_f32_16x16x32_bf16 v[124:127], v[208:211], v[40:43], v[124:127]
    ds_read_b128 v[192:195], v6 offset:34816
    v_mfma_f32_16x16x32_bf16 v[152:155], v[208:211], v[44:47], v[152:155]
    v_mfma_f32_16x16x32_bf16 v[128:131], v[212:215], v[40:43], v[128:131]
    v_mfma_f32_16x16x32_bf16 v[156:159], v[212:215], v[44:47], v[156:159]
    v_mfma_f32_16x16x32_bf16 v[132:135], v[216:219], v[40:43], v[132:135]
    v_mfma_f32_16x16x32_bf16 v[160:163], v[216:219], v[44:47], v[160:163]
    v_mfma_f32_16x16x32_bf16 v[136:139], v[220:223], v[40:43], v[136:139]
    v_mfma_f32_16x16x32_bf16 v[164:167], v[220:223], v[44:47], v[164:167]
    s_waitcnt lgkmcnt(0)
    s_waitcnt vmcnt(14)
    v_mfma_f32_16x16x32_bf16 v[112:115], v[168:171], v[48:51], v[112:115]
    ds_read_b128 v[196:199], v6 offset:35840
    v_mfma_f32_16x16x32_bf16 v[140:143], v[168:171], v[52:55], v[140:143]
    ds_read_b128 v[200:203], v6 offset:36864
    v_mfma_f32_16x16x32_bf16 v[116:119], v[172:175], v[48:51], v[116:119]
    ds_read_b128 v[204:207], v6 offset:37888
    v_mfma_f32_16x16x32_bf16 v[144:147], v[172:175], v[52:55], v[144:147]
    ds_read_b128 v[208:211], v6 offset:38912
    v_mfma_f32_16x16x32_bf16 v[120:123], v[176:179], v[48:51], v[120:123]
    ds_read_b128 v[212:215], v6 offset:39936
    v_mfma_f32_16x16x32_bf16 v[148:151], v[176:179], v[52:55], v[148:151]
    ds_read_b128 v[216:219], v6 offset:40960
    v_mfma_f32_16x16x32_bf16 v[124:127], v[180:183], v[48:51], v[124:127]
    ds_read_b128 v[220:223], v6 offset:41984
    v_mfma_f32_16x16x32_bf16 v[152:155], v[180:183], v[52:55], v[152:155]
    v_mfma_f32_16x16x32_bf16 v[128:131], v[184:187], v[48:51], v[128:131]
    v_mfma_f32_16x16x32_bf16 v[156:159], v[184:187], v[52:55], v[156:159]
    v_mfma_f32_16x16x32_bf16 v[132:135], v[188:191], v[48:51], v[132:135]
    v_mfma_f32_16x16x32_bf16 v[160:163], v[188:191], v[52:55], v[160:163]
    v_mfma_f32_16x16x32_bf16 v[136:139], v[192:195], v[48:51], v[136:139]
    v_mfma_f32_16x16x32_bf16 v[164:167], v[192:195], v[52:55], v[164:167]
    s_waitcnt lgkmcnt(0)
    s_barrier
    s_waitcnt vmcnt(12)
    v_mfma_f32_16x16x32_bf16 v[112:115], v[196:199], v[56:59], v[112:115]
    ds_read_b128 v[168:171], v6 offset:43008
    v_mfma_f32_16x16x32_bf16 v[140:143], v[196:199], v[60:63], v[140:143]
    ds_read_b128 v[172:175], v6 offset:44032
    v_mfma_f32_16x16x32_bf16 v[116:119], v[200:203], v[56:59], v[116:119]
    ds_read_b128 v[176:179], v6 offset:45056
    v_mfma_f32_16x16x32_bf16 v[144:147], v[200:203], v[60:63], v[144:147]
    ds_read_b128 v[180:183], v6 offset:46080
    v_mfma_f32_16x16x32_bf16 v[120:123], v[204:207], v[56:59], v[120:123]
    ds_read_b128 v[184:187], v6 offset:47104
    v_mfma_f32_16x16x32_bf16 v[148:151], v[204:207], v[60:63], v[148:151]
    ds_read_b128 v[188:191], v6 offset:48128
    v_mfma_f32_16x16x32_bf16 v[124:127], v[208:211], v[56:59], v[124:127]
    ds_read_b128 v[192:195], v6 offset:49152
    v_mfma_f32_16x16x32_bf16 v[152:155], v[208:211], v[60:63], v[152:155]
    v_mfma_f32_16x16x32_bf16 v[128:131], v[212:215], v[56:59], v[128:131]
    v_mfma_f32_16x16x32_bf16 v[156:159], v[212:215], v[60:63], v[156:159]
    v_mfma_f32_16x16x32_bf16 v[132:135], v[216:219], v[56:59], v[132:135]
    v_mfma_f32_16x16x32_bf16 v[160:163], v[216:219], v[60:63], v[160:163]
    v_mfma_f32_16x16x32_bf16 v[136:139], v[220:223], v[56:59], v[136:139]
    v_mfma_f32_16x16x32_bf16 v[164:167], v[220:223], v[60:63], v[164:167]
    buffer_load_dwordx4 v[32:35], v23, s[16:19], s32 offen offset:0
    buffer_load_dwordx4 v[36:39], v23, s[16:19], s32 offen offset:64
    buffer_load_dwordx4 v[40:43], v23, s[16:19], s32 offen offset:128
    buffer_load_dwordx4 v[44:47], v23, s[16:19], s32 offen offset:192
    buffer_load_dwordx4 v[48:51], v23, s[16:19], s32 offen offset:256
    buffer_load_dwordx4 v[52:55], v23, s[16:19], s32 offen offset:320
    buffer_load_dwordx4 v[56:59], v23, s[16:19], s32 offen offset:384
    s_waitcnt lgkmcnt(0)
    s_waitcnt vmcnt(17)
    v_mfma_f32_16x16x32_bf16 v[112:115], v[168:171], v[64:67], v[112:115]
    ds_read_b128 v[196:199], v6 offset:50176
    v_mfma_f32_16x16x32_bf16 v[140:143], v[168:171], v[68:71], v[140:143]
    ds_read_b128 v[200:203], v6 offset:51200
    v_mfma_f32_16x16x32_bf16 v[116:119], v[172:175], v[64:67], v[116:119]
    ds_read_b128 v[204:207], v6 offset:52224
    v_mfma_f32_16x16x32_bf16 v[144:147], v[172:175], v[68:71], v[144:147]
    ds_read_b128 v[208:211], v6 offset:53248
    v_mfma_f32_16x16x32_bf16 v[120:123], v[176:179], v[64:67], v[120:123]
    ds_read_b128 v[212:215], v6 offset:54272
    v_mfma_f32_16x16x32_bf16 v[148:151], v[176:179], v[68:71], v[148:151]
    ds_read_b128 v[216:219], v6 offset:55296
    v_mfma_f32_16x16x32_bf16 v[124:127], v[180:183], v[64:67], v[124:127]
    ds_read_b128 v[220:223], v6 offset:56320
    v_mfma_f32_16x16x32_bf16 v[152:155], v[180:183], v[68:71], v[152:155]
    v_mfma_f32_16x16x32_bf16 v[128:131], v[184:187], v[64:67], v[128:131]
    v_mfma_f32_16x16x32_bf16 v[156:159], v[184:187], v[68:71], v[156:159]
    v_mfma_f32_16x16x32_bf16 v[132:135], v[188:191], v[64:67], v[132:135]
    v_mfma_f32_16x16x32_bf16 v[160:163], v[188:191], v[68:71], v[160:163]
    v_mfma_f32_16x16x32_bf16 v[136:139], v[192:195], v[64:67], v[136:139]
    v_mfma_f32_16x16x32_bf16 v[164:167], v[192:195], v[68:71], v[164:167]
    s_waitcnt lgkmcnt(0)
    s_barrier
    s_waitcnt vmcnt(15)
    v_mfma_f32_16x16x32_bf16 v[112:115], v[196:199], v[72:75], v[112:115]
    ds_read_b128 v[168:171], v7 offset:0
    v_mfma_f32_16x16x32_bf16 v[140:143], v[196:199], v[76:79], v[140:143]
    ds_read_b128 v[172:175], v7 offset:1024
    v_mfma_f32_16x16x32_bf16 v[116:119], v[200:203], v[72:75], v[116:119]
    ds_read_b128 v[176:179], v7 offset:2048
    v_mfma_f32_16x16x32_bf16 v[144:147], v[200:203], v[76:79], v[144:147]
    ds_read_b128 v[180:183], v7 offset:3072
    v_mfma_f32_16x16x32_bf16 v[120:123], v[204:207], v[72:75], v[120:123]
    ds_read_b128 v[184:187], v7 offset:4096
    v_mfma_f32_16x16x32_bf16 v[148:151], v[204:207], v[76:79], v[148:151]
    ds_read_b128 v[188:191], v7 offset:5120
    v_mfma_f32_16x16x32_bf16 v[124:127], v[208:211], v[72:75], v[124:127]
    ds_read_b128 v[192:195], v7 offset:6144
    v_mfma_f32_16x16x32_bf16 v[152:155], v[208:211], v[76:79], v[152:155]
    v_mfma_f32_16x16x32_bf16 v[128:131], v[212:215], v[72:75], v[128:131]
    v_mfma_f32_16x16x32_bf16 v[156:159], v[212:215], v[76:79], v[156:159]
    v_mfma_f32_16x16x32_bf16 v[132:135], v[216:219], v[72:75], v[132:135]
    v_mfma_f32_16x16x32_bf16 v[160:163], v[216:219], v[76:79], v[160:163]
    v_mfma_f32_16x16x32_bf16 v[136:139], v[220:223], v[72:75], v[136:139]
    v_mfma_f32_16x16x32_bf16 v[164:167], v[220:223], v[76:79], v[164:167]
    s_waitcnt lgkmcnt(0)
    s_waitcnt vmcnt(13)
    v_mfma_f32_16x16x32_bf16 v[112:115], v[168:171], v[80:83], v[112:115]
    ds_read_b128 v[196:199], v7 offset:7168
    v_mfma_f32_16x16x32_bf16 v[140:143], v[168:171], v[84:87], v[140:143]
    ds_read_b128 v[200:203], v7 offset:8192
    v_mfma_f32_16x16x32_bf16 v[116:119], v[172:175], v[80:83], v[116:119]
    ds_read_b128 v[204:207], v7 offset:9216
    v_mfma_f32_16x16x32_bf16 v[144:147], v[172:175], v[84:87], v[144:147]
    ds_read_b128 v[208:211], v7 offset:10240
    v_mfma_f32_16x16x32_bf16 v[120:123], v[176:179], v[80:83], v[120:123]
    ds_read_b128 v[212:215], v7 offset:11264
    v_mfma_f32_16x16x32_bf16 v[148:151], v[176:179], v[84:87], v[148:151]
    ds_read_b128 v[216:219], v7 offset:12288
    v_mfma_f32_16x16x32_bf16 v[124:127], v[180:183], v[80:83], v[124:127]
    ds_read_b128 v[220:223], v7 offset:13312
    v_mfma_f32_16x16x32_bf16 v[152:155], v[180:183], v[84:87], v[152:155]
    v_mfma_f32_16x16x32_bf16 v[128:131], v[184:187], v[80:83], v[128:131]
    v_mfma_f32_16x16x32_bf16 v[156:159], v[184:187], v[84:87], v[156:159]
    v_mfma_f32_16x16x32_bf16 v[132:135], v[188:191], v[80:83], v[132:135]
    v_mfma_f32_16x16x32_bf16 v[160:163], v[188:191], v[84:87], v[160:163]
    v_mfma_f32_16x16x32_bf16 v[136:139], v[192:195], v[80:83], v[136:139]
    v_mfma_f32_16x16x32_bf16 v[164:167], v[192:195], v[84:87], v[164:167]
    s_waitcnt lgkmcnt(0)
    s_barrier
    s_waitcnt vmcnt(11)
    v_mfma_f32_16x16x32_bf16 v[112:115], v[196:199], v[88:91], v[112:115]
    ds_read_b128 v[168:171], v7 offset:14336
    v_mfma_f32_16x16x32_bf16 v[140:143], v[196:199], v[92:95], v[140:143]
    ds_read_b128 v[172:175], v7 offset:15360
    v_mfma_f32_16x16x32_bf16 v[116:119], v[200:203], v[88:91], v[116:119]
    ds_read_b128 v[176:179], v7 offset:16384
    v_mfma_f32_16x16x32_bf16 v[144:147], v[200:203], v[92:95], v[144:147]
    ds_read_b128 v[180:183], v7 offset:17408
    v_mfma_f32_16x16x32_bf16 v[120:123], v[204:207], v[88:91], v[120:123]
    ds_read_b128 v[184:187], v7 offset:18432
    v_mfma_f32_16x16x32_bf16 v[148:151], v[204:207], v[92:95], v[148:151]
    ds_read_b128 v[188:191], v7 offset:19456
    v_mfma_f32_16x16x32_bf16 v[124:127], v[208:211], v[88:91], v[124:127]
    ds_read_b128 v[192:195], v7 offset:20480
    v_mfma_f32_16x16x32_bf16 v[152:155], v[208:211], v[92:95], v[152:155]
    v_mfma_f32_16x16x32_bf16 v[128:131], v[212:215], v[88:91], v[128:131]
    v_mfma_f32_16x16x32_bf16 v[156:159], v[212:215], v[92:95], v[156:159]
    v_mfma_f32_16x16x32_bf16 v[132:135], v[216:219], v[88:91], v[132:135]
    v_mfma_f32_16x16x32_bf16 v[160:163], v[216:219], v[92:95], v[160:163]
    v_mfma_f32_16x16x32_bf16 v[136:139], v[220:223], v[88:91], v[136:139]
    v_mfma_f32_16x16x32_bf16 v[164:167], v[220:223], v[92:95], v[164:167]
    s_waitcnt lgkmcnt(0)
    s_waitcnt vmcnt(9)
    v_mfma_f32_16x16x32_bf16 v[112:115], v[168:171], v[96:99], v[112:115]
    ds_read_b128 v[196:199], v7 offset:21504
    v_mfma_f32_16x16x32_bf16 v[140:143], v[168:171], v[100:103], v[140:143]
    ds_read_b128 v[200:203], v7 offset:22528
    v_mfma_f32_16x16x32_bf16 v[116:119], v[172:175], v[96:99], v[116:119]
    ds_read_b128 v[204:207], v7 offset:23552
    v_mfma_f32_16x16x32_bf16 v[144:147], v[172:175], v[100:103], v[144:147]
    ds_read_b128 v[208:211], v7 offset:24576
    v_mfma_f32_16x16x32_bf16 v[120:123], v[176:179], v[96:99], v[120:123]
    ds_read_b128 v[212:215], v7 offset:25600
    v_mfma_f32_16x16x32_bf16 v[148:151], v[176:179], v[100:103], v[148:151]
    ds_read_b128 v[216:219], v7 offset:26624
    v_mfma_f32_16x16x32_bf16 v[124:127], v[180:183], v[96:99], v[124:127]
    ds_read_b128 v[220:223], v7 offset:27648
    v_mfma_f32_16x16x32_bf16 v[152:155], v[180:183], v[100:103], v[152:155]
    v_mfma_f32_16x16x32_bf16 v[128:131], v[184:187], v[96:99], v[128:131]
    v_mfma_f32_16x16x32_bf16 v[156:159], v[184:187], v[100:103], v[156:159]
    v_mfma_f32_16x16x32_bf16 v[132:135], v[188:191], v[96:99], v[132:135]
    v_mfma_f32_16x16x32_bf16 v[160:163], v[188:191], v[100:103], v[160:163]
    v_mfma_f32_16x16x32_bf16 v[136:139], v[192:195], v[96:99], v[136:139]
    v_mfma_f32_16x16x32_bf16 v[164:167], v[192:195], v[100:103], v[164:167]
    s_waitcnt lgkmcnt(0)
    s_barrier
    s_waitcnt vmcnt(7)
    v_mfma_f32_16x16x32_bf16 v[112:115], v[196:199], v[104:107], v[112:115]
    v_mfma_f32_16x16x32_bf16 v[140:143], v[196:199], v[108:111], v[140:143]
    v_mfma_f32_16x16x32_bf16 v[116:119], v[200:203], v[104:107], v[116:119]
    v_mfma_f32_16x16x32_bf16 v[144:147], v[200:203], v[108:111], v[144:147]
    v_mfma_f32_16x16x32_bf16 v[120:123], v[204:207], v[104:107], v[120:123]
    v_mfma_f32_16x16x32_bf16 v[148:151], v[204:207], v[108:111], v[148:151]
    v_mfma_f32_16x16x32_bf16 v[124:127], v[208:211], v[104:107], v[124:127]
    v_mfma_f32_16x16x32_bf16 v[152:155], v[208:211], v[108:111], v[152:155]
    v_mfma_f32_16x16x32_bf16 v[128:131], v[212:215], v[104:107], v[128:131]
    v_mfma_f32_16x16x32_bf16 v[156:159], v[212:215], v[108:111], v[156:159]
    v_mfma_f32_16x16x32_bf16 v[132:135], v[216:219], v[104:107], v[132:135]
    v_mfma_f32_16x16x32_bf16 v[160:163], v[216:219], v[108:111], v[160:163]
    v_mfma_f32_16x16x32_bf16 v[136:139], v[220:223], v[104:107], v[136:139]
    v_mfma_f32_16x16x32_bf16 v[164:167], v[220:223], v[108:111], v[164:167]
    v_mov_b32 v28, -0.1029432395800235
    v_mov_b32 v29, -0.1029432395800235
    v_mov_b32 v30, -2.302208198144325
    v_mov_b32 v31, -2.302208198144325
    s_add_u32 s36, s4, 23068672
    s_addc_u32 s37, s5, 0
    s_mov_b32 s38, 7160832
    s_mov_b32 s39, 0x00020000
    s_waitcnt vmcnt(31)
    v_add_f32 v224, v224, v226
    v_add_f32 v225, v225, v227
    v_add_f32 v228, v228, v230
    v_add_f32 v229, v229, v231
    v_mov_b32 v232, v224
    v_mov_b32 v233, v225
    v_mov_b32 v234, v228
    v_mov_b32 v235, v229
    s_nop 1
    v_permlane32_swap_b32 v224, v232
    v_permlane32_swap_b32 v225, v233
    v_permlane32_swap_b32 v228, v234
    v_permlane32_swap_b32 v229, v235
    s_nop 1
    v_add_f32 v224, v224, v232
    v_add_f32 v225, v225, v233
    v_add_f32 v228, v228, v234
    v_add_f32 v229, v229, v235
    v_mov_b32 v232, v224
    v_mov_b32 v233, v225
    v_mov_b32 v234, v228
    v_mov_b32 v235, v229
    s_nop 1
    v_permlane16_swap_b32 v224, v232
    v_permlane16_swap_b32 v225, v233
    v_permlane16_swap_b32 v228, v234
    v_permlane16_swap_b32 v229, v235
    s_nop 1
    v_add_f32 v224, v224, v232
    v_add_f32 v225, v225, v233
    v_add_f32 v228, v228, v234
    v_add_f32 v229, v229, v235
    v_mul_f32 v12, 0.0015625, v224
    v_mul_f32 v14, 0.0015625, v225
    v_fma_f32 v14, -v12, v12, v14
    v_max_f32 v14, 0, v14
    v_add_f32 v14, 1e-5, v14
    v_rsq_f32 v14, v14
    s_nop 0
    v_mov_b32 v13, v12
    v_mov_b32 v15, v14
    v_mul_f32 v16, 0.0015625, v228
    v_mul_f32 v18, 0.0015625, v229
    v_fma_f32 v18, -v16, v16, v18
    v_max_f32 v18, 0, v18
    v_add_f32 v18, 1e-5, v18
    v_rsq_f32 v18, v18
    s_nop 0
    v_mov_b32 v17, v16
    v_mov_b32 v19, v18
    s_waitcnt vmcnt(0)
    v_lshrrev_b32 v11, 1, v3
    v_mul_u32_u24 v11, 2072, v11
    v_and_b32 v9, 1, v3
    v_lshl_add_u32 v11, v9, 4, v11
    v_add_u32 v11, v11, v10
    v_lshlrev_b32 v9, 4, v11
    s_mul_i32 s44, s21, 66304
    v_pk_fma_f32 v[112:113], v[12:13], v[32:33], v[112:113] neg_lo:[1,0,0] neg_hi:[1,0,0]
    v_pk_fma_f32 v[114:115], v[12:13], v[34:35], v[114:115] neg_lo:[1,0,0] neg_hi:[1,0,0]
    v_pk_fma_f32 v[116:117], v[12:13], v[36:37], v[116:117] neg_lo:[1,0,0] neg_hi:[1,0,0]
    v_pk_fma_f32 v[118:119], v[12:13], v[38:39], v[118:119] neg_lo:[1,0,0] neg_hi:[1,0,0]
    v_pk_mul_f32 v[112:113], v[14:15], v[112:113]
    v_pk_mul_f32 v[114:115], v[14:15], v[114:115]
    v_pk_mul_f32 v[116:117], v[14:15], v[116:117]
    v_pk_mul_f32 v[118:119], v[14:15], v[118:119]
    v_pk_fma_f32 v[140:141], v[16:17], v[32:33], v[140:141] neg_lo:[1,0,0] neg_hi:[1,0,0]
    v_pk_fma_f32 v[142:143], v[16:17], v[34:35], v[142:143] neg_lo:[1,0,0] neg_hi:[1,0,0]
    v_pk_fma_f32 v[144:145], v[16:17], v[36:37], v[144:145] neg_lo:[1,0,0] neg_hi:[1,0,0]
    v_pk_fma_f32 v[146:147], v[16:17], v[38:39], v[146:147] neg_lo:[1,0,0] neg_hi:[1,0,0]
    v_pk_mul_f32 v[140:141], v[18:19], v[140:141]
    v_pk_mul_f32 v[142:143], v[18:19], v[142:143]
    v_pk_mul_f32 v[144:145], v[18:19], v[144:145]
    v_pk_mul_f32 v[146:147], v[18:19], v[146:147]
    v_pk_mul_f32 v[168:169], v[112:113], v[112:113]
    v_pk_mul_f32 v[170:171], v[114:115], v[114:115]
    v_pk_mul_f32 v[172:173], v[116:117], v[116:117]
    v_pk_mul_f32 v[174:175], v[118:119], v[118:119]
    v_pk_mul_f32 v[176:177], v[140:141], v[140:141]
    v_pk_mul_f32 v[178:179], v[142:143], v[142:143]
    v_pk_mul_f32 v[180:181], v[144:145], v[144:145]
    v_pk_mul_f32 v[182:183], v[146:147], v[146:147]
    v_pk_fma_f32 v[168:169], v[168:169], v[28:29], v[30:31]
    v_pk_fma_f32 v[170:171], v[170:171], v[28:29], v[30:31]
    v_pk_fma_f32 v[172:173], v[172:173], v[28:29], v[30:31]
    v_pk_fma_f32 v[174:175], v[174:175], v[28:29], v[30:31]
    v_pk_fma_f32 v[176:177], v[176:177], v[28:29], v[30:31]
    v_pk_fma_f32 v[178:179], v[178:179], v[28:29], v[30:31]
    v_pk_fma_f32 v[180:181], v[180:181], v[28:29], v[30:31]
    v_pk_fma_f32 v[182:183], v[182:183], v[28:29], v[30:31]
    v_pk_mul_f32 v[168:169], v[168:169], v[112:113]
    v_pk_mul_f32 v[170:171], v[170:171], v[114:115]
    v_pk_mul_f32 v[172:173], v[172:173], v[116:117]
    v_pk_mul_f32 v[174:175], v[174:175], v[118:119]
    v_pk_mul_f32 v[176:177], v[176:177], v[140:141]
    v_pk_mul_f32 v[178:179], v[178:179], v[142:143]
    v_pk_mul_f32 v[180:181], v[180:181], v[144:145]
    v_pk_mul_f32 v[182:183], v[182:183], v[146:147]
    v_exp_f32 v168, v168
    v_exp_f32 v169, v169
    v_exp_f32 v170, v170
    v_exp_f32 v171, v171
    v_exp_f32 v172, v172
    v_exp_f32 v173, v173
    v_exp_f32 v174, v174
    v_exp_f32 v175, v175
    v_exp_f32 v176, v176
    v_exp_f32 v177, v177
    v_exp_f32 v178, v178
    v_exp_f32 v179, v179
    v_exp_f32 v180, v180
    v_exp_f32 v181, v181
    v_exp_f32 v182, v182
    v_exp_f32 v183, v183
    s_nop 0
    v_pk_add_f32 v[168:169], v[168:169], 1.0 op_sel_hi:[1,0]
    v_pk_add_f32 v[170:171], v[170:171], 1.0 op_sel_hi:[1,0]
    v_pk_add_f32 v[172:173], v[172:173], 1.0 op_sel_hi:[1,0]
    v_pk_add_f32 v[174:175], v[174:175], 1.0 op_sel_hi:[1,0]
    v_pk_add_f32 v[176:177], v[176:177], 1.0 op_sel_hi:[1,0]
    v_pk_add_f32 v[178:179], v[178:179], 1.0 op_sel_hi:[1,0]
    v_pk_add_f32 v[180:181], v[180:181], 1.0 op_sel_hi:[1,0]
    v_pk_add_f32 v[182:183], v[182:183], 1.0 op_sel_hi:[1,0]
    v_rcp_f32 v168, v168
    v_rcp_f32 v169, v169
    v_rcp_f32 v170, v170
    v_rcp_f32 v171, v171
    v_rcp_f32 v172, v172
    v_rcp_f32 v173, v173
    v_rcp_f32 v174, v174
    v_rcp_f32 v175, v175
    v_rcp_f32 v176, v176
    v_rcp_f32 v177, v177
    v_rcp_f32 v178, v178
    v_rcp_f32 v179, v179
    v_rcp_f32 v180, v180
    v_rcp_f32 v181, v181
    v_rcp_f32 v182, v182
    v_rcp_f32 v183, v183
    s_nop 0
    v_pk_mul_f32 v[112:113], v[168:169], v[112:113]
    v_pk_mul_f32 v[114:115], v[170:171], v[114:115]
    v_pk_mul_f32 v[116:117], v[172:173], v[116:117]
    v_pk_mul_f32 v[118:119], v[174:175], v[118:119]
    v_pk_mul_f32 v[140:141], v[176:177], v[140:141]
    v_pk_mul_f32 v[142:143], v[178:179], v[142:143]
    v_pk_mul_f32 v[144:145], v[180:181], v[144:145]
    v_pk_mul_f32 v[146:147], v[182:183], v[146:147]
    v_cvt_pk_bf16_f32 v196, v112, v113
    v_cvt_pk_bf16_f32 v197, v114, v115
    v_cvt_pk_bf16_f32 v198, v140, v141
    v_cvt_pk_bf16_f32 v199, v142, v143
    s_nop 1
    v_permlane16_swap_b32 v196, v198
    v_permlane16_swap_b32 v197, v199
    s_nop 0
    buffer_store_dwordx4 v[196:199], v9, s[36:39], s44 offen sc1
    s_add_u32 s44, s44, 66304
    v_cvt_pk_bf16_f32 v200, v116, v117
    v_cvt_pk_bf16_f32 v201, v118, v119
    v_cvt_pk_bf16_f32 v202, v144, v145
    v_cvt_pk_bf16_f32 v203, v146, v147
    s_nop 1
    v_permlane16_swap_b32 v200, v202
    v_permlane16_swap_b32 v201, v203
    s_nop 0
    buffer_store_dwordx4 v[200:203], v9, s[36:39], s44 offen sc1
    s_add_u32 s44, s44, 66304
    v_pk_fma_f32 v[120:121], v[12:13], v[40:41], v[120:121] neg_lo:[1,0,0] neg_hi:[1,0,0]
    v_pk_fma_f32 v[122:123], v[12:13], v[42:43], v[122:123] neg_lo:[1,0,0] neg_hi:[1,0,0]
    v_pk_fma_f32 v[124:125], v[12:13], v[44:45], v[124:125] neg_lo:[1,0,0] neg_hi:[1,0,0]
    v_pk_fma_f32 v[126:127], v[12:13], v[46:47], v[126:127] neg_lo:[1,0,0] neg_hi:[1,0,0]
    v_pk_mul_f32 v[120:121], v[14:15], v[120:121]
    v_pk_mul_f32 v[122:123], v[14:15], v[122:123]
    v_pk_mul_f32 v[124:125], v[14:15], v[124:125]
    v_pk_mul_f32 v[126:127], v[14:15], v[126:127]
    v_pk_fma_f32 v[148:149], v[16:17], v[40:41], v[148:149] neg_lo:[1,0,0] neg_hi:[1,0,0]
    v_pk_fma_f32 v[150:151], v[16:17], v[42:43], v[150:151] neg_lo:[1,0,0] neg_hi:[1,0,0]
    v_pk_fma_f32 v[152:153], v[16:17], v[44:45], v[152:153] neg_lo:[1,0,0] neg_hi:[1,0,0]
    v_pk_fma_f32 v[154:155], v[16:17], v[46:47], v[154:155] neg_lo:[1,0,0] neg_hi:[1,0,0]
    v_pk_mul_f32 v[148:149], v[18:19], v[148:149]
    v_pk_mul_f32 v[150:151], v[18:19], v[150:151]
    v_pk_mul_f32 v[152:153], v[18:19], v[152:153]
    v_pk_mul_f32 v[154:155], v[18:19], v[154:155]
    v_pk_mul_f32 v[168:169], v[120:121], v[120:121]
    v_pk_mul_f32 v[170:171], v[122:123], v[122:123]
    v_pk_mul_f32 v[172:173], v[124:125], v[124:125]
    v_pk_mul_f32 v[174:175], v[126:127], v[126:127]
    v_pk_mul_f32 v[176:177], v[148:149], v[148:149]
    v_pk_mul_f32 v[178:179], v[150:151], v[150:151]
    v_pk_mul_f32 v[180:181], v[152:153], v[152:153]
    v_pk_mul_f32 v[182:183], v[154:155], v[154:155]
    v_pk_fma_f32 v[168:169], v[168:169], v[28:29], v[30:31]
    v_pk_fma_f32 v[170:171], v[170:171], v[28:29], v[30:31]
    v_pk_fma_f32 v[172:173], v[172:173], v[28:29], v[30:31]
    v_pk_fma_f32 v[174:175], v[174:175], v[28:29], v[30:31]
    v_pk_fma_f32 v[176:177], v[176:177], v[28:29], v[30:31]
    v_pk_fma_f32 v[178:179], v[178:179], v[28:29], v[30:31]
    v_pk_fma_f32 v[180:181], v[180:181], v[28:29], v[30:31]
    v_pk_fma_f32 v[182:183], v[182:183], v[28:29], v[30:31]
    v_pk_mul_f32 v[168:169], v[168:169], v[120:121]
    v_pk_mul_f32 v[170:171], v[170:171], v[122:123]
    v_pk_mul_f32 v[172:173], v[172:173], v[124:125]
    v_pk_mul_f32 v[174:175], v[174:175], v[126:127]
    v_pk_mul_f32 v[176:177], v[176:177], v[148:149]
    v_pk_mul_f32 v[178:179], v[178:179], v[150:151]
    v_pk_mul_f32 v[180:181], v[180:181], v[152:153]
    v_pk_mul_f32 v[182:183], v[182:183], v[154:155]
    v_exp_f32 v168, v168
    v_exp_f32 v169, v169
    v_exp_f32 v170, v170
    v_exp_f32 v171, v171
    v_exp_f32 v172, v172
    v_exp_f32 v173, v173
    v_exp_f32 v174, v174
    v_exp_f32 v175, v175
    v_exp_f32 v176, v176
    v_exp_f32 v177, v177
    v_exp_f32 v178, v178
    v_exp_f32 v179, v179
    v_exp_f32 v180, v180
    v_exp_f32 v181, v181
    v_exp_f32 v182, v182
    v_exp_f32 v183, v183
    s_nop 0
    v_pk_add_f32 v[168:169], v[168:169], 1.0 op_sel_hi:[1,0]
    v_pk_add_f32 v[170:171], v[170:171], 1.0 op_sel_hi:[1,0]
    v_pk_add_f32 v[172:173], v[172:173], 1.0 op_sel_hi:[1,0]
    v_pk_add_f32 v[174:175], v[174:175], 1.0 op_sel_hi:[1,0]
    v_pk_add_f32 v[176:177], v[176:177], 1.0 op_sel_hi:[1,0]
    v_pk_add_f32 v[178:179], v[178:179], 1.0 op_sel_hi:[1,0]
    v_pk_add_f32 v[180:181], v[180:181], 1.0 op_sel_hi:[1,0]
    v_pk_add_f32 v[182:183], v[182:183], 1.0 op_sel_hi:[1,0]
    v_rcp_f32 v168, v168
    v_rcp_f32 v169, v169
    v_rcp_f32 v170, v170
    v_rcp_f32 v171, v171
    v_rcp_f32 v172, v172
    v_rcp_f32 v173, v173
    v_rcp_f32 v174, v174
    v_rcp_f32 v175, v175
    v_rcp_f32 v176, v176
    v_rcp_f32 v177, v177
    v_rcp_f32 v178, v178
    v_rcp_f32 v179, v179
    v_rcp_f32 v180, v180
    v_rcp_f32 v181, v181
    v_rcp_f32 v182, v182
    v_rcp_f32 v183, v183
    s_nop 0
    v_pk_mul_f32 v[120:121], v[168:169], v[120:121]
    v_pk_mul_f32 v[122:123], v[170:171], v[122:123]
    v_pk_mul_f32 v[124:125], v[172:173], v[124:125]
    v_pk_mul_f32 v[126:127], v[174:175], v[126:127]
    v_pk_mul_f32 v[148:149], v[176:177], v[148:149]
    v_pk_mul_f32 v[150:151], v[178:179], v[150:151]
    v_pk_mul_f32 v[152:153], v[180:181], v[152:153]
    v_pk_mul_f32 v[154:155], v[182:183], v[154:155]
    v_cvt_pk_bf16_f32 v196, v120, v121
    v_cvt_pk_bf16_f32 v197, v122, v123
    v_cvt_pk_bf16_f32 v198, v148, v149
    v_cvt_pk_bf16_f32 v199, v150, v151
    s_nop 1
    v_permlane16_swap_b32 v196, v198
    v_permlane16_swap_b32 v197, v199
    s_nop 0
    buffer_store_dwordx4 v[196:199], v9, s[36:39], s44 offen sc1
    s_add_u32 s44, s44, 66304
    v_cvt_pk_bf16_f32 v200, v124, v125
    v_cvt_pk_bf16_f32 v201, v126, v127
    v_cvt_pk_bf16_f32 v202, v152, v153
    v_cvt_pk_bf16_f32 v203, v154, v155
    s_nop 1
    v_permlane16_swap_b32 v200, v202
    v_permlane16_swap_b32 v201, v203
    s_nop 0
    buffer_store_dwordx4 v[200:203], v9, s[36:39], s44 offen sc1
    s_add_u32 s44, s44, 66304
    v_pk_fma_f32 v[128:129], v[12:13], v[48:49], v[128:129] neg_lo:[1,0,0] neg_hi:[1,0,0]
    v_pk_fma_f32 v[130:131], v[12:13], v[50:51], v[130:131] neg_lo:[1,0,0] neg_hi:[1,0,0]
    v_pk_fma_f32 v[132:133], v[12:13], v[52:53], v[132:133] neg_lo:[1,0,0] neg_hi:[1,0,0]
    v_pk_fma_f32 v[134:135], v[12:13], v[54:55], v[134:135] neg_lo:[1,0,0] neg_hi:[1,0,0]
    v_pk_mul_f32 v[128:129], v[14:15], v[128:129]
    v_pk_mul_f32 v[130:131], v[14:15], v[130:131]
    v_pk_mul_f32 v[132:133], v[14:15], v[132:133]
    v_pk_mul_f32 v[134:135], v[14:15], v[134:135]
    v_pk_fma_f32 v[156:157], v[16:17], v[48:49], v[156:157] neg_lo:[1,0,0] neg_hi:[1,0,0]
    v_pk_fma_f32 v[158:159], v[16:17], v[50:51], v[158:159] neg_lo:[1,0,0] neg_hi:[1,0,0]
    v_pk_fma_f32 v[160:161], v[16:17], v[52:53], v[160:161] neg_lo:[1,0,0] neg_hi:[1,0,0]
    v_pk_fma_f32 v[162:163], v[16:17], v[54:55], v[162:163] neg_lo:[1,0,0] neg_hi:[1,0,0]
    v_pk_mul_f32 v[156:157], v[18:19], v[156:157]
    v_pk_mul_f32 v[158:159], v[18:19], v[158:159]
    v_pk_mul_f32 v[160:161], v[18:19], v[160:161]
    v_pk_mul_f32 v[162:163], v[18:19], v[162:163]
    v_pk_mul_f32 v[168:169], v[128:129], v[128:129]
    v_pk_mul_f32 v[170:171], v[130:131], v[130:131]
    v_pk_mul_f32 v[172:173], v[132:133], v[132:133]
    v_pk_mul_f32 v[174:175], v[134:135], v[134:135]
    v_pk_mul_f32 v[176:177], v[156:157], v[156:157]
    v_pk_mul_f32 v[178:179], v[158:159], v[158:159]
    v_pk_mul_f32 v[180:181], v[160:161], v[160:161]
    v_pk_mul_f32 v[182:183], v[162:163], v[162:163]
    v_pk_fma_f32 v[168:169], v[168:169], v[28:29], v[30:31]
    v_pk_fma_f32 v[170:171], v[170:171], v[28:29], v[30:31]
    v_pk_fma_f32 v[172:173], v[172:173], v[28:29], v[30:31]
    v_pk_fma_f32 v[174:175], v[174:175], v[28:29], v[30:31]
    v_pk_fma_f32 v[176:177], v[176:177], v[28:29], v[30:31]
    v_pk_fma_f32 v[178:179], v[178:179], v[28:29], v[30:31]
    v_pk_fma_f32 v[180:181], v[180:181], v[28:29], v[30:31]
    v_pk_fma_f32 v[182:183], v[182:183], v[28:29], v[30:31]
    v_pk_mul_f32 v[168:169], v[168:169], v[128:129]
    v_pk_mul_f32 v[170:171], v[170:171], v[130:131]
    v_pk_mul_f32 v[172:173], v[172:173], v[132:133]
    v_pk_mul_f32 v[174:175], v[174:175], v[134:135]
    v_pk_mul_f32 v[176:177], v[176:177], v[156:157]
    v_pk_mul_f32 v[178:179], v[178:179], v[158:159]
    v_pk_mul_f32 v[180:181], v[180:181], v[160:161]
    v_pk_mul_f32 v[182:183], v[182:183], v[162:163]
    v_exp_f32 v168, v168
    v_exp_f32 v169, v169
    v_exp_f32 v170, v170
    v_exp_f32 v171, v171
    v_exp_f32 v172, v172
    v_exp_f32 v173, v173
    v_exp_f32 v174, v174
    v_exp_f32 v175, v175
    v_exp_f32 v176, v176
    v_exp_f32 v177, v177
    v_exp_f32 v178, v178
    v_exp_f32 v179, v179
    v_exp_f32 v180, v180
    v_exp_f32 v181, v181
    v_exp_f32 v182, v182
    v_exp_f32 v183, v183
    s_nop 0
    v_pk_add_f32 v[168:169], v[168:169], 1.0 op_sel_hi:[1,0]
    v_pk_add_f32 v[170:171], v[170:171], 1.0 op_sel_hi:[1,0]
    v_pk_add_f32 v[172:173], v[172:173], 1.0 op_sel_hi:[1,0]
    v_pk_add_f32 v[174:175], v[174:175], 1.0 op_sel_hi:[1,0]
    v_pk_add_f32 v[176:177], v[176:177], 1.0 op_sel_hi:[1,0]
    v_pk_add_f32 v[178:179], v[178:179], 1.0 op_sel_hi:[1,0]
    v_pk_add_f32 v[180:181], v[180:181], 1.0 op_sel_hi:[1,0]
    v_pk_add_f32 v[182:183], v[182:183], 1.0 op_sel_hi:[1,0]
    v_rcp_f32 v168, v168
    v_rcp_f32 v169, v169
    v_rcp_f32 v170, v170
    v_rcp_f32 v171, v171
    v_rcp_f32 v172, v172
    v_rcp_f32 v173, v173
    v_rcp_f32 v174, v174
    v_rcp_f32 v175, v175
    v_rcp_f32 v176, v176
    v_rcp_f32 v177, v177
    v_rcp_f32 v178, v178
    v_rcp_f32 v179, v179
    v_rcp_f32 v180, v180
    v_rcp_f32 v181, v181
    v_rcp_f32 v182, v182
    v_rcp_f32 v183, v183
    s_nop 0
    v_pk_mul_f32 v[128:129], v[168:169], v[128:129]
    v_pk_mul_f32 v[130:131], v[170:171], v[130:131]
    v_pk_mul_f32 v[132:133], v[172:173], v[132:133]
    v_pk_mul_f32 v[134:135], v[174:175], v[134:135]
    v_pk_mul_f32 v[156:157], v[176:177], v[156:157]
    v_pk_mul_f32 v[158:159], v[178:179], v[158:159]
    v_pk_mul_f32 v[160:161], v[180:181], v[160:161]
    v_pk_mul_f32 v[162:163], v[182:183], v[162:163]
    v_cvt_pk_bf16_f32 v196, v128, v129
    v_cvt_pk_bf16_f32 v197, v130, v131
    v_cvt_pk_bf16_f32 v198, v156, v157
    v_cvt_pk_bf16_f32 v199, v158, v159
    s_nop 1
    v_permlane16_swap_b32 v196, v198
    v_permlane16_swap_b32 v197, v199
    s_nop 0
    buffer_store_dwordx4 v[196:199], v9, s[36:39], s44 offen sc1
    s_add_u32 s44, s44, 66304
    v_cvt_pk_bf16_f32 v200, v132, v133
    v_cvt_pk_bf16_f32 v201, v134, v135
    v_cvt_pk_bf16_f32 v202, v160, v161
    v_cvt_pk_bf16_f32 v203, v162, v163
    s_nop 1
    v_permlane16_swap_b32 v200, v202
    v_permlane16_swap_b32 v201, v203
    s_nop 0
    buffer_store_dwordx4 v[200:203], v9, s[36:39], s44 offen sc1
    s_add_u32 s44, s44, 66304
    v_pk_fma_f32 v[136:137], v[12:13], v[56:57], v[136:137] neg_lo:[1,0,0] neg_hi:[1,0,0]
    v_pk_fma_f32 v[138:139], v[12:13], v[58:59], v[138:139] neg_lo:[1,0,0] neg_hi:[1,0,0]
    v_pk_mul_f32 v[136:137], v[14:15], v[136:137]
    v_pk_mul_f32 v[138:139], v[14:15], v[138:139]
    v_pk_fma_f32 v[164:165], v[16:17], v[56:57], v[164:165] neg_lo:[1,0,0] neg_hi:[1,0,0]
    v_pk_fma_f32 v[166:167], v[16:17], v[58:59], v[166:167] neg_lo:[1,0,0] neg_hi:[1,0,0]
    v_pk_mul_f32 v[164:165], v[18:19], v[164:165]
    v_pk_mul_f32 v[166:167], v[18:19], v[166:167]
    v_pk_mul_f32 v[168:169], v[136:137], v[136:137]
    v_pk_mul_f32 v[170:171], v[138:139], v[138:139]
    v_pk_mul_f32 v[172:173], v[164:165], v[164:165]
    v_pk_mul_f32 v[174:175], v[166:167], v[166:167]
    v_pk_fma_f32 v[168:169], v[168:169], v[28:29], v[30:31]
    v_pk_fma_f32 v[170:171], v[170:171], v[28:29], v[30:31]
    v_pk_fma_f32 v[172:173], v[172:173], v[28:29], v[30:31]
    v_pk_fma_f32 v[174:175], v[174:175], v[28:29], v[30:31]
    v_pk_mul_f32 v[168:169], v[168:169], v[136:137]
    v_pk_mul_f32 v[170:171], v[170:171], v[138:139]
    v_pk_mul_f32 v[172:173], v[172:173], v[164:165]
    v_pk_mul_f32 v[174:175], v[174:175], v[166:167]
    v_exp_f32 v168, v168
    v_exp_f32 v169, v169
    v_exp_f32 v170, v170
    v_exp_f32 v171, v171
    v_exp_f32 v172, v172
    v_exp_f32 v173, v173
    v_exp_f32 v174, v174
    v_exp_f32 v175, v175
    s_nop 0
    v_pk_add_f32 v[168:169], v[168:169], 1.0 op_sel_hi:[1,0]
    v_pk_add_f32 v[170:171], v[170:171], 1.0 op_sel_hi:[1,0]
    v_pk_add_f32 v[172:173], v[172:173], 1.0 op_sel_hi:[1,0]
    v_pk_add_f32 v[174:175], v[174:175], 1.0 op_sel_hi:[1,0]
    v_rcp_f32 v168, v168
    v_rcp_f32 v169, v169
    v_rcp_f32 v170, v170
    v_rcp_f32 v171, v171
    v_rcp_f32 v172, v172
    v_rcp_f32 v173, v173
    v_rcp_f32 v174, v174
    v_rcp_f32 v175, v175
    s_nop 0
    v_pk_mul_f32 v[136:137], v[168:169], v[136:137]
    v_pk_mul_f32 v[138:139], v[170:171], v[138:139]
    v_pk_mul_f32 v[164:165], v[172:173], v[164:165]
    v_pk_mul_f32 v[166:167], v[174:175], v[166:167]
    v_cvt_pk_bf16_f32 v196, v136, v137
    v_cvt_pk_bf16_f32 v197, v138, v139
    v_cvt_pk_bf16_f32 v198, v164, v165
    v_cvt_pk_bf16_f32 v199, v166, v167
    s_nop 1
    v_permlane16_swap_b32 v196, v198
    v_permlane16_swap_b32 v197, v199
    s_nop 0
    buffer_store_dwordx4 v[196:199], v9, s[36:39], s44 offen sc1
    s_add_u32 s44, s44, 66304
    s_waitcnt vmcnt(0)
    s_barrier
    v_lshrrev_b32 v1, 6, v0
    s_nop 0
    v_readfirstlane_b32 s3, v1
    v_and_b32 v1, 63, v0
    v_and_b32 v2, 15, v1
    v_lshrrev_b32 v3, 4, v1
    v_lshlrev_b32 v4, 4, v1
    s_and_b32 s20, s2, 3
    s_lshl_b32 s20, s20, 3
    s_lshr_b32 s22, s2, 3
    s_and_b32 s21, s22, 7
    s_add_u32 s20, s20, s21
    s_lshr_b32 s22, s22, 3
    s_and_b32 s21, s2, 4
    s_add_u32 s21, s21, s22
    s_and_b32 s23, s3, 1
    s_lshr_b32 s24, s3, 1
    s_lshl_b32 s25, s20, 6
    s_lshl_b32 s26, s23, 5
    s_add_u32 s25, s25, s26
    v_add_u32 v5, s25, v2
    v_lshrrev_b32 v11, 1, v3
    v_mul_u32_u24 v11, 2072, v11
    v_add_u32 v11, v11, v5
    v_lshlrev_b32 v11, 4, v11
    v_and_b32 v8, 1, v3
    v_lshl_add_u32 v8, v8, 3, v11
    s_lshl_b32 s27, s24, 4
    v_add_u32 v17, s27, v5
    v_mul_u32_u24 v17, 1280, v17
    v_lshl_add_u32 v17, v3, 3, v17
    v_mul_u32_u24 v11, 2072, v3
    v_add_u32 v5, v5, v11
    v_lshlrev_b32 v5, 4, v5
    s_mul_i32 s26, s24, 3580416
    s_add_u32 s8, s4, 23068672
    s_addc_u32 s9, s5, 0
    s_mov_b32 s10, 7160832
    s_mov_b32 s11, 0x00020000
    s_mov_b32 s16, s4
    s_mov_b32 s17, s5
    s_mov_b32 s18, 131072
    s_mov_b32 s19, 0x00020000
    s_add_u32 s12, s4, 10485760
    s_addc_u32 s13, s5, 0
    s_mov_b32 s14, 2652160
    s_mov_b32 s15, 0x00020000
    s_add_u32 s48, s4, 19922944
    s_addc_u32 s49, s5, 0
    s_mov_b32 s50, 2652160
    s_mov_b32 s51, 0x00020000
    s_mul_i32 s30, s21, 5
    s_add_u32 s40, s30, 0
    s_lshr_b32 s41, s40, 1
    s_mul_i32 s41, s41, 132608
    s_and_b32 s40, s40, 1
    s_lshl_b32 s40, s40, 3
    s_add_u32 s41, s41, s40
    s_lshl_b32 s40, s24, 8
    s_add_u32 s52, s41, s40
    s_add_u32 s40, s30, 1
    s_lshr_b32 s41, s40, 1
    s_mul_i32 s41, s41, 132608
    s_and_b32 s40, s40, 1
    s_lshl_b32 s40, s40, 3
    s_add_u32 s41, s41, s40
    s_lshl_b32 s40, s24, 8
    s_add_u32 s53, s41, s40
    s_add_u32 s40, s30, 2
    s_lshr_b32 s41, s40, 1
    s_mul_i32 s41, s41, 132608
    s_and_b32 s40, s40, 1
    s_lshl_b32 s40, s40, 3
    s_add_u32 s41, s41, s40
    s_lshl_b32 s40, s24, 8
    s_add_u32 s54, s41, s40
    s_add_u32 s40, s30, 3
    s_lshr_b32 s41, s40, 1
    s_mul_i32 s41, s41, 132608
    s_and_b32 s40, s40, 1
    s_lshl_b32 s40, s40, 3
    s_add_u32 s41, s41, s40
    s_lshl_b32 s40, s24, 8
    s_add_u32 s55, s41, s40
    s_add_u32 s40, s30, 4
    s_lshr_b32 s41, s40, 1
    s_mul_i32 s41, s41, 132608
    s_and_b32 s40, s40, 1
    s_lshl_b32 s40, s40, 3
    s_add_u32 s41, s41, s40
    s_lshl_b32 s40, s24, 8
    s_add_u32 s56, s41, s40
    s_mul_i32 s58, s30, 66304
    s_lshl_b32 s40, s24, 8
    s_add_u32 s58, s58, s40
    s_add_u32 s59, s58, 66304
    s_add_u32 s60, s58, 132608
    s_add_u32 s61, s58, 198912
    s_add_u32 s62, s58, 265216
    v_lshlrev_b32 v23, 4, v3
    s_mul_i32 s32, s21, 320
    s_add_u32 s32, s32, 102912
    s_mul_i32 s27, s24, 10240
    v_add_u32 v4, s27, v4
    v_add_u32 v6, 61440, v4
    buffer_load_dwordx2 v[196:197], v5, s[12:15], s52 offen
    buffer_load_dwordx4 v[216:219], v23, s[16:19], s32 offen offset:0
    buffer_load_dwordx2 v[198:199], v5, s[12:15], s53 offen
    buffer_load_dwordx4 v[220:223], v23, s[16:19], s32 offen offset:64
    buffer_load_dwordx2 v[200:201], v5, s[12:15], s54 offen
    buffer_load_dwordx4 v[224:227], v23, s[16:19], s32 offen offset:128
    buffer_load_dwordx2 v[202:203], v5, s[12:15], s55 offen
    buffer_load_dwordx4 v[228:231], v23, s[16:19], s32 offen offset:192
    buffer_load_dwordx2 v[204:205], v5, s[12:15], s56 offen
    buffer_load_dwordx4 v[232:235], v23, s[16:19], s32 offen offset:256
    s_barrier
    buffer_load_dwordx2 v[206:207], v8, s[48:51], s58 offen sc1
    buffer_load_dwordx2 v[208:209], v8, s[48:51], s59 offen sc1
    buffer_load_dwordx2 v[210:211], v8, s[48:51], s60 offen sc1
    buffer_load_dwordx2 v[212:213], v8, s[48:51], s61 offen sc1
    buffer_load_dwordx2 v[214:215], v8, s[48:51], s62 offen sc1
    buffer_load_dwordx4 v[32:35], v5, s[8:11], s26 offen offset:0 sc1
    buffer_load_dwordx4 v[36:39], v5, s[8:11], s26 offen offset:256 sc1
    s_add_u32 s26, s26, 132608
    buffer_load_dwordx4 v[40:43], v5, s[8:11], s26 offen offset:0 sc1
    buffer_load_dwordx4 v[44:47], v5, s[8:11], s26 offen offset:256 sc1
    s_add_u32 s26, s26, 132608
    buffer_load_dwordx4 v[48:51], v5, s[8:11], s26 offen offset:0 sc1
    buffer_load_dwordx4 v[52:55], v5, s[8:11], s26 offen offset:256 sc1
    s_add_u32 s26, s26, 132608
    buffer_load_dwordx4 v[56:59], v5, s[8:11], s26 offen offset:0 sc1
    buffer_load_dwordx4 v[60:63], v5, s[8:11], s26 offen offset:256 sc1
    s_add_u32 s26, s26, 132608
    buffer_load_dwordx4 v[64:67], v5, s[8:11], s26 offen offset:0 sc1
    buffer_load_dwordx4 v[68:71], v5, s[8:11], s26 offen offset:256 sc1
    s_add_u32 s26, s26, 132608
    buffer_load_dwordx4 v[72:75], v5, s[8:11], s26 offen offset:0 sc1
    buffer_load_dwordx4 v[76:79], v5, s[8:11], s26 offen offset:256 sc1
    s_add_u32 s26, s26, 132608
    s_barrier
    ds_read_b128 v[136:139], v4 offset:0
    ds_read_b128 v[140:143], v4 offset:1024
    ds_read_b128 v[144:147], v4 offset:2048
    ds_read_b128 v[148:151], v4 offset:3072
    ds_read_b128 v[152:155], v4 offset:4096
    s_waitcnt lgkmcnt(0)
    s_waitcnt vmcnt(10)
    v_mfma_f32_16x16x32_bf16 v[96:99], v[136:139], v[32:35], 0
    ds_read_b128 v[156:159], v4 offset:5120
    v_mfma_f32_16x16x32_bf16 v[116:119], v[136:139], v[36:39], 0
    ds_read_b128 v[160:163], v4 offset:6144
    v_mfma_f32_16x16x32_bf16 v[100:103], v[140:143], v[32:35], 0
    ds_read_b128 v[164:167], v4 offset:7168
    v_mfma_f32_16x16x32_bf16 v[120:123], v[140:143], v[36:39], 0
    ds_read_b128 v[168:171], v4 offset:8192
    v_mfma_f32_16x16x32_bf16 v[104:107], v[144:147], v[32:35], 0
    ds_read_b128 v[172:175], v4 offset:9216
    v_mfma_f32_16x16x32_bf16 v[124:127], v[144:147], v[36:39], 0
    v_mfma_f32_16x16x32_bf16 v[108:111], v[148:151], v[32:35], 0
    v_mfma_f32_16x16x32_bf16 v[128:131], v[148:151], v[36:39], 0
    v_mfma_f32_16x16x32_bf16 v[112:115], v[152:155], v[32:35], 0
    v_mfma_f32_16x16x32_bf16 v[132:135], v[152:155], v[36:39], 0
    buffer_load_dwordx4 v[80:83], v5, s[8:11], s26 offen offset:0 sc1
    buffer_load_dwordx4 v[84:87], v5, s[8:11], s26 offen offset:256 sc1
    s_add_u32 s26, s26, 132608
    buffer_load_dwordx4 v[88:91], v5, s[8:11], s26 offen offset:0 sc1
    buffer_load_dwordx4 v[92:95], v5, s[8:11], s26 offen offset:256 sc1
    s_add_u32 s26, s26, 132608
    s_waitcnt lgkmcnt(0)
    s_barrier
    s_waitcnt vmcnt(12)
    v_mfma_f32_16x16x32_bf16 v[96:99], v[156:159], v[40:43], v[96:99]
    ds_read_b128 v[136:139], v4 offset:20480
    v_mfma_f32_16x16x32_bf16 v[116:119], v[156:159], v[44:47], v[116:119]
    ds_read_b128 v[140:143], v4 offset:21504
    v_mfma_f32_16x16x32_bf16 v[100:103], v[160:163], v[40:43], v[100:103]
    ds_read_b128 v[144:147], v4 offset:22528
    v_mfma_f32_16x16x32_bf16 v[120:123], v[160:163], v[44:47], v[120:123]
    ds_read_b128 v[148:151], v4 offset:23552
    v_mfma_f32_16x16x32_bf16 v[104:107], v[164:167], v[40:43], v[104:107]
    ds_read_b128 v[152:155], v4 offset:24576
    v_mfma_f32_16x16x32_bf16 v[124:127], v[164:167], v[44:47], v[124:127]
    v_mfma_f32_16x16x32_bf16 v[108:111], v[168:171], v[40:43], v[108:111]
    v_mfma_f32_16x16x32_bf16 v[128:131], v[168:171], v[44:47], v[128:131]
    v_mfma_f32_16x16x32_bf16 v[112:115], v[172:175], v[40:43], v[112:115]
    v_mfma_f32_16x16x32_bf16 v[132:135], v[172:175], v[44:47], v[132:135]
    buffer_load_dwordx4 v[32:35], v5, s[8:11], s26 offen offset:0 sc1
    buffer_load_dwordx4 v[36:39], v5, s[8:11], s26 offen offset:256 sc1
    s_add_u32 s26, s26, 132608
    buffer_load_dwordx4 v[40:43], v5, s[8:11], s26 offen offset:0 sc1
    buffer_load_dwordx4 v[44:47], v5, s[8:11], s26 offen offset:256 sc1
    s_add_u32 s26, s26, 132608
    s_waitcnt lgkmcnt(0)
    s_waitcnt vmcnt(14)
    v_mfma_f32_16x16x32_bf16 v[96:99], v[136:139], v[48:51], v[96:99]
    ds_read_b128 v[156:159], v4 offset:25600
    v_mfma_f32_16x16x32_bf16 v[116:119], v[136:139], v[52:55], v[116:119]
    ds_read_b128 v[160:163], v4 offset:26624
    v_mfma_f32_16x16x32_bf16 v[100:103], v[140:143], v[48:51], v[100:103]
    ds_read_b128 v[164:167], v4 offset:27648
    v_mfma_f32_16x16x32_bf16 v[120:123], v[140:143], v[52:55], v[120:123]
    ds_read_b128 v[168:171], v4 offset:28672
    v_mfma_f32_16x16x32_bf16 v[104:107], v[144:147], v[48:51], v[104:107]
    ds_read_b128 v[172:175], v4 offset:29696
    v_mfma_f32_16x16x32_bf16 v[124:127], v[144:147], v[52:55], v[124:127]
    v_mfma_f32_16x16x32_bf16 v[108:111], v[148:151], v[48:51], v[108:111]
    v_mfma_f32_16x16x32_bf16 v[128:131], v[148:151], v[52:55], v[128:131]
    v_mfma_f32_16x16x32_bf16 v[112:115], v[152:155], v[48:51], v[112:115]
    v_mfma_f32_16x16x32_bf16 v[132:135], v[152:155], v[52:55], v[132:135]
    buffer_load_dwordx4 v[48:51], v5, s[8:11], s26 offen offset:0 sc1
    buffer_load_dwordx4 v[52:55], v5, s[8:11], s26 offen offset:256 sc1
    s_add_u32 s26, s26, 132608
    s_waitcnt lgkmcnt(0)
    s_barrier
    s_waitcnt vmcnt(14)
    v_mfma_f32_16x16x32_bf16 v[96:99], v[156:159], v[56:59], v[96:99]
    ds_read_b128 v[136:139], v4 offset:40960
    v_mfma_f32_16x16x32_bf16 v[116:119], v[156:159], v[60:63], v[116:119]
    ds_read_b128 v[140:143], v4 offset:41984
    v_mfma_f32_16x16x32_bf16 v[100:103], v[160:163], v[56:59], v[100:103]
    ds_read_b128 v[144:147], v4 offset:43008
    v_mfma_f32_16x16x32_bf16 v[120:123], v[160:163], v[60:63], v[120:123]
    ds_read_b128 v[148:151], v4 offset:44032
    v_mfma_f32_16x16x32_bf16 v[104:107], v[164:167], v[56:59], v[104:107]
    ds_read_b128 v[152:155], v4 offset:45056
    v_mfma_f32_16x16x32_bf16 v[124:127], v[164:167], v[60:63], v[124:127]
    v_mfma_f32_16x16x32_bf16 v[108:111], v[168:171], v[56:59], v[108:111]
    v_mfma_f32_16x16x32_bf16 v[128:131], v[168:171], v[60:63], v[128:131]
    v_mfma_f32_16x16x32_bf16 v[112:115], v[172:175], v[56:59], v[112:115]
    v_mfma_f32_16x16x32_bf16 v[132:135], v[172:175], v[60:63], v[132:135]
    buffer_load_dwordx4 v[56:59], v5, s[8:11], s26 offen offset:0 sc1
    buffer_load_dwordx4 v[60:63], v5, s[8:11], s26 offen offset:256 sc1
    s_add_u32 s26, s26, 132608
    s_waitcnt lgkmcnt(0)
    s_waitcnt vmcnt(14)
    v_mfma_f32_16x16x32_bf16 v[96:99], v[136:139], v[64:67], v[96:99]
    ds_read_b128 v[156:159], v4 offset:46080
    v_mfma_f32_16x16x32_bf16 v[116:119], v[136:139], v[68:71], v[116:119]
    ds_read_b128 v[160:163], v4 offset:47104
    v_mfma_f32_16x16x32_bf16 v[100:103], v[140:143], v[64:67], v[100:103]
    ds_read_b128 v[164:167], v4 offset:48128
    v_mfma_f32_16x16x32_bf16 v[120:123], v[140:143], v[68:71], v[120:123]
    ds_read_b128 v[168:171], v4 offset:49152
    v_mfma_f32_16x16x32_bf16 v[104:107], v[144:147], v[64:67], v[104:107]
    ds_read_b128 v[172:175], v4 offset:50176
    v_mfma_f32_16x16x32_bf16 v[124:127], v[144:147], v[68:71], v[124:127]
    v_mfma_f32_16x16x32_bf16 v[108:111], v[148:151], v[64:67], v[108:111]
    v_mfma_f32_16x16x32_bf16 v[128:131], v[148:151], v[68:71], v[128:131]
    v_mfma_f32_16x16x32_bf16 v[112:115], v[152:155], v[64:67], v[112:115]
    v_mfma_f32_16x16x32_bf16 v[132:135], v[152:155], v[68:71], v[132:135]
    buffer_load_dwordx4 v[64:67], v5, s[8:11], s26 offen offset:0 sc1
    buffer_load_dwordx4 v[68:71], v5, s[8:11], s26 offen offset:256 sc1
    s_add_u32 s26, s26, 132608
    s_waitcnt lgkmcnt(0)
    s_barrier
    s_waitcnt vmcnt(14)
    v_mfma_f32_16x16x32_bf16 v[96:99], v[156:159], v[72:75], v[96:99]
    ds_read_b128 v[136:139], v6 offset:0
    v_mfma_f32_16x16x32_bf16 v[116:119], v[156:159], v[76:79], v[116:119]
    ds_read_b128 v[140:143], v6 offset:1024
    v_mfma_f32_16x16x32_bf16 v[100:103], v[160:163], v[72:75], v[100:103]
    ds_read_b128 v[144:147], v6 offset:2048
    v_mfma_f32_16x16x32_bf16 v[120:123], v[160:163], v[76:79], v[120:123]
    ds_read_b128 v[148:151], v6 offset:3072
    v_mfma_f32_16x16x32_bf16 v[104:107], v[164:167], v[72:75], v[104:107]
    ds_read_b128 v[152:155], v6 offset:4096
    v_mfma_f32_16x16x32_bf16 v[124:127], v[164:167], v[76:79], v[124:127]
    v_mfma_f32_16x16x32_bf16 v[108:111], v[168:171], v[72:75], v[108:111]
    v_mfma_f32_16x16x32_bf16 v[128:131], v[168:171], v[76:79], v[128:131]
    v_mfma_f32_16x16x32_bf16 v[112:115], v[172:175], v[72:75], v[112:115]
    v_mfma_f32_16x16x32_bf16 v[132:135], v[172:175], v[76:79], v[132:135]
    buffer_load_dwordx4 v[72:75], v5, s[8:11], s26 offen offset:0 sc1
    buffer_load_dwordx4 v[76:79], v5, s[8:11], s26 offen offset:256 sc1
    s_add_u32 s26, s26, 132608
    s_waitcnt lgkmcnt(0)
    s_waitcnt vmcnt(14)
    v_mfma_f32_16x16x32_bf16 v[96:99], v[136:139], v[80:83], v[96:99]
    ds_read_b128 v[156:159], v6 offset:5120
    v_mfma_f32_16x16x32_bf16 v[116:119], v[136:139], v[84:87], v[116:119]
    ds_read_b128 v[160:163], v6 offset:6144
    v_mfma_f32_16x16x32_bf16 v[100:103], v[140:143], v[80:83], v[100:103]
    ds_read_b128 v[164:167], v6 offset:7168
    v_mfma_f32_16x16x32_bf16 v[120:123], v[140:143], v[84:87], v[120:123]
    ds_read_b128 v[168:171], v6 offset:8192
    v_mfma_f32_16x16x32_bf16 v[104:107], v[144:147], v[80:83], v[104:107]
    ds_read_b128 v[172:175], v6 offset:9216
    v_mfma_f32_16x16x32_bf16 v[124:127], v[144:147], v[84:87], v[124:127]
    v_mfma_f32_16x16x32_bf16 v[108:111], v[148:151], v[80:83], v[108:111]
    v_mfma_f32_16x16x32_bf16 v[128:131], v[148:151], v[84:87], v[128:131]
    v_mfma_f32_16x16x32_bf16 v[112:115], v[152:155], v[80:83], v[112:115]
    v_mfma_f32_16x16x32_bf16 v[132:135], v[152:155], v[84:87], v[132:135]
    buffer_load_dwordx4 v[80:83], v5, s[8:11], s26 offen offset:0 sc1
    buffer_load_dwordx4 v[84:87], v5, s[8:11], s26 offen offset:256 sc1
    s_add_u32 s26, s26, 132608
    s_waitcnt lgkmcnt(0)
    s_barrier
    s_waitcnt vmcnt(14)
    v_mfma_f32_16x16x32_bf16 v[96:99], v[156:159], v[88:91], v[96:99]
    ds_read_b128 v[136:139], v6 offset:20480
    v_mfma_f32_16x16x32_bf16 v[116:119], v[156:159], v[92:95], v[116:119]
    ds_read_b128 v[140:143], v6 offset:21504
    v_mfma_f32_16x16x32_bf16 v[100:103], v[160:163], v[88:91], v[100:103]
    ds_read_b128 v[144:147], v6 offset:22528
    v_mfma_f32_16x16x32_bf16 v[120:123], v[160:163], v[92:95], v[120:123]
    ds_read_b128 v[148:151], v6 offset:23552
    v_mfma_f32_16x16x32_bf16 v[104:107], v[164:167], v[88:91], v[104:107]
    ds_read_b128 v[152:155], v6 offset:24576
    v_mfma_f32_16x16x32_bf16 v[124:127], v[164:167], v[92:95], v[124:127]
    v_mfma_f32_16x16x32_bf16 v[108:111], v[168:171], v[88:91], v[108:111]
    v_mfma_f32_16x16x32_bf16 v[128:131], v[168:171], v[92:95], v[128:131]
    v_mfma_f32_16x16x32_bf16 v[112:115], v[172:175], v[88:91], v[112:115]
    v_mfma_f32_16x16x32_bf16 v[132:135], v[172:175], v[92:95], v[132:135]
    buffer_load_dwordx4 v[88:91], v5, s[8:11], s26 offen offset:0 sc1
    buffer_load_dwordx4 v[92:95], v5, s[8:11], s26 offen offset:256 sc1
    s_add_u32 s26, s26, 132608
    s_waitcnt lgkmcnt(0)
    s_waitcnt vmcnt(14)
    v_mfma_f32_16x16x32_bf16 v[96:99], v[136:139], v[32:35], v[96:99]
    ds_read_b128 v[156:159], v6 offset:25600
    v_mfma_f32_16x16x32_bf16 v[116:119], v[136:139], v[36:39], v[116:119]
    ds_read_b128 v[160:163], v6 offset:26624
    v_mfma_f32_16x16x32_bf16 v[100:103], v[140:143], v[32:35], v[100:103]
    ds_read_b128 v[164:167], v6 offset:27648
    v_mfma_f32_16x16x32_bf16 v[120:123], v[140:143], v[36:39], v[120:123]
    ds_read_b128 v[168:171], v6 offset:28672
    v_mfma_f32_16x16x32_bf16 v[104:107], v[144:147], v[32:35], v[104:107]
    ds_read_b128 v[172:175], v6 offset:29696
    v_mfma_f32_16x16x32_bf16 v[124:127], v[144:147], v[36:39], v[124:127]
    v_mfma_f32_16x16x32_bf16 v[108:111], v[148:151], v[32:35], v[108:111]
    v_mfma_f32_16x16x32_bf16 v[128:131], v[148:151], v[36:39], v[128:131]
    v_mfma_f32_16x16x32_bf16 v[112:115], v[152:155], v[32:35], v[112:115]
    v_mfma_f32_16x16x32_bf16 v[132:135], v[152:155], v[36:39], v[132:135]
    buffer_load_dwordx4 v[32:35], v5, s[8:11], s26 offen offset:0 sc1
    buffer_load_dwordx4 v[36:39], v5, s[8:11], s26 offen offset:256 sc1
    s_add_u32 s26, s26, 132608
    s_waitcnt lgkmcnt(0)
    s_barrier
    s_waitcnt vmcnt(14)
    v_mfma_f32_16x16x32_bf16 v[96:99], v[156:159], v[40:43], v[96:99]
    ds_read_b128 v[136:139], v6 offset:40960
    v_mfma_f32_16x16x32_bf16 v[116:119], v[156:159], v[44:47], v[116:119]
    ds_read_b128 v[140:143], v6 offset:41984
    v_mfma_f32_16x16x32_bf16 v[100:103], v[160:163], v[40:43], v[100:103]
    ds_read_b128 v[144:147], v6 offset:43008
    v_mfma_f32_16x16x32_bf16 v[120:123], v[160:163], v[44:47], v[120:123]
    ds_read_b128 v[148:151], v6 offset:44032
    v_mfma_f32_16x16x32_bf16 v[104:107], v[164:167], v[40:43], v[104:107]
    ds_read_b128 v[152:155], v6 offset:45056
    v_mfma_f32_16x16x32_bf16 v[124:127], v[164:167], v[44:47], v[124:127]
    v_mfma_f32_16x16x32_bf16 v[108:111], v[168:171], v[40:43], v[108:111]
    v_mfma_f32_16x16x32_bf16 v[128:131], v[168:171], v[44:47], v[128:131]
    v_mfma_f32_16x16x32_bf16 v[112:115], v[172:175], v[40:43], v[112:115]
    v_mfma_f32_16x16x32_bf16 v[132:135], v[172:175], v[44:47], v[132:135]
    buffer_load_dwordx4 v[40:43], v5, s[8:11], s26 offen offset:0 sc1
    buffer_load_dwordx4 v[44:47], v5, s[8:11], s26 offen offset:256 sc1
    s_add_u32 s26, s26, 132608
    s_waitcnt lgkmcnt(0)
    s_waitcnt vmcnt(14)
    v_mfma_f32_16x16x32_bf16 v[96:99], v[136:139], v[48:51], v[96:99]
    ds_read_b128 v[156:159], v6 offset:46080
    v_mfma_f32_16x16x32_bf16 v[116:119], v[136:139], v[52:55], v[116:119]
    ds_read_b128 v[160:163], v6 offset:47104
    v_mfma_f32_16x16x32_bf16 v[100:103], v[140:143], v[48:51], v[100:103]
    ds_read_b128 v[164:167], v6 offset:48128
    v_mfma_f32_16x16x32_bf16 v[120:123], v[140:143], v[52:55], v[120:123]
    ds_read_b128 v[168:171], v6 offset:49152
    v_mfma_f32_16x16x32_bf16 v[104:107], v[144:147], v[48:51], v[104:107]
    ds_read_b128 v[172:175], v6 offset:50176
    v_mfma_f32_16x16x32_bf16 v[124:127], v[144:147], v[52:55], v[124:127]
    v_mfma_f32_16x16x32_bf16 v[108:111], v[148:151], v[48:51], v[108:111]
    v_mfma_f32_16x16x32_bf16 v[128:131], v[148:151], v[52:55], v[128:131]
    v_mfma_f32_16x16x32_bf16 v[112:115], v[152:155], v[48:51], v[112:115]
    v_mfma_f32_16x16x32_bf16 v[132:135], v[152:155], v[52:55], v[132:135]
    buffer_load_dwordx4 v[48:51], v5, s[8:11], s26 offen offset:0 sc1
    buffer_load_dwordx4 v[52:55], v5, s[8:11], s26 offen offset:256 sc1
    s_add_u32 s26, s26, 132608
    s_waitcnt lgkmcnt(0)
    s_barrier
    s_waitcnt vmcnt(14)
    v_mfma_f32_16x16x32_bf16 v[96:99], v[156:159], v[56:59], v[96:99]
    ds_read_b128 v[136:139], v4 offset:0
    v_mfma_f32_16x16x32_bf16 v[116:119], v[156:159], v[60:63], v[116:119]
    ds_read_b128 v[140:143], v4 offset:1024
    v_mfma_f32_16x16x32_bf16 v[100:103], v[160:163], v[56:59], v[100:103]
    ds_read_b128 v[144:147], v4 offset:2048
    v_mfma_f32_16x16x32_bf16 v[120:123], v[160:163], v[60:63], v[120:123]
    ds_read_b128 v[148:151], v4 offset:3072
    v_mfma_f32_16x16x32_bf16 v[104:107], v[164:167], v[56:59], v[104:107]
    ds_read_b128 v[152:155], v4 offset:4096
    v_mfma_f32_16x16x32_bf16 v[124:127], v[164:167], v[60:63], v[124:127]
    v_mfma_f32_16x16x32_bf16 v[108:111], v[168:171], v[56:59], v[108:111]
    v_mfma_f32_16x16x32_bf16 v[128:131], v[168:171], v[60:63], v[128:131]
    v_mfma_f32_16x16x32_bf16 v[112:115], v[172:175], v[56:59], v[112:115]
    v_mfma_f32_16x16x32_bf16 v[132:135], v[172:175], v[60:63], v[132:135]
    buffer_load_dwordx4 v[56:59], v5, s[8:11], s26 offen offset:0 sc1
    buffer_load_dwordx4 v[60:63], v5, s[8:11], s26 offen offset:256 sc1
    s_add_u32 s26, s26, 132608
    s_waitcnt lgkmcnt(0)
    s_waitcnt vmcnt(14)
    v_mfma_f32_16x16x32_bf16 v[96:99], v[136:139], v[64:67], v[96:99]
    ds_read_b128 v[156:159], v4 offset:5120
    v_mfma_f32_16x16x32_bf16 v[116:119], v[136:139], v[68:71], v[116:119]
    ds_read_b128 v[160:163], v4 offset:6144
    v_mfma_f32_16x16x32_bf16 v[100:103], v[140:143], v[64:67], v[100:103]
    ds_read_b128 v[164:167], v4 offset:7168
    v_mfma_f32_16x16x32_bf16 v[120:123], v[140:143], v[68:71], v[120:123]
    ds_read_b128 v[168:171], v4 offset:8192
    v_mfma_f32_16x16x32_bf16 v[104:107], v[144:147], v[64:67], v[104:107]
    ds_read_b128 v[172:175], v4 offset:9216
    v_mfma_f32_16x16x32_bf16 v[124:127], v[144:147], v[68:71], v[124:127]
    v_mfma_f32_16x16x32_bf16 v[108:111], v[148:151], v[64:67], v[108:111]
    v_mfma_f32_16x16x32_bf16 v[128:131], v[148:151], v[68:71], v[128:131]
    v_mfma_f32_16x16x32_bf16 v[112:115], v[152:155], v[64:67], v[112:115]
    v_mfma_f32_16x16x32_bf16 v[132:135], v[152:155], v[68:71], v[132:135]
    buffer_load_dwordx4 v[64:67], v5, s[8:11], s26 offen offset:0 sc1
    buffer_load_dwordx4 v[68:71], v5, s[8:11], s26 offen offset:256 sc1
    s_add_u32 s26, s26, 132608
    s_waitcnt lgkmcnt(0)
    s_barrier
    s_waitcnt vmcnt(14)
    v_mfma_f32_16x16x32_bf16 v[96:99], v[156:159], v[72:75], v[96:99]
    ds_read_b128 v[136:139], v4 offset:20480
    v_mfma_f32_16x16x32_bf16 v[116:119], v[156:159], v[76:79], v[116:119]
    ds_read_b128 v[140:143], v4 offset:21504
    v_mfma_f32_16x16x32_bf16 v[100:103], v[160:163], v[72:75], v[100:103]
    ds_read_b128 v[144:147], v4 offset:22528
    v_mfma_f32_16x16x32_bf16 v[120:123], v[160:163], v[76:79], v[120:123]
    ds_read_b128 v[148:151], v4 offset:23552
    v_mfma_f32_16x16x32_bf16 v[104:107], v[164:167], v[72:75], v[104:107]
    ds_read_b128 v[152:155], v4 offset:24576
    v_mfma_f32_16x16x32_bf16 v[124:127], v[164:167], v[76:79], v[124:127]
    v_mfma_f32_16x16x32_bf16 v[108:111], v[168:171], v[72:75], v[108:111]
    v_mfma_f32_16x16x32_bf16 v[128:131], v[168:171], v[76:79], v[128:131]
    v_mfma_f32_16x16x32_bf16 v[112:115], v[172:175], v[72:75], v[112:115]
    v_mfma_f32_16x16x32_bf16 v[132:135], v[172:175], v[76:79], v[132:135]
    buffer_load_dwordx4 v[72:75], v5, s[8:11], s26 offen offset:0 sc1
    buffer_load_dwordx4 v[76:79], v5, s[8:11], s26 offen offset:256 sc1
    s_add_u32 s26, s26, 132608
    s_waitcnt lgkmcnt(0)
    s_waitcnt vmcnt(14)
    v_mfma_f32_16x16x32_bf16 v[96:99], v[136:139], v[80:83], v[96:99]
    ds_read_b128 v[156:159], v4 offset:25600
    v_mfma_f32_16x16x32_bf16 v[116:119], v[136:139], v[84:87], v[116:119]
    ds_read_b128 v[160:163], v4 offset:26624
    v_mfma_f32_16x16x32_bf16 v[100:103], v[140:143], v[80:83], v[100:103]
    ds_read_b128 v[164:167], v4 offset:27648
    v_mfma_f32_16x16x32_bf16 v[120:123], v[140:143], v[84:87], v[120:123]
    ds_read_b128 v[168:171], v4 offset:28672
    v_mfma_f32_16x16x32_bf16 v[104:107], v[144:147], v[80:83], v[104:107]
    ds_read_b128 v[172:175], v4 offset:29696
    v_mfma_f32_16x16x32_bf16 v[124:127], v[144:147], v[84:87], v[124:127]
    v_mfma_f32_16x16x32_bf16 v[108:111], v[148:151], v[80:83], v[108:111]
    v_mfma_f32_16x16x32_bf16 v[128:131], v[148:151], v[84:87], v[128:131]
    v_mfma_f32_16x16x32_bf16 v[112:115], v[152:155], v[80:83], v[112:115]
    v_mfma_f32_16x16x32_bf16 v[132:135], v[152:155], v[84:87], v[132:135]
    buffer_load_dwordx4 v[80:83], v5, s[8:11], s26 offen offset:0 sc1
    buffer_load_dwordx4 v[84:87], v5, s[8:11], s26 offen offset:256 sc1
    s_add_u32 s26, s26, 132608
    s_waitcnt lgkmcnt(0)
    s_barrier
    s_waitcnt vmcnt(14)
    v_mfma_f32_16x16x32_bf16 v[96:99], v[156:159], v[88:91], v[96:99]
    ds_read_b128 v[136:139], v4 offset:40960
    v_mfma_f32_16x16x32_bf16 v[116:119], v[156:159], v[92:95], v[116:119]
    ds_read_b128 v[140:143], v4 offset:41984
    v_mfma_f32_16x16x32_bf16 v[100:103], v[160:163], v[88:91], v[100:103]
    ds_read_b128 v[144:147], v4 offset:43008
    v_mfma_f32_16x16x32_bf16 v[120:123], v[160:163], v[92:95], v[120:123]
    ds_read_b128 v[148:151], v4 offset:44032
    v_mfma_f32_16x16x32_bf16 v[104:107], v[164:167], v[88:91], v[104:107]
    ds_read_b128 v[152:155], v4 offset:45056
    v_mfma_f32_16x16x32_bf16 v[124:127], v[164:167], v[92:95], v[124:127]
    v_mfma_f32_16x16x32_bf16 v[108:111], v[168:171], v[88:91], v[108:111]
    v_mfma_f32_16x16x32_bf16 v[128:131], v[168:171], v[92:95], v[128:131]
    v_mfma_f32_16x16x32_bf16 v[112:115], v[172:175], v[88:91], v[112:115]
    v_mfma_f32_16x16x32_bf16 v[132:135], v[172:175], v[92:95], v[132:135]
    buffer_load_dwordx4 v[88:91], v5, s[8:11], s26 offen offset:0 sc1
    buffer_load_dwordx4 v[92:95], v5, s[8:11], s26 offen offset:256 sc1
    s_add_u32 s26, s26, 132608
    s_waitcnt lgkmcnt(0)
    s_waitcnt vmcnt(14)
    v_mfma_f32_16x16x32_bf16 v[96:99], v[136:139], v[32:35], v[96:99]
    ds_read_b128 v[156:159], v4 offset:46080
    v_mfma_f32_16x16x32_bf16 v[116:119], v[136:139], v[36:39], v[116:119]
    ds_read_b128 v[160:163], v4 offset:47104
    v_mfma_f32_16x16x32_bf16 v[100:103], v[140:143], v[32:35], v[100:103]
    ds_read_b128 v[164:167], v4 offset:48128
    v_mfma_f32_16x16x32_bf16 v[120:123], v[140:143], v[36:39], v[120:123]
    ds_read_b128 v[168:171], v4 offset:49152
    v_mfma_f32_16x16x32_bf16 v[104:107], v[144:147], v[32:35], v[104:107]
    ds_read_b128 v[172:175], v4 offset:50176
    v_mfma_f32_16x16x32_bf16 v[124:127], v[144:147], v[36:39], v[124:127]
    v_mfma_f32_16x16x32_bf16 v[108:111], v[148:151], v[32:35], v[108:111]
    v_mfma_f32_16x16x32_bf16 v[128:131], v[148:151], v[36:39], v[128:131]
    v_mfma_f32_16x16x32_bf16 v[112:115], v[152:155], v[32:35], v[112:115]
    v_mfma_f32_16x16x32_bf16 v[132:135], v[152:155], v[36:39], v[132:135]
    buffer_load_dwordx4 v[32:35], v5, s[8:11], s26 offen offset:0 sc1
    buffer_load_dwordx4 v[36:39], v5, s[8:11], s26 offen offset:256 sc1
    s_add_u32 s26, s26, 132608
    s_waitcnt lgkmcnt(0)
    s_barrier
    s_waitcnt vmcnt(14)
    v_mfma_f32_16x16x32_bf16 v[96:99], v[156:159], v[40:43], v[96:99]
    ds_read_b128 v[136:139], v6 offset:0
    v_mfma_f32_16x16x32_bf16 v[116:119], v[156:159], v[44:47], v[116:119]
    ds_read_b128 v[140:143], v6 offset:1024
    v_mfma_f32_16x16x32_bf16 v[100:103], v[160:163], v[40:43], v[100:103]
    ds_read_b128 v[144:147], v6 offset:2048
    v_mfma_f32_16x16x32_bf16 v[120:123], v[160:163], v[44:47], v[120:123]
    ds_read_b128 v[148:151], v6 offset:3072
    v_mfma_f32_16x16x32_bf16 v[104:107], v[164:167], v[40:43], v[104:107]
    ds_read_b128 v[152:155], v6 offset:4096
    v_mfma_f32_16x16x32_bf16 v[124:127], v[164:167], v[44:47], v[124:127]
    v_mfma_f32_16x16x32_bf16 v[108:111], v[168:171], v[40:43], v[108:111]
    v_mfma_f32_16x16x32_bf16 v[128:131], v[168:171], v[44:47], v[128:131]
    v_mfma_f32_16x16x32_bf16 v[112:115], v[172:175], v[40:43], v[112:115]
    v_mfma_f32_16x16x32_bf16 v[132:135], v[172:175], v[44:47], v[132:135]
    buffer_load_dwordx4 v[40:43], v5, s[8:11], s26 offen offset:0 sc1
    buffer_load_dwordx4 v[44:47], v5, s[8:11], s26 offen offset:256 sc1
    s_add_u32 s26, s26, 132608
    s_waitcnt lgkmcnt(0)
    s_waitcnt vmcnt(14)
    v_mfma_f32_16x16x32_bf16 v[96:99], v[136:139], v[48:51], v[96:99]
    ds_read_b128 v[156:159], v6 offset:5120
    v_mfma_f32_16x16x32_bf16 v[116:119], v[136:139], v[52:55], v[116:119]
    ds_read_b128 v[160:163], v6 offset:6144
    v_mfma_f32_16x16x32_bf16 v[100:103], v[140:143], v[48:51], v[100:103]
    ds_read_b128 v[164:167], v6 offset:7168
    v_mfma_f32_16x16x32_bf16 v[120:123], v[140:143], v[52:55], v[120:123]
    ds_read_b128 v[168:171], v6 offset:8192
    v_mfma_f32_16x16x32_bf16 v[104:107], v[144:147], v[48:51], v[104:107]
    ds_read_b128 v[172:175], v6 offset:9216
    v_mfma_f32_16x16x32_bf16 v[124:127], v[144:147], v[52:55], v[124:127]
    v_mfma_f32_16x16x32_bf16 v[108:111], v[148:151], v[48:51], v[108:111]
    v_mfma_f32_16x16x32_bf16 v[128:131], v[148:151], v[52:55], v[128:131]
    v_mfma_f32_16x16x32_bf16 v[112:115], v[152:155], v[48:51], v[112:115]
    v_mfma_f32_16x16x32_bf16 v[132:135], v[152:155], v[52:55], v[132:135]
    buffer_load_dwordx4 v[48:51], v5, s[8:11], s26 offen offset:0 sc1
    buffer_load_dwordx4 v[52:55], v5, s[8:11], s26 offen offset:256 sc1
    s_add_u32 s26, s26, 132608
    s_waitcnt lgkmcnt(0)
    s_barrier
    s_waitcnt vmcnt(14)
    v_mfma_f32_16x16x32_bf16 v[96:99], v[156:159], v[56:59], v[96:99]
    ds_read_b128 v[136:139], v6 offset:20480
    v_mfma_f32_16x16x32_bf16 v[116:119], v[156:159], v[60:63], v[116:119]
    ds_read_b128 v[140:143], v6 offset:21504
    v_mfma_f32_16x16x32_bf16 v[100:103], v[160:163], v[56:59], v[100:103]
    ds_read_b128 v[144:147], v6 offset:22528
    v_mfma_f32_16x16x32_bf16 v[120:123], v[160:163], v[60:63], v[120:123]
    ds_read_b128 v[148:151], v6 offset:23552
    v_mfma_f32_16x16x32_bf16 v[104:107], v[164:167], v[56:59], v[104:107]
    ds_read_b128 v[152:155], v6 offset:24576
    v_mfma_f32_16x16x32_bf16 v[124:127], v[164:167], v[60:63], v[124:127]
    v_mfma_f32_16x16x32_bf16 v[108:111], v[168:171], v[56:59], v[108:111]
    v_mfma_f32_16x16x32_bf16 v[128:131], v[168:171], v[60:63], v[128:131]
    v_mfma_f32_16x16x32_bf16 v[112:115], v[172:175], v[56:59], v[112:115]
    v_mfma_f32_16x16x32_bf16 v[132:135], v[172:175], v[60:63], v[132:135]
    s_waitcnt lgkmcnt(0)
    s_waitcnt vmcnt(12)
    v_mfma_f32_16x16x32_bf16 v[96:99], v[136:139], v[64:67], v[96:99]
    ds_read_b128 v[156:159], v6 offset:25600
    v_mfma_f32_16x16x32_bf16 v[116:119], v[136:139], v[68:71], v[116:119]
    ds_read_b128 v[160:163], v6 offset:26624
    v_mfma_f32_16x16x32_bf16 v[100:103], v[140:143], v[64:67], v[100:103]
    ds_read_b128 v[164:167], v6 offset:27648
    v_mfma_f32_16x16x32_bf16 v[120:123], v[140:143], v[68:71], v[120:123]
    ds_read_b128 v[168:171], v6 offset:28672
    v_mfma_f32_16x16x32_bf16 v[104:107], v[144:147], v[64:67], v[104:107]
    ds_read_b128 v[172:175], v6 offset:29696
    v_mfma_f32_16x16x32_bf16 v[124:127], v[144:147], v[68:71], v[124:127]
    v_mfma_f32_16x16x32_bf16 v[108:111], v[148:151], v[64:67], v[108:111]
    v_mfma_f32_16x16x32_bf16 v[128:131], v[148:151], v[68:71], v[128:131]
    v_mfma_f32_16x16x32_bf16 v[112:115], v[152:155], v[64:67], v[112:115]
    v_mfma_f32_16x16x32_bf16 v[132:135], v[152:155], v[68:71], v[132:135]
    s_waitcnt lgkmcnt(0)
    s_barrier
    s_waitcnt vmcnt(10)
    v_mfma_f32_16x16x32_bf16 v[96:99], v[156:159], v[72:75], v[96:99]
    ds_read_b128 v[136:139], v6 offset:40960
    v_mfma_f32_16x16x32_bf16 v[116:119], v[156:159], v[76:79], v[116:119]
    ds_read_b128 v[140:143], v6 offset:41984
    v_mfma_f32_16x16x32_bf16 v[100:103], v[160:163], v[72:75], v[100:103]
    ds_read_b128 v[144:147], v6 offset:43008
    v_mfma_f32_16x16x32_bf16 v[120:123], v[160:163], v[76:79], v[120:123]
    ds_read_b128 v[148:151], v6 offset:44032
    v_mfma_f32_16x16x32_bf16 v[104:107], v[164:167], v[72:75], v[104:107]
    ds_read_b128 v[152:155], v6 offset:45056
    v_mfma_f32_16x16x32_bf16 v[124:127], v[164:167], v[76:79], v[124:127]
    v_mfma_f32_16x16x32_bf16 v[108:111], v[168:171], v[72:75], v[108:111]
    v_mfma_f32_16x16x32_bf16 v[128:131], v[168:171], v[76:79], v[128:131]
    v_mfma_f32_16x16x32_bf16 v[112:115], v[172:175], v[72:75], v[112:115]
    v_mfma_f32_16x16x32_bf16 v[132:135], v[172:175], v[76:79], v[132:135]
    s_waitcnt lgkmcnt(0)
    s_waitcnt vmcnt(8)
    v_mfma_f32_16x16x32_bf16 v[96:99], v[136:139], v[80:83], v[96:99]
    ds_read_b128 v[156:159], v6 offset:46080
    v_mfma_f32_16x16x32_bf16 v[116:119], v[136:139], v[84:87], v[116:119]
    ds_read_b128 v[160:163], v6 offset:47104
    v_mfma_f32_16x16x32_bf16 v[100:103], v[140:143], v[80:83], v[100:103]
    ds_read_b128 v[164:167], v6 offset:48128
    v_mfma_f32_16x16x32_bf16 v[120:123], v[140:143], v[84:87], v[120:123]
    ds_read_b128 v[168:171], v6 offset:49152
    v_mfma_f32_16x16x32_bf16 v[104:107], v[144:147], v[80:83], v[104:107]
    ds_read_b128 v[172:175], v6 offset:50176
    v_mfma_f32_16x16x32_bf16 v[124:127], v[144:147], v[84:87], v[124:127]
    v_mfma_f32_16x16x32_bf16 v[108:111], v[148:151], v[80:83], v[108:111]
    v_mfma_f32_16x16x32_bf16 v[128:131], v[148:151], v[84:87], v[128:131]
    v_mfma_f32_16x16x32_bf16 v[112:115], v[152:155], v[80:83], v[112:115]
    v_mfma_f32_16x16x32_bf16 v[132:135], v[152:155], v[84:87], v[132:135]
    s_waitcnt lgkmcnt(0)
    s_barrier
    s_waitcnt vmcnt(6)
    v_mfma_f32_16x16x32_bf16 v[96:99], v[156:159], v[88:91], v[96:99]
    ds_read_b128 v[136:139], v4 offset:0
    v_mfma_f32_16x16x32_bf16 v[116:119], v[156:159], v[92:95], v[116:119]
    ds_read_b128 v[140:143], v4 offset:1024
    v_mfma_f32_16x16x32_bf16 v[100:103], v[160:163], v[88:91], v[100:103]
    ds_read_b128 v[144:147], v4 offset:2048
    v_mfma_f32_16x16x32_bf16 v[120:123], v[160:163], v[92:95], v[120:123]
    ds_read_b128 v[148:151], v4 offset:3072
    v_mfma_f32_16x16x32_bf16 v[104:107], v[164:167], v[88:91], v[104:107]
    ds_read_b128 v[152:155], v4 offset:4096
    v_mfma_f32_16x16x32_bf16 v[124:127], v[164:167], v[92:95], v[124:127]
    v_mfma_f32_16x16x32_bf16 v[108:111], v[168:171], v[88:91], v[108:111]
    v_mfma_f32_16x16x32_bf16 v[128:131], v[168:171], v[92:95], v[128:131]
    v_mfma_f32_16x16x32_bf16 v[112:115], v[172:175], v[88:91], v[112:115]
    v_mfma_f32_16x16x32_bf16 v[132:135], v[172:175], v[92:95], v[132:135]
    s_waitcnt lgkmcnt(0)
    s_waitcnt vmcnt(4)
    v_mfma_f32_16x16x32_bf16 v[96:99], v[136:139], v[32:35], v[96:99]
    ds_read_b128 v[156:159], v4 offset:5120
    v_mfma_f32_16x16x32_bf16 v[116:119], v[136:139], v[36:39], v[116:119]
    ds_read_b128 v[160:163], v4 offset:6144
    v_mfma_f32_16x16x32_bf16 v[100:103], v[140:143], v[32:35], v[100:103]
    ds_read_b128 v[164:167], v4 offset:7168
    v_mfma_f32_16x16x32_bf16 v[120:123], v[140:143], v[36:39], v[120:123]
    ds_read_b128 v[168:171], v4 offset:8192
    v_mfma_f32_16x16x32_bf16 v[104:107], v[144:147], v[32:35], v[104:107]
    ds_read_b128 v[172:175], v4 offset:9216
    v_mfma_f32_16x16x32_bf16 v[124:127], v[144:147], v[36:39], v[124:127]
    v_mfma_f32_16x16x32_bf16 v[108:111], v[148:151], v[32:35], v[108:111]
    v_mfma_f32_16x16x32_bf16 v[128:131], v[148:151], v[36:39], v[128:131]
    v_mfma_f32_16x16x32_bf16 v[112:115], v[152:155], v[32:35], v[112:115]
    v_mfma_f32_16x16x32_bf16 v[132:135], v[152:155], v[36:39], v[132:135]
    s_waitcnt lgkmcnt(0)
    s_barrier
    s_waitcnt vmcnt(2)
    v_mfma_f32_16x16x32_bf16 v[96:99], v[156:159], v[40:43], v[96:99]
    ds_read_b128 v[136:139], v4 offset:20480
    v_mfma_f32_16x16x32_bf16 v[116:119], v[156:159], v[44:47], v[116:119]
    ds_read_b128 v[140:143], v4 offset:21504
    v_mfma_f32_16x16x32_bf16 v[100:103], v[160:163], v[40:43], v[100:103]
    ds_read_b128 v[144:147], v4 offset:22528
    v_mfma_f32_16x16x32_bf16 v[120:123], v[160:163], v[44:47], v[120:123]
    ds_read_b128 v[148:151], v4 offset:23552
    v_mfma_f32_16x16x32_bf16 v[104:107], v[164:167], v[40:43], v[104:107]
    ds_read_b128 v[152:155], v4 offset:24576
    v_mfma_f32_16x16x32_bf16 v[124:127], v[164:167], v[44:47], v[124:127]
    v_mfma_f32_16x16x32_bf16 v[108:111], v[168:171], v[40:43], v[108:111]
    v_mfma_f32_16x16x32_bf16 v[128:131], v[168:171], v[44:47], v[128:131]
    v_mfma_f32_16x16x32_bf16 v[112:115], v[172:175], v[40:43], v[112:115]
    v_mfma_f32_16x16x32_bf16 v[132:135], v[172:175], v[44:47], v[132:135]
    s_waitcnt lgkmcnt(0)
    s_waitcnt vmcnt(0)
    v_mfma_f32_16x16x32_bf16 v[96:99], v[136:139], v[48:51], v[96:99]
    v_mfma_f32_16x16x32_bf16 v[116:119], v[136:139], v[52:55], v[116:119]
    v_mfma_f32_16x16x32_bf16 v[100:103], v[140:143], v[48:51], v[100:103]
    v_mfma_f32_16x16x32_bf16 v[120:123], v[140:143], v[52:55], v[120:123]
    v_mfma_f32_16x16x32_bf16 v[104:107], v[144:147], v[48:51], v[104:107]
    v_mfma_f32_16x16x32_bf16 v[124:127], v[144:147], v[52:55], v[124:127]
    v_mfma_f32_16x16x32_bf16 v[108:111], v[148:151], v[48:51], v[108:111]
    v_mfma_f32_16x16x32_bf16 v[128:131], v[148:151], v[52:55], v[128:131]
    v_mfma_f32_16x16x32_bf16 v[112:115], v[152:155], v[48:51], v[112:115]
    v_mfma_f32_16x16x32_bf16 v[132:135], v[152:155], v[52:55], v[132:135]
    v_lshlrev_b32 v12, 4, v1
    s_lshl_b32 s27, s23, 1
    s_add_u32 s28, s27, s24
    s_mul_i32 s28, s28, 5120
    s_add_u32 s28, s28, 122880
    v_add_u32 v13, s28, v12
    s_xor_b32 s29, s24, 1
    s_add_u32 s28, s27, s29
    s_mul_i32 s28, s28, 5120
    s_add_u32 s28, s28, 122880
    v_add_u32 v12, s28, v12
    s_nop 4
    s_cmp_eq_u32 s24, 0
    s_cbranch_scc0 K6_b
    ds_write_b128 v13, v[116:119] offset:0
    ds_write_b128 v13, v[120:123] offset:1024
    ds_write_b128 v13, v[124:127] offset:2048
    ds_write_b128 v13, v[128:131] offset:3072
    ds_write_b128 v13, v[132:135] offset:4096
    s_waitcnt lgkmcnt(0)
    s_barrier
    ds_read_b128 v[176:179], v12 offset:0
    ds_read_b128 v[180:183], v12 offset:1024
    ds_read_b128 v[184:187], v12 offset:2048
    ds_read_b128 v[188:191], v12 offset:3072
    ds_read_b128 v[192:195], v12 offset:4096
    s_waitcnt lgkmcnt(4)
    v_pk_add_f32 v[176:177], v[176:177], v[96:97]
    v_pk_add_f32 v[178:179], v[178:179], v[98:99]
    s_waitcnt lgkmcnt(3)
    v_pk_add_f32 v[180:181], v[180:181], v[100:101]
    v_pk_add_f32 v[182:183], v[182:183], v[102:103]
    s_waitcnt lgkmcnt(2)
    v_pk_add_f32 v[184:185], v[184:185], v[104:105]
    v_pk_add_f32 v[186:187], v[186:187], v[106:107]
    s_waitcnt lgkmcnt(1)
    v_pk_add_f32 v[188:189], v[188:189], v[108:109]
    v_pk_add_f32 v[190:191], v[190:191], v[110:111]
    s_waitcnt lgkmcnt(0)
    v_pk_add_f32 v[192:193], v[192:193], v[112:113]
    v_pk_add_f32 v[194:195], v[194:195], v[114:115]
    s_branch K6_c
K6_b:
    ds_write_b128 v13, v[96:99] offset:0
    ds_write_b128 v13, v[100:103] offset:1024
    ds_write_b128 v13, v[104:107] offset:2048
    ds_write_b128 v13, v[108:111] offset:3072
    ds_write_b128 v13, v[112:115] offset:4096
    s_waitcnt lgkmcnt(0)
    s_barrier
    ds_read_b128 v[176:179], v12 offset:0
    ds_read_b128 v[180:183], v12 offset:1024
    ds_read_b128 v[184:187], v12 offset:2048
    ds_read_b128 v[188:191], v12 offset:3072
    ds_read_b128 v[192:195], v12 offset:4096
    s_waitcnt lgkmcnt(4)
    v_pk_add_f32 v[176:177], v[176:177], v[116:117]
    v_pk_add_f32 v[178:179], v[178:179], v[118:119]
    s_waitcnt lgkmcnt(3)
    v_pk_add_f32 v[180:181], v[180:181], v[120:121]
    v_pk_add_f32 v[182:183], v[182:183], v[122:123]
    s_waitcnt lgkmcnt(2)
    v_pk_add_f32 v[184:185], v[184:185], v[124:125]
    v_pk_add_f32 v[186:187], v[186:187], v[126:127]
    s_waitcnt lgkmcnt(1)
    v_pk_add_f32 v[188:189], v[188:189], v[128:129]
    v_pk_add_f32 v[190:191], v[190:191], v[130:131]
    s_waitcnt lgkmcnt(0)
    v_pk_add_f32 v[192:193], v[192:193], v[132:133]
    v_pk_add_f32 v[194:195], v[194:195], v[134:135]
K6_c:
    s_mov_b32 s8, s94
    s_mov_b32 s9, s95
    s_mov_b32 s10, 2621440
    s_mov_b32 s11, 0x00020000
    s_mul_i32 s33, s21, 160
    v_lshlrev_b32 v32, 16, v206
    v_and_b32 v33, 0xffff0000, v206
    v_lshlrev_b32 v34, 16, v207
    v_and_b32 v35, 0xffff0000, v207
    v_lshlrev_b32 v36, 16, v196
    v_and_b32 v37, 0xffff0000, v196
    v_lshlrev_b32 v38, 16, v197
    v_and_b32 v39, 0xffff0000, v197
    v_pk_add_f32 v[176:177], v[176:177], v[32:33]
    v_pk_add_f32 v[178:179], v[178:179], v[34:35]
    v_pk_fma_f32 v[176:177], v[176:177], v[216:217], v[36:37]
    v_pk_fma_f32 v[178:179], v[178:179], v[218:219], v[38:39]
    v_cvt_pk_bf16_f32 v176, v176, v177
    v_cvt_pk_bf16_f32 v177, v178, v179
    buffer_store_dwordx2 v[176:177], v17, s[8:11], s33 offen offset:0
    v_lshlrev_b32 v32, 16, v208
    v_and_b32 v33, 0xffff0000, v208
    v_lshlrev_b32 v34, 16, v209
    v_and_b32 v35, 0xffff0000, v209
    v_lshlrev_b32 v36, 16, v198
    v_and_b32 v37, 0xffff0000, v198
    v_lshlrev_b32 v38, 16, v199
    v_and_b32 v39, 0xffff0000, v199
    v_pk_add_f32 v[180:181], v[180:181], v[32:33]
    v_pk_add_f32 v[182:183], v[182:183], v[34:35]
    v_pk_fma_f32 v[180:181], v[180:181], v[220:221], v[36:37]
    v_pk_fma_f32 v[182:183], v[182:183], v[222:223], v[38:39]
    v_cvt_pk_bf16_f32 v180, v180, v181
    v_cvt_pk_bf16_f32 v181, v182, v183
    buffer_store_dwordx2 v[180:181], v17, s[8:11], s33 offen offset:32
    v_lshlrev_b32 v32, 16, v210
    v_and_b32 v33, 0xffff0000, v210
    v_lshlrev_b32 v34, 16, v211
    v_and_b32 v35, 0xffff0000, v211
    v_lshlrev_b32 v36, 16, v200
    v_and_b32 v37, 0xffff0000, v200
    v_lshlrev_b32 v38, 16, v201
    v_and_b32 v39, 0xffff0000, v201
    v_pk_add_f32 v[184:185], v[184:185], v[32:33]
    v_pk_add_f32 v[186:187], v[186:187], v[34:35]
    v_pk_fma_f32 v[184:185], v[184:185], v[224:225], v[36:37]
    v_pk_fma_f32 v[186:187], v[186:187], v[226:227], v[38:39]
    v_cvt_pk_bf16_f32 v184, v184, v185
    v_cvt_pk_bf16_f32 v185, v186, v187
    buffer_store_dwordx2 v[184:185], v17, s[8:11], s33 offen offset:64
    v_lshlrev_b32 v32, 16, v212
    v_and_b32 v33, 0xffff0000, v212
    v_lshlrev_b32 v34, 16, v213
    v_and_b32 v35, 0xffff0000, v213
    v_lshlrev_b32 v36, 16, v202
    v_and_b32 v37, 0xffff0000, v202
    v_lshlrev_b32 v38, 16, v203
    v_and_b32 v39, 0xffff0000, v203
    v_pk_add_f32 v[188:189], v[188:189], v[32:33]
    v_pk_add_f32 v[190:191], v[190:191], v[34:35]
    v_pk_fma_f32 v[188:189], v[188:189], v[228:229], v[36:37]
    v_pk_fma_f32 v[190:191], v[190:191], v[230:231], v[38:39]
    v_cvt_pk_bf16_f32 v188, v188, v189
    v_cvt_pk_bf16_f32 v189, v190, v191
    buffer_store_dwordx2 v[188:189], v17, s[8:11], s33 offen offset:96
    v_lshlrev_b32 v32, 16, v214
    v_and_b32 v33, 0xffff0000, v214
    v_lshlrev_b32 v34, 16, v215
    v_and_b32 v35, 0xffff0000, v215
    v_lshlrev_b32 v36, 16, v204
    v_and_b32 v37, 0xffff0000, v204
    v_lshlrev_b32 v38, 16, v205
    v_and_b32 v39, 0xffff0000, v205
    v_pk_add_f32 v[192:193], v[192:193], v[32:33]
    v_pk_add_f32 v[194:195], v[194:195], v[34:35]
    v_pk_fma_f32 v[192:193], v[192:193], v[232:233], v[36:37]
    v_pk_fma_f32 v[194:195], v[194:195], v[234:235], v[38:39]
    v_cvt_pk_bf16_f32 v192, v192, v193
    v_cvt_pk_bf16_f32 v193, v194, v195
    buffer_store_dwordx2 v[192:193], v17, s[8:11], s33 offen offset:128
    s_endpgm
KM_ld:
    s_waitcnt lgkmcnt(0)
    s_add_u32 s96, s4, 524288
    s_addc_u32 s97, s5, 0
    s_mov_b32 s98, 98304
    s_mov_b32 s99, 0x00020000
    v_mov_b32 v11, 0
    v_mov_b32 v12, 0
    s_mov_b32 s33, 0
    s_mov_b32 s34, 0
    s_mov_b64 s[92:93], exec
    s_and_b32 s20, s2, 7
    s_lshr_b32 s21, s2, 3
    s_lshr_b32 s22, s21, 3
    s_lshl_b32 s22, s22, 3
    s_add_u32 s20, s20, s22
    s_and_b32 s21, s21, 7
    s_sub_u32 s23, s3, 4
    s_waitcnt lgkmcnt(0)
    s_add_u32 s12, s4, 50331648
    s_addc_u32 s13, s5, 0
    s_mov_b32 s14, 819200
    s_mov_b32 s15, 0x00020000
    s_mov_b32 s16, s4
    s_mov_b32 s17, s5
    s_mov_b32 s18, 131072
    s_mov_b32 s19, 0x00020000
    s_cmp_lg_u32 s23, 3
    s_cbranch_scc1 K3_nz
    s_cmp_eq_u32 s20, 0
    s_cselect_b32 s27, 6, 0
    s_cmp_eq_u32 s20, 31
    s_cselect_b32 s27, 2056, s27
    s_cmp_eq_u32 s27, 0
    s_cbranch_scc1 K3_nz
    s_add_u32 s36, s4, 16777216
    s_addc_u32 s37, s5, 0
    s_mov_b32 s38, 2652160
    s_mov_b32 s39, 0x00020000
    v_lshrrev_b32 v14, 1, v1
    v_and_b32 v15, 1, v1
    s_mul_i32 s28, s21, 10
    v_add_u32 v14, s28, v14
    v_mul_u32_u24 v14, 2072, v14
    v_add_u32 v15, s27, v15
    v_add_u32 v14, v15, v14
    v_lshlrev_b32 v14, 4, v14
    v_mov_b32 v16, 0
    v_mov_b32 v17, 0
    v_mov_b32 v18, 0
    v_mov_b32 v19, 0
    v_cmp_gt_u32 vcc, 20, v1
    s_and_saveexec_b64 s[42:43], vcc
    buffer_store_dwordx4 v[16:19], v14, s[36:39], 0 offen sc1
    s_mov_b64 exec, s[42:43]
K3_nz:
    v_lshlrev_b32 v14, 4, v1
    s_lshl_b32 s27, s23, 10
    s_add_u32 s28, s27, 97792
    s_add_u32 m0, s27, 122880
    s_nop 0
    buffer_load_dwordx4 v14, s[16:19], s28 offen lds
    s_cmp_lg_u32 s23, 0
    s_cbranch_scc1 K3_n4
    s_mov_b32 s28, 101888
    s_mov_b32 m0, 126976
    s_nop 0
    buffer_load_dwordx4 v14, s[16:19], s28 offen lds
K3_n4:
    s_lshr_b32 s24, s23, 1
    s_and_b32 s23, s23, 1
    s_mul_i32 s24, s24, 10
    s_add_u32 s24, s24, s23
    s_mul_i32 s26, s24, 40960
    s_mul_i32 s27, s21, 5120
    s_add_u32 s26, s26, s27
    s_mul_i32 s28, s24, 5120
    s_waitcnt vmcnt(0)
    s_barrier
    s_add_u32 m0, s28, 0
    s_nop 0
    buffer_load_dwordx4 v4, s[12:15], s26 offen lds
    s_add_u32 m0, s28, 1024
    s_add_u32 s31, s26, 1024
    buffer_load_dwordx4 v4, s[12:15], s31 offen lds
    s_add_u32 m0, s28, 2048
    s_add_u32 s31, s26, 2048
    buffer_load_dwordx4 v4, s[12:15], s31 offen lds
    s_add_u32 m0, s28, 3072
    s_add_u32 s31, s26, 3072
    buffer_load_dwordx4 v4, s[12:15], s31 offen lds
    s_add_u32 m0, s28, 4096
    s_add_u32 s29, s26, 4096
    s_nop 0
    buffer_load_dwordx4 v4, s[12:15], s29 offen lds
    s_add_u32 s26, s26, 81920
    s_add_u32 m0, s28, 10240
    s_nop 0
    buffer_load_dwordx4 v4, s[12:15], s26 offen lds
    s_add_u32 m0, s28, 11264
    s_add_u32 s31, s26, 1024
    buffer_load_dwordx4 v4, s[12:15], s31 offen lds
    s_add_u32 m0, s28, 12288
    s_add_u32 s31, s26, 2048
    buffer_load_dwordx4 v4, s[12:15], s31 offen lds
    s_add_u32 m0, s28, 13312
    s_add_u32 s31, s26, 3072
    buffer_load_dwordx4 v4, s[12:15], s31 offen lds
    s_add_u32 m0, s28, 14336
    s_add_u32 s29, s26, 4096
    s_nop 0
    buffer_load_dwordx4 v4, s[12:15], s29 offen lds
    s_add_u32 s26, s26, 81920
    s_add_u32 m0, s28, 20480
    s_nop 0
    buffer_load_dwordx4 v4, s[12:15], s26 offen lds
    s_add_u32 m0, s28, 21504
    s_add_u32 s31, s26, 1024
    buffer_load_dwordx4 v4, s[12:15], s31 offen lds
    s_add_u32 m0, s28, 22528
    s_add_u32 s31, s26, 2048
    buffer_load_dwordx4 v4, s[12:15], s31 offen lds
    s_add_u32 m0, s28, 23552
    s_add_u32 s31, s26, 3072
    buffer_load_dwordx4 v4, s[12:15], s31 offen lds
    s_add_u32 m0, s28, 24576
    s_add_u32 s29, s26, 4096
    s_nop 0
    buffer_load_dwordx4 v4, s[12:15], s29 offen lds
    s_add_u32 s26, s26, 81920
    s_add_u32 m0, s28, 30720
    s_nop 0
    buffer_load_dwordx4 v4, s[12:15], s26 offen lds
    s_add_u32 m0, s28, 31744
    s_add_u32 s31, s26, 1024
    buffer_load_dwordx4 v4, s[12:15], s31 offen lds
    s_add_u32 m0, s28, 32768
    s_add_u32 s31, s26, 2048
    buffer_load_dwordx4 v4, s[12:15], s31 offen lds
    s_add_u32 m0, s28, 33792
    s_add_u32 s31, s26, 3072
    buffer_load_dwordx4 v4, s[12:15], s31 offen lds
    s_add_u32 m0, s28, 34816
    s_add_u32 s29, s26, 4096
    s_nop 0
    buffer_load_dwordx4 v4, s[12:15], s29 offen lds
    s_add_u32 s26, s26, 81920
    s_add_u32 m0, s28, 40960
    s_nop 0
    buffer_load_dwordx4 v4, s[12:15], s26 offen lds
    s_add_u32 m0, s28, 41984
    s_add_u32 s31, s26, 1024
    buffer_load_dwordx4 v4, s[12:15], s31 offen lds
    s_add_u32 m0, s28, 43008
    s_add_u32 s31, s26, 2048
    buffer_load_dwordx4 v4, s[12:15], s31 offen lds
    s_add_u32 m0, s28, 44032
    s_add_u32 s31, s26, 3072
    buffer_load_dwordx4 v4, s[12:15], s31 offen lds
    s_add_u32 m0, s28, 45056
    s_add_u32 s29, s26, 4096
    s_nop 0
    buffer_load_dwordx4 v4, s[12:15], s29 offen lds
    s_add_u32 s26, s26, 81920
    s_waitcnt vmcnt(20)
    s_barrier
    s_waitcnt vmcnt(15)
    s_barrier
    s_waitcnt vmcnt(10)
    s_barrier
    s_waitcnt vmcnt(5)
    s_barrier
    s_waitcnt vmcnt(0)
    s_barrier
    s_and_b32 s20, s2, 7
    s_lshr_b32 s21, s2, 3
    s_lshr_b32 s22, s21, 3
    s_lshl_b32 s22, s22, 3
    s_add_u32 s20, s20, s22
    s_and_b32 s21, s21, 7
    s_sub_u32 s23, s3, 4
    s_lshr_b32 s24, s23, 1
    s_and_b32 s23, s23, 1
    s_mul_i32 s24, s24, 10
    s_add_u32 s24, s24, s23
    s_mul_i32 s26, s24, 40960
    s_mul_i32 s27, s21, 5120
    s_add_u32 s26, s26, s27
    s_mul_i32 s28, s24, 5120
    s_add_u32 s12, s4, 51150848
    s_addc_u32 s13, s5, 0
    s_mov_b32 s14, 819200
    s_mov_b32 s15, 0x00020000
    s_mov_b32 s16, s4
    s_mov_b32 s17, s5
    s_mov_b32 s18, 131072
    s_mov_b32 s19, 0x00020000
    s_barrier
    s_add_u32 m0, s28, 0
    s_nop 0
    buffer_load_dwordx4 v4, s[12:15], s26 offen lds
    s_add_u32 m0, s28, 1024
    s_add_u32 s31, s26, 1024
    buffer_load_dwordx4 v4, s[12:15], s31 offen lds
    s_add_u32 m0, s28, 2048
    s_add_u32 s31, s26, 2048
    buffer_load_dwordx4 v4, s[12:15], s31 offen lds
    s_add_u32 m0, s28, 3072
    s_add_u32 s31, s26, 3072
    buffer_load_dwordx4 v4, s[12:15], s31 offen lds
    s_add_u32 m0, s28, 4096
    s_add_u32 s29, s26, 4096
    s_nop 0
    buffer_load_dwordx4 v4, s[12:15], s29 offen lds
    s_add_u32 s26, s26, 81920
    s_add_u32 m0, s28, 10240
    s_nop 0
    buffer_load_dwordx4 v4, s[12:15], s26 offen lds
    s_add_u32 m0, s28, 11264
    s_add_u32 s31, s26, 1024
    buffer_load_dwordx4 v4, s[12:15], s31 offen lds
    s_add_u32 m0, s28, 12288
    s_add_u32 s31, s26, 2048
    buffer_load_dwordx4 v4, s[12:15], s31 offen lds
    s_add_u32 m0, s28, 13312
    s_add_u32 s31, s26, 3072
    buffer_load_dwordx4 v4, s[12:15], s31 offen lds
    s_add_u32 m0, s28, 14336
    s_add_u32 s29, s26, 4096
    s_nop 0
    buffer_load_dwordx4 v4, s[12:15], s29 offen lds
    s_add_u32 s26, s26, 81920
    s_add_u32 m0, s28, 20480
    s_nop 0
    buffer_load_dwordx4 v4, s[12:15], s26 offen lds
    s_add_u32 m0, s28, 21504
    s_add_u32 s31, s26, 1024
    buffer_load_dwordx4 v4, s[12:15], s31 offen lds
    s_add_u32 m0, s28, 22528
    s_add_u32 s31, s26, 2048
    buffer_load_dwordx4 v4, s[12:15], s31 offen lds
    s_add_u32 m0, s28, 23552
    s_add_u32 s31, s26, 3072
    buffer_load_dwordx4 v4, s[12:15], s31 offen lds
    s_add_u32 m0, s28, 24576
    s_add_u32 s29, s26, 4096
    s_nop 0
    buffer_load_dwordx4 v4, s[12:15], s29 offen lds
    s_add_u32 s26, s26, 81920
    s_add_u32 m0, s28, 30720
    s_nop 0
    buffer_load_dwordx4 v4, s[12:15], s26 offen lds
    s_add_u32 m0, s28, 31744
    s_add_u32 s31, s26, 1024
    buffer_load_dwordx4 v4, s[12:15], s31 offen lds
    s_add_u32 m0, s28, 32768
    s_add_u32 s31, s26, 2048
    buffer_load_dwordx4 v4, s[12:15], s31 offen lds
    s_add_u32 m0, s28, 33792
    s_add_u32 s31, s26, 3072
    buffer_load_dwordx4 v4, s[12:15], s31 offen lds
    s_add_u32 m0, s28, 34816
    s_add_u32 s29, s26, 4096
    s_nop 0
    buffer_load_dwordx4 v4, s[12:15], s29 offen lds
    s_add_u32 s26, s26, 81920
    s_add_u32 m0, s28, 40960
    s_nop 0
    buffer_load_dwordx4 v4, s[12:15], s26 offen lds
    s_add_u32 m0, s28, 41984
    s_add_u32 s31, s26, 1024
    buffer_load_dwordx4 v4, s[12:15], s31 offen lds
    s_add_u32 m0, s28, 43008
    s_add_u32 s31, s26, 2048
    buffer_load_dwordx4 v4, s[12:15], s31 offen lds
    s_add_u32 m0, s28, 44032
    s_add_u32 s31, s26, 3072
    buffer_load_dwordx4 v4, s[12:15], s31 offen lds
    s_add_u32 m0, s28, 45056
    s_add_u32 s29, s26, 4096
    s_nop 0
    buffer_load_dwordx4 v4, s[12:15], s29 offen lds
    s_add_u32 s26, s26, 81920
    s_barrier
    s_cmp_lg_u32 s3, 5
    s_cbranch_scc1 H3_x
    v_and_b32 v13, 63, v0
    s_lshl_b32 s34, s20, 3
    s_sub_u32 s34, s34, 8
    v_add_u32 v14, s34, v13
    v_lshlrev_b32 v11, 7, v14
    v_lshrrev_b32 v15, 3, v13
    v_sub_u32 v15, 2, v15
    v_lshlrev_b32 v15, 3, v15
    v_add_u32 v15, s21, v15
    v_lshl_add_u32 v11, v15, 2, v11
    v_cmp_gt_u32 vcc, 0x100, v14
    s_nop 4
    s_mov_b64 s[92:93], vcc
    v_cmp_gt_u32 vcc, 24, v13
    s_nop 4
    s_and_b64 vcc, vcc, s[92:93]
    v_mov_b32 v12, 1
    s_nop 3
    s_mov_b64 s[92:93], vcc
    s_mov_b32 s34, 0
H3_x:
    s_cmp_lg_u32 s3, 4
    s_cbranch_scc1 H3_y
    s_cmp_eq_u32 s20, 0
    s_cselect_b32 s34, 8, 0
    s_cmp_eq_u32 s20, 31
    s_cselect_b32 s35, 15, 23
    v_and_b32 v11, 63, v0
    v_max_u32 v11, s34, v11
    v_min_u32 v11, s35, v11
    v_lshlrev_b32 v11, 2, v11
    s_lshl_b32 s33, s20, 3
    s_add_u32 s33, s33, s21
    s_lshl_b32 s33, s33, 7
    s_add_u32 s33, s33, 0
H3_y:
    s_barrier
    s_cmp_lg_u32 s3, 5
    s_cbranch_scc1 H3_a
    s_mov_b64 exec, s[92:93]
    buffer_store_dword v12, v11, s[96:99], s34 offen sc1
    s_mov_b64 exec, -1
H3_a:
    s_cmp_lg_u32 s3, 4
    s_cbranch_scc1 H3_b
    s_mov_b32 s91, 0
    s_waitcnt vmcnt(0)
    buffer_load_dword v12, v11, s[96:99], s33 offen sc1
H3_poll:
    s_waitcnt vmcnt(0)
    v_cmp_ne_u32 vcc, 1, v12
    s_cbranch_vccz H3_pd
    buffer_load_dword v12, v11, s[96:99], s33 offen sc1
    s_add_u32 s91, s91, 1
    s_cmp_le_u32 s91, 0x8000
    s_cbranch_scc1 H3_poll
H3_pd:
H3_b:
    s_barrier
    s_waitcnt vmcnt(20)
    s_barrier
    s_waitcnt vmcnt(15)
    s_barrier
    s_waitcnt vmcnt(10)
    s_barrier
    s_waitcnt vmcnt(5)
    s_barrier
    s_waitcnt vmcnt(0)
    s_barrier
    s_lshr_b32 s88, s20, 1
    s_lshl_b32 s88, s88, 4
    s_and_b32 s89, s20, 1
    s_lshl_b32 s89, s89, 3
    s_add_u32 s89, s89, s21
    s_and_b32 s20, s2, 3
    s_lshl_b32 s20, s20, 2
    s_lshr_b32 s22, s2, 3
    s_and_b32 s21, s22, 3
    s_add_u32 s20, s20, s21
    s_lshr_b32 s22, s22, 2
    s_and_b32 s21, s2, 4
    s_lshl_b32 s21, s21, 1
    s_add_u32 s21, s21, s22
    s_lshl_b32 s90, s20, 4
    s_mov_b32 s101, s21
    s_add_u32 s100, s90, s21
    s_mul_i32 s21, s21, 101
    s_mul_i32 s21, s21, 4370
    s_lshr_b32 s21, s21, 16
    s_sub_u32 s23, s3, 4
    s_and_b32 s24, s23, 1
    s_lshr_b32 s23, s23, 1
    s_mul_i32 s26, s24, 110592
    s_lshl_b32 s27, s21, 10
    s_add_u32 s26, s26, s27
    s_mul_i32 s28, s24, 7168
    s_add_u32 s12, s4, 54525952
    s_addc_u32 s13, s5, 0
    s_mov_b32 s14, 2211840
    s_mov_b32 s15, 0x00020000
    s_mov_b32 s16, s4
    s_mov_b32 s17, s5
    s_mov_b32 s18, 131072
    s_mov_b32 s19, 0x00020000
    s_cmp_eq_u32 s23, 0
    s_cbranch_scc0 K5_ld1
    s_barrier
    s_add_u32 m0, s28, 0
    s_add_u32 s31, s26, 0
    buffer_load_dwordx4 v4, s[12:15], s31 offen lds
    s_add_u32 m0, s28, 1024
    s_add_u32 s31, s26, 1024
    buffer_load_dwordx4 v4, s[12:15], s31 offen lds
    s_add_u32 m0, s28, 2048
    s_add_u32 s31, s26, 2048
    buffer_load_dwordx4 v4, s[12:15], s31 offen lds
    s_add_u32 m0, s28, 3072
    s_add_u32 s31, s26, 3072
    buffer_load_dwordx4 v4, s[12:15], s31 offen lds
    s_add_u32 s26, s26, 221184
    s_add_u32 m0, s28, 14336
    s_add_u32 s31, s26, 0
    buffer_load_dwordx4 v4, s[12:15], s31 offen lds
    s_add_u32 m0, s28, 15360
    s_add_u32 s31, s26, 1024
    buffer_load_dwordx4 v4, s[12:15], s31 offen lds
    s_add_u32 m0, s28, 16384
    s_add_u32 s31, s26, 2048
    buffer_load_dwordx4 v4, s[12:15], s31 offen lds
    s_add_u32 m0, s28, 17408
    s_add_u32 s31, s26, 3072
    buffer_load_dwordx4 v4, s[12:15], s31 offen lds
    s_add_u32 s26, s26, 221184
    s_add_u32 m0, s28, 28672
    s_add_u32 s31, s26, 0
    buffer_load_dwordx4 v4, s[12:15], s31 offen lds
    s_add_u32 m0, s28, 29696
    s_add_u32 s31, s26, 1024
    buffer_load_dwordx4 v4, s[12:15], s31 offen lds
    s_add_u32 m0, s28, 30720
    s_add_u32 s31, s26, 2048
    buffer_load_dwordx4 v4, s[12:15], s31 offen lds
    s_add_u32 m0, s28, 31744
    s_add_u32 s31, s26, 3072
    buffer_load_dwordx4 v4, s[12:15], s31 offen lds
    s_add_u32 s26, s26, 221184
    s_add_u32 m0, s28, 43008
    s_add_u32 s31, s26, 0
    buffer_load_dwordx4 v4, s[12:15], s31 offen lds
    s_add_u32 m0, s28, 44032
    s_add_u32 s31, s26, 1024
    buffer_load_dwordx4 v4, s[12:15], s31 offen lds
    s_add_u32 m0, s28, 45056
    s_add_u32 s31, s26, 2048
    buffer_load_dwordx4 v4, s[12:15], s31 offen lds
    s_add_u32 m0, s28, 46080
    s_add_u32 s31, s26, 3072
    buffer_load_dwordx4 v4, s[12:15], s31 offen lds
    s_add_u32 s26, s26, 221184
    s_add_u32 m0, s28, 57344
    s_add_u32 s31, s26, 0
    buffer_load_dwordx4 v4, s[12:15], s31 offen lds
    s_add_u32 m0, s28, 58368
    s_add_u32 s31, s26, 1024
    buffer_load_dwordx4 v4, s[12:15], s31 offen lds
    s_add_u32 m0, s28, 59392
    s_add_u32 s31, s26, 2048
    buffer_load_dwordx4 v4, s[12:15], s31 offen lds
    s_add_u32 m0, s28, 60416
    s_add_u32 s31, s26, 3072
    buffer_load_dwordx4 v4, s[12:15], s31 offen lds
    s_add_u32 s26, s26, 221184
    s_add_u32 m0, s28, 71680
    s_add_u32 s31, s26, 0
    buffer_load_dwordx4 v4, s[12:15], s31 offen lds
    s_add_u32 m0, s28, 72704
    s_add_u32 s31, s26, 1024
    buffer_load_dwordx4 v4, s[12:15], s31 offen lds
    s_add_u32 m0, s28, 73728
    s_add_u32 s31, s26, 2048
    buffer_load_dwordx4 v4, s[12:15], s31 offen lds
    s_add_u32 m0, s28, 74752
    s_add_u32 s31, s26, 3072
    buffer_load_dwordx4 v4, s[12:15], s31 offen lds
    s_add_u32 s26, s26, 221184
    s_add_u32 m0, s28, 86016
    s_add_u32 s31, s26, 0
    buffer_load_dwordx4 v4, s[12:15], s31 offen lds
    s_add_u32 m0, s28, 87040
    s_add_u32 s31, s26, 1024
    buffer_load_dwordx4 v4, s[12:15], s31 offen lds
    s_add_u32 m0, s28, 88064
    s_add_u32 s31, s26, 2048
    buffer_load_dwordx4 v4, s[12:15], s31 offen lds
    s_add_u32 m0, s28, 89088
    s_add_u32 s31, s26, 3072
    buffer_load_dwordx4 v4, s[12:15], s31 offen lds
    s_add_u32 s26, s26, 221184
    s_barrier
    s_cmp_lg_u32 s3, 5
    s_cbranch_scc1 H40_x
    v_and_b32 v13, 63, v0
    v_add_u32 v11, s88, v13
    v_lshlrev_b32 v11, 7, v11
    s_lshl_b32 s34, s89, 2
    v_add_u32 v11, s34, v11
    v_cmp_gt_u32 vcc, 16, v13
    v_mov_b32 v12, 1
    s_nop 3
    s_mov_b64 s[92:93], vcc
    s_mov_b32 s34, 32768
H40_x:
    s_cmp_lg_u32 s3, 4
    s_cbranch_scc1 H40_y
    v_and_b32 v11, 63, v0
    v_min_u32 v11, 15, v11
    v_lshlrev_b32 v11, 2, v11
    s_lshl_b32 s33, s100, 7
    s_add_u32 s33, s33, 32768
H40_y:
    s_barrier
    s_cmp_lg_u32 s3, 5
    s_cbranch_scc1 H40_a
    s_mov_b64 exec, s[92:93]
    buffer_store_dword v12, v11, s[96:99], s34 offen sc1
    s_mov_b64 exec, -1
H40_a:
    s_cmp_lg_u32 s3, 4
    s_cbranch_scc1 H40_b
    s_mov_b32 s91, 0
    s_waitcnt vmcnt(0)
    buffer_load_dword v12, v11, s[96:99], s33 offen sc1
H40_poll:
    s_waitcnt vmcnt(0)
    v_cmp_ne_u32 vcc, 1, v12
    s_cbranch_vccz H40_pd
    buffer_load_dword v12, v11, s[96:99], s33 offen sc1
    s_add_u32 s91, s91, 1
    s_cmp_le_u32 s91, 0x8000
    s_cbranch_scc1 H40_poll
H40_pd:
H40_b:
    s_barrier
    s_waitcnt vmcnt(24)
    s_barrier
    s_waitcnt vmcnt(20)
    s_barrier
    s_waitcnt vmcnt(16)
    s_barrier
    s_add_u32 m0, s28, 100352
    s_add_u32 s31, s26, 0
    buffer_load_dwordx4 v4, s[12:15], s31 offen lds
    s_add_u32 m0, s28, 101376
    s_add_u32 s31, s26, 1024
    buffer_load_dwordx4 v4, s[12:15], s31 offen lds
    s_add_u32 m0, s28, 102400
    s_add_u32 s31, s26, 2048
    buffer_load_dwordx4 v4, s[12:15], s31 offen lds
    s_add_u32 m0, s28, 103424
    s_add_u32 s31, s26, 3072
    buffer_load_dwordx4 v4, s[12:15], s31 offen lds
    s_add_u32 s26, s26, 221184
    s_waitcnt vmcnt(16)
    s_barrier
    s_add_u32 m0, s28, 114688
    s_add_u32 s31, s26, 0
    buffer_load_dwordx4 v4, s[12:15], s31 offen lds
    s_add_u32 m0, s28, 115712
    s_add_u32 s31, s26, 1024
    buffer_load_dwordx4 v4, s[12:15], s31 offen lds
    s_add_u32 m0, s28, 116736
    s_add_u32 s31, s26, 2048
    buffer_load_dwordx4 v4, s[12:15], s31 offen lds
    s_add_u32 m0, s28, 117760
    s_add_u32 s31, s26, 3072
    buffer_load_dwordx4 v4, s[12:15], s31 offen lds
    s_add_u32 s26, s26, 221184
    s_waitcnt vmcnt(16)
    s_barrier
    s_add_u32 m0, s28, 129024
    s_add_u32 s31, s26, 0
    buffer_load_dwordx4 v4, s[12:15], s31 offen lds
    s_add_u32 m0, s28, 130048
    s_add_u32 s31, s26, 1024
    buffer_load_dwordx4 v4, s[12:15], s31 offen lds
    s_add_u32 m0, s28, 131072
    s_add_u32 s31, s26, 2048
    buffer_load_dwordx4 v4, s[12:15], s31 offen lds
    s_add_u32 m0, s28, 132096
    s_add_u32 s31, s26, 3072
    buffer_load_dwordx4 v4, s[12:15], s31 offen lds
    s_add_u32 s26, s26, 221184
    s_waitcnt vmcnt(16)
    s_barrier
    s_waitcnt vmcnt(12)
    s_barrier
    s_waitcnt vmcnt(8)
    s_barrier
    s_waitcnt vmcnt(4)
    s_barrier
    s_waitcnt vmcnt(0)
    s_barrier
    s_branch K5_ld2
K5_ld1:
    s_barrier
    s_add_u32 m0, s28, 4096
    s_add_u32 s31, s26, 4096
    buffer_load_dwordx4 v4, s[12:15], s31 offen lds
    s_add_u32 m0, s28, 5120
    s_add_u32 s31, s26, 5120
    buffer_load_dwordx4 v4, s[12:15], s31 offen lds
    s_add_u32 m0, s28, 6144
    s_add_u32 s31, s26, 6144
    buffer_load_dwordx4 v4, s[12:15], s31 offen lds
    s_add_u32 s26, s26, 221184
    s_add_u32 m0, s28, 18432
    s_add_u32 s31, s26, 4096
    buffer_load_dwordx4 v4, s[12:15], s31 offen lds
    s_add_u32 m0, s28, 19456
    s_add_u32 s31, s26, 5120
    buffer_load_dwordx4 v4, s[12:15], s31 offen lds
    s_add_u32 m0, s28, 20480
    s_add_u32 s31, s26, 6144
    buffer_load_dwordx4 v4, s[12:15], s31 offen lds
    s_add_u32 s26, s26, 221184
    s_add_u32 m0, s28, 32768
    s_add_u32 s31, s26, 4096
    buffer_load_dwordx4 v4, s[12:15], s31 offen lds
    s_add_u32 m0, s28, 33792
    s_add_u32 s31, s26, 5120
    buffer_load_dwordx4 v4, s[12:15], s31 offen lds
    s_add_u32 m0, s28, 34816
    s_add_u32 s31, s26, 6144
    buffer_load_dwordx4 v4, s[12:15], s31 offen lds
    s_add_u32 s26, s26, 221184
    s_add_u32 m0, s28, 47104
    s_add_u32 s31, s26, 4096
    buffer_load_dwordx4 v4, s[12:15], s31 offen lds
    s_add_u32 m0, s28, 48128
    s_add_u32 s31, s26, 5120
    buffer_load_dwordx4 v4, s[12:15], s31 offen lds
    s_add_u32 m0, s28, 49152
    s_add_u32 s31, s26, 6144
    buffer_load_dwordx4 v4, s[12:15], s31 offen lds
    s_add_u32 s26, s26, 221184
    s_add_u32 m0, s28, 61440
    s_add_u32 s31, s26, 4096
    buffer_load_dwordx4 v4, s[12:15], s31 offen lds
    s_add_u32 m0, s28, 62464
    s_add_u32 s31, s26, 5120
    buffer_load_dwordx4 v4, s[12:15], s31 offen lds
    s_add_u32 m0, s28, 63488
    s_add_u32 s31, s26, 6144
    buffer_load_dwordx4 v4, s[12:15], s31 offen lds
    s_add_u32 s26, s26, 221184
    s_add_u32 m0, s28, 75776
    s_add_u32 s31, s26, 4096
    buffer_load_dwordx4 v4, s[12:15], s31 offen lds
    s_add_u32 m0, s28, 76800
    s_add_u32 s31, s26, 5120
    buffer_load_dwordx4 v4, s[12:15], s31 offen lds
    s_add_u32 m0, s28, 77824
    s_add_u32 s31, s26, 6144
    buffer_load_dwordx4 v4, s[12:15], s31 offen lds
    s_add_u32 s26, s26, 221184
    s_add_u32 m0, s28, 90112
    s_add_u32 s31, s26, 4096
    buffer_load_dwordx4 v4, s[12:15], s31 offen lds
    s_add_u32 m0, s28, 91136
    s_add_u32 s31, s26, 5120
    buffer_load_dwordx4 v4, s[12:15], s31 offen lds
    s_add_u32 m0, s28, 92160
    s_add_u32 s31, s26, 6144
    buffer_load_dwordx4 v4, s[12:15], s31 offen lds
    s_add_u32 s26, s26, 221184
    s_barrier
    s_cmp_lg_u32 s3, 5
    s_cbranch_scc1 H41_x
    v_and_b32 v13, 63, v0
    v_add_u32 v11, s88, v13
    v_lshlrev_b32 v11, 7, v11
    s_lshl_b32 s34, s89, 2
    v_add_u32 v11, s34, v11
    v_cmp_gt_u32 vcc, 16, v13
    v_mov_b32 v12, 1
    s_nop 3
    s_mov_b64 s[92:93], vcc
    s_mov_b32 s34, 32768
H41_x:
    s_cmp_lg_u32 s3, 4
    s_cbranch_scc1 H41_y
    v_and_b32 v11, 63, v0
    v_min_u32 v11, 15, v11
    v_lshlrev_b32 v11, 2, v11
    s_lshl_b32 s33, s100, 7
    s_add_u32 s33, s33, 32768
H41_y:
    s_barrier
    s_cmp_lg_u32 s3, 5
    s_cbranch_scc1 H41_a
    s_mov_b64 exec, s[92:93]
    buffer_store_dword v12, v11, s[96:99], s34 offen sc1
    s_mov_b64 exec, -1
H41_a:
    s_cmp_lg_u32 s3, 4
    s_cbranch_scc1 H41_b
    s_mov_b32 s91, 0
    s_waitcnt vmcnt(0)
    buffer_load_dword v12, v11, s[96:99], s33 offen sc1
H41_poll:
    s_waitcnt vmcnt(0)
    v_cmp_ne_u32 vcc, 1, v12
    s_cbranch_vccz H41_pd
    buffer_load_dword v12, v11, s[96:99], s33 offen sc1
    s_add_u32 s91, s91, 1
    s_cmp_le_u32 s91, 0x8000
    s_cbranch_scc1 H41_poll
H41_pd:
H41_b:
    s_barrier
    s_waitcnt vmcnt(18)
    s_barrier
    s_waitcnt vmcnt(15)
    s_barrier
    s_waitcnt vmcnt(12)
    s_barrier
    s_add_u32 m0, s28, 104448
    s_add_u32 s31, s26, 4096
    buffer_load_dwordx4 v4, s[12:15], s31 offen lds
    s_add_u32 m0, s28, 105472
    s_add_u32 s31, s26, 5120
    buffer_load_dwordx4 v4, s[12:15], s31 offen lds
    s_add_u32 m0, s28, 106496
    s_add_u32 s31, s26, 6144
    buffer_load_dwordx4 v4, s[12:15], s31 offen lds
    s_add_u32 s26, s26, 221184
    s_waitcnt vmcnt(12)
    s_barrier
    s_add_u32 m0, s28, 118784
    s_add_u32 s31, s26, 4096
    buffer_load_dwordx4 v4, s[12:15], s31 offen lds
    s_add_u32 m0, s28, 119808
    s_add_u32 s31, s26, 5120
    buffer_load_dwordx4 v4, s[12:15], s31 offen lds
    s_add_u32 m0, s28, 120832
    s_add_u32 s31, s26, 6144
    buffer_load_dwordx4 v4, s[12:15], s31 offen lds
    s_add_u32 s26, s26, 221184
    s_waitcnt vmcnt(12)
    s_barrier
    s_add_u32 m0, s28, 133120
    s_add_u32 s31, s26, 4096
    buffer_load_dwordx4 v4, s[12:15], s31 offen lds
    s_add_u32 m0, s28, 134144
    s_add_u32 s31, s26, 5120
    buffer_load_dwordx4 v4, s[12:15], s31 offen lds
    s_add_u32 m0, s28, 135168
    s_add_u32 s31, s26, 6144
    buffer_load_dwordx4 v4, s[12:15], s31 offen lds
    s_add_u32 s26, s26, 221184
    s_waitcnt vmcnt(12)
    s_barrier
    s_waitcnt vmcnt(9)
    s_barrier
    s_waitcnt vmcnt(6)
    s_barrier
    s_waitcnt vmcnt(3)
    s_barrier
    s_waitcnt vmcnt(0)
    s_barrier
K5_ld2:
    s_mov_b32 s88, s90
    s_mov_b32 s89, s101
    s_and_b32 s20, s2, 3
    s_lshl_b32 s20, s20, 3
    s_lshr_b32 s22, s2, 3
    s_and_b32 s21, s22, 7
    s_add_u32 s20, s20, s21
    s_lshr_b32 s22, s22, 3
    s_and_b32 s21, s2, 4
    s_add_u32 s21, s21, s22
    s_sub_u32 s23, s3, 4
    s_lshr_b32 s24, s23, 1
    s_and_b32 s23, s23, 1
    s_mul_i32 s25, s24, 27
    s_add_u32 s25, s25, s23
    s_mul_i32 s26, s25, 40960
    s_mul_i32 s27, s21, 5120
    s_add_u32 s26, s26, s27
    s_mul_i32 s28, s24, 10240
    s_mul_i32 s29, s23, 5120
    s_add_u32 s28, s28, s29
    s_add_u32 s12, s4, 51970048
    s_addc_u32 s13, s5, 0
    s_mov_b32 s14, 2211840
    s_mov_b32 s15, 0x00020000
    s_lshl_b32 s100, s20, 3
    s_add_u32 s100, s100, s21
    s_barrier
    s_add_u32 m0, s28, 0
    s_nop 0
    buffer_load_dwordx4 v4, s[12:15], s26 offen lds
    s_add_u32 m0, s28, 1024
    s_add_u32 s31, s26, 1024
    buffer_load_dwordx4 v4, s[12:15], s31 offen lds
    s_add_u32 m0, s28, 2048
    s_add_u32 s31, s26, 2048
    buffer_load_dwordx4 v4, s[12:15], s31 offen lds
    s_add_u32 m0, s28, 3072
    s_add_u32 s31, s26, 3072
    buffer_load_dwordx4 v4, s[12:15], s31 offen lds
    s_add_u32 m0, s28, 4096
    s_add_u32 s29, s26, 4096
    s_nop 0
    buffer_load_dwordx4 v4, s[12:15], s29 offen lds
    s_add_u32 s26, s26, 81920
    s_add_u32 m0, s28, 20480
    s_nop 0
    buffer_load_dwordx4 v4, s[12:15], s26 offen lds
    s_add_u32 m0, s28, 21504
    s_add_u32 s31, s26, 1024
    buffer_load_dwordx4 v4, s[12:15], s31 offen lds
    s_add_u32 m0, s28, 22528
    s_add_u32 s31, s26, 2048
    buffer_load_dwordx4 v4, s[12:15], s31 offen lds
    s_add_u32 m0, s28, 23552
    s_add_u32 s31, s26, 3072
    buffer_load_dwordx4 v4, s[12:15], s31 offen lds
    s_add_u32 m0, s28, 24576
    s_add_u32 s29, s26, 4096
    s_nop 0
    buffer_load_dwordx4 v4, s[12:15], s29 offen lds
    s_add_u32 s26, s26, 81920
    s_add_u32 m0, s28, 40960
    s_nop 0
    buffer_load_dwordx4 v4, s[12:15], s26 offen lds
    s_add_u32 m0, s28, 41984
    s_add_u32 s31, s26, 1024
    buffer_load_dwordx4 v4, s[12:15], s31 offen lds
    s_add_u32 m0, s28, 43008
    s_add_u32 s31, s26, 2048
    buffer_load_dwordx4 v4, s[12:15], s31 offen lds
    s_add_u32 m0, s28, 44032
    s_add_u32 s31, s26, 3072
    buffer_load_dwordx4 v4, s[12:15], s31 offen lds
    s_add_u32 m0, s28, 45056
    s_add_u32 s29, s26, 4096
    s_nop 0
    buffer_load_dwordx4 v4, s[12:15], s29 offen lds
    s_add_u32 s26, s26, 81920
    s_add_u32 m0, s28, 61440
    s_nop 0
    buffer_load_dwordx4 v4, s[12:15], s26 offen lds
    s_add_u32 m0, s28, 62464
    s_add_u32 s31, s26, 1024
    buffer_load_dwordx4 v4, s[12:15], s31 offen lds
    s_add_u32 m0, s28, 63488
    s_add_u32 s31, s26, 2048
    buffer_load_dwordx4 v4, s[12:15], s31 offen lds
    s_add_u32 m0, s28, 64512
    s_add_u32 s31, s26, 3072
    buffer_load_dwordx4 v4, s[12:15], s31 offen lds
    s_add_u32 m0, s28, 65536
    s_add_u32 s29, s26, 4096
    s_nop 0
    buffer_load_dwordx4 v4, s[12:15], s29 offen lds
    s_add_u32 s26, s26, 81920
    s_add_u32 m0, s28, 81920
    s_nop 0
    buffer_load_dwordx4 v4, s[12:15], s26 offen lds
    s_add_u32 m0, s28, 82944
    s_add_u32 s31, s26, 1024
    buffer_load_dwordx4 v4, s[12:15], s31 offen lds
    s_add_u32 m0, s28, 83968
    s_add_u32 s31, s26, 2048
    buffer_load_dwordx4 v4, s[12:15], s31 offen lds
    s_add_u32 m0, s28, 84992
    s_add_u32 s31, s26, 3072
    buffer_load_dwordx4 v4, s[12:15], s31 offen lds
    s_add_u32 m0, s28, 86016
    s_add_u32 s29, s26, 4096
    s_nop 0
    buffer_load_dwordx4 v4, s[12:15], s29 offen lds
    s_add_u32 s26, s26, 81920
    s_add_u32 m0, s28, 102400
    s_nop 0
    buffer_load_dwordx4 v4, s[12:15], s26 offen lds
    s_add_u32 m0, s28, 103424
    s_add_u32 s31, s26, 1024
    buffer_load_dwordx4 v4, s[12:15], s31 offen lds
    s_add_u32 m0, s28, 104448
    s_add_u32 s31, s26, 2048
    buffer_load_dwordx4 v4, s[12:15], s31 offen lds
    s_add_u32 m0, s28, 105472
    s_add_u32 s31, s26, 3072
    buffer_load_dwordx4 v4, s[12:15], s31 offen lds
    s_add_u32 m0, s28, 106496
    s_add_u32 s29, s26, 4096
    s_nop 0
    buffer_load_dwordx4 v4, s[12:15], s29 offen lds
    s_add_u32 s26, s26, 81920
    s_cmp_lg_u32 s3, 5
    s_cbranch_scc1 H5_x
    v_and_b32 v13, 63, v0
    v_add_u32 v11, s88, v13
    v_lshlrev_b32 v11, 7, v11
    s_lshl_b32 s34, s89, 2
    v_add_u32 v11, s34, v11
    v_cmp_gt_u32 vcc, 16, v13
    v_mov_b32 v12, 1
    s_nop 3
    s_mov_b64 s[92:93], vcc
    s_mov_b32 s34, 65536
H5_x:
    s_cmp_lg_u32 s3, 4
    s_cbranch_scc1 H5_y
    v_and_b32 v11, 63, v0
    v_min_u32 v11, 15, v11
    v_lshlrev_b32 v11, 2, v11
    s_lshl_b32 s33, s100, 7
    s_add_u32 s33, s33, 65536
H5_y:
    s_barrier
    s_cmp_lg_u32 s3, 5
    s_cbranch_scc1 H5_a
    s_mov_b64 exec, s[92:93]
    buffer_store_dword v12, v11, s[96:99], s34 offen sc1
    s_mov_b64 exec, -1
H5_a:
    s_cmp_lg_u32 s3, 4
    s_cbranch_scc1 H5_b
    s_mov_b32 s91, 0
    s_waitcnt vmcnt(0)
    buffer_load_dword v12, v11, s[96:99], s33 offen sc1
H5_poll:
    s_waitcnt vmcnt(0)
    v_cmp_ne_u32 vcc, 1, v12
    s_cbranch_vccz H5_pd
    buffer_load_dword v12, v11, s[96:99], s33 offen sc1
    s_add_u32 s91, s91, 1
    s_cmp_le_u32 s91, 0x8000
    s_cbranch_scc1 H5_poll
H5_pd:
H5_b:
    s_barrier
    s_waitcnt vmcnt(25)
    s_barrier
    s_waitcnt vmcnt(20)
    s_barrier
    s_add_u32 m0, s28, 0
    s_nop 0
    buffer_load_dwordx4 v4, s[12:15], s26 offen lds
    s_add_u32 m0, s28, 1024
    s_add_u32 s31, s26, 1024
    buffer_load_dwordx4 v4, s[12:15], s31 offen lds
    s_add_u32 m0, s28, 2048
    s_add_u32 s31, s26, 2048
    buffer_load_dwordx4 v4, s[12:15], s31 offen lds
    s_add_u32 m0, s28, 3072
    s_add_u32 s31, s26, 3072
    buffer_load_dwordx4 v4, s[12:15], s31 offen lds
    s_add_u32 m0, s28, 4096
    s_add_u32 s29, s26, 4096
    s_nop 0
    buffer_load_dwordx4 v4, s[12:15], s29 offen lds
    s_add_u32 s26, s26, 81920
    s_waitcnt vmcnt(20)
    s_barrier
    s_add_u32 m0, s28, 20480
    s_nop 0
    buffer_load_dwordx4 v4, s[12:15], s26 offen lds
    s_add_u32 m0, s28, 21504
    s_add_u32 s31, s26, 1024
    buffer_load_dwordx4 v4, s[12:15], s31 offen lds
    s_add_u32 m0, s28, 22528
    s_add_u32 s31, s26, 2048
    buffer_load_dwordx4 v4, s[12:15], s31 offen lds
    s_add_u32 m0, s28, 23552
    s_add_u32 s31, s26, 3072
    buffer_load_dwordx4 v4, s[12:15], s31 offen lds
    s_add_u32 m0, s28, 24576
    s_add_u32 s29, s26, 4096
    s_nop 0
    buffer_load_dwordx4 v4, s[12:15], s29 offen lds
    s_add_u32 s26, s26, 81920
    s_waitcnt vmcnt(20)
    s_barrier
    s_add_u32 m0, s28, 40960
    s_nop 0
    buffer_load_dwordx4 v4, s[12:15], s26 offen lds
    s_add_u32 m0, s28, 41984
    s_add_u32 s31, s26, 1024
    buffer_load_dwordx4 v4, s[12:15], s31 offen lds
    s_add_u32 m0, s28, 43008
    s_add_u32 s31, s26, 2048
    buffer_load_dwordx4 v4, s[12:15], s31 offen lds
    s_add_u32 m0, s28, 44032
    s_add_u32 s31, s26, 3072
    buffer_load_dwordx4 v4, s[12:15], s31 offen lds
    s_add_u32 m0, s28, 45056
    s_add_u32 s29, s26, 4096
    s_nop 0
    buffer_load_dwordx4 v4, s[12:15], s29 offen lds
    s_add_u32 s26, s26, 81920
    s_waitcnt vmcnt(20)
    s_barrier
    s_add_u32 m0, s28, 61440
    s_nop 0
    buffer_load_dwordx4 v4, s[12:15], s26 offen lds
    s_add_u32 m0, s28, 62464
    s_add_u32 s31, s26, 1024
    buffer_load_dwordx4 v4, s[12:15], s31 offen lds
    s_add_u32 m0, s28, 63488
    s_add_u32 s31, s26, 2048
    buffer_load_dwordx4 v4, s[12:15], s31 offen lds
    s_add_u32 m0, s28, 64512
    s_add_u32 s31, s26, 3072
    buffer_load_dwordx4 v4, s[12:15], s31 offen lds
    s_add_u32 m0, s28, 65536
    s_add_u32 s29, s26, 4096
    s_nop 0
    buffer_load_dwordx4 v4, s[12:15], s29 offen lds
    s_add_u32 s26, s26, 81920
    s_waitcnt vmcnt(20)
    s_barrier
    s_add_u32 m0, s28, 81920
    s_nop 0
    buffer_load_dwordx4 v4, s[12:15], s26 offen lds
    s_add_u32 m0, s28, 82944
    s_add_u32 s31, s26, 1024
    buffer_load_dwordx4 v4, s[12:15], s31 offen lds
    s_add_u32 m0, s28, 83968
    s_add_u32 s31, s26, 2048
    buffer_load_dwordx4 v4, s[12:15], s31 offen lds
    s_add_u32 m0, s28, 84992
    s_add_u32 s31, s26, 3072
    buffer_load_dwordx4 v4, s[12:15], s31 offen lds
    s_add_u32 m0, s28, 86016
    s_add_u32 s29, s26, 4096
    s_nop 0
    buffer_load_dwordx4 v4, s[12:15], s29 offen lds
    s_add_u32 s26, s26, 81920
    s_waitcnt vmcnt(20)
    s_barrier
    s_add_u32 m0, s28, 102400
    s_nop 0
    buffer_load_dwordx4 v4, s[12:15], s26 offen lds
    s_add_u32 m0, s28, 103424
    s_add_u32 s31, s26, 1024
    buffer_load_dwordx4 v4, s[12:15], s31 offen lds
    s_add_u32 m0, s28, 104448
    s_add_u32 s31, s26, 2048
    buffer_load_dwordx4 v4, s[12:15], s31 offen lds
    s_add_u32 m0, s28, 105472
    s_add_u32 s31, s26, 3072
    buffer_load_dwordx4 v4, s[12:15], s31 offen lds
    s_add_u32 m0, s28, 106496
    s_add_u32 s29, s26, 4096
    s_nop 0
    buffer_load_dwordx4 v4, s[12:15], s29 offen lds
    s_add_u32 s26, s26, 81920
    s_waitcnt vmcnt(20)
    s_barrier
    s_add_u32 m0, s28, 0
    s_nop 0
    buffer_load_dwordx4 v4, s[12:15], s26 offen lds
    s_add_u32 m0, s28, 1024
    s_add_u32 s31, s26, 1024
    buffer_load_dwordx4 v4, s[12:15], s31 offen lds
    s_add_u32 m0, s28, 2048
    s_add_u32 s31, s26, 2048
    buffer_load_dwordx4 v4, s[12:15], s31 offen lds
    s_add_u32 m0, s28, 3072
    s_add_u32 s31, s26, 3072
    buffer_load_dwordx4 v4, s[12:15], s31 offen lds
    s_add_u32 m0, s28, 4096
    s_add_u32 s29, s26, 4096
    s_nop 0
    buffer_load_dwordx4 v4, s[12:15], s29 offen lds
    s_add_u32 s26, s26, 81920
    s_waitcnt vmcnt(20)
    s_barrier
    s_add_u32 m0, s28, 20480
    s_nop 0
    buffer_load_dwordx4 v4, s[12:15], s26 offen lds
    s_add_u32 m0, s28, 21504
    s_add_u32 s31, s26, 1024
    buffer_load_dwordx4 v4, s[12:15], s31 offen lds
    s_add_u32 m0, s28, 22528
    s_add_u32 s31, s26, 2048
    buffer_load_dwordx4 v4, s[12:15], s31 offen lds
    s_add_u32 m0, s28, 23552
    s_add_u32 s31, s26, 3072
    buffer_load_dwordx4 v4, s[12:15], s31 offen lds
    s_add_u32 m0, s28, 24576
    s_add_u32 s29, s26, 4096
    s_nop 0
    buffer_load_dwordx4 v4, s[12:15], s29 offen lds
    s_add_u32 s26, s26, 81920
    s_waitcnt vmcnt(20)
    s_barrier
    s_waitcnt vmcnt(15)
    s_barrier
    s_waitcnt vmcnt(10)
    s_barrier
    s_waitcnt vmcnt(5)
    s_barrier
    s_waitcnt vmcnt(0)
    s_barrier
    s_barrier
    s_endpgm
K6_end:
    s_endpgm
.section .rodata,"a"
.p2align 6
.amdhsa_kernel k1_kernel
  .amdhsa_next_free_vgpr 168
  .amdhsa_next_free_sgpr 102
  .amdhsa_accum_offset 168
  .amdhsa_group_segment_fixed_size 0
  .amdhsa_kernarg_size 152
  .amdhsa_user_sgpr_count 2
  .amdhsa_user_sgpr_kernarg_segment_ptr 1
  .amdhsa_system_sgpr_workgroup_id_x 1
.end_amdhsa_kernel
.p2align 6
.amdhsa_kernel k2_kernel
  .amdhsa_next_free_vgpr 224
  .amdhsa_next_free_sgpr 102
  .amdhsa_accum_offset 224
  .amdhsa_group_segment_fixed_size 0
  .amdhsa_kernarg_size 152
  .amdhsa_user_sgpr_count 2
  .amdhsa_user_sgpr_kernarg_segment_ptr 1
  .amdhsa_system_sgpr_workgroup_id_x 1
.end_amdhsa_kernel
.p2align 6
.amdhsa_kernel adaLN_cond__ssm_conv_s4__mixer_s_mlp__prompt_kernel
  .amdhsa_next_free_vgpr 256
  .amdhsa_next_free_sgpr 102
  .amdhsa_accum_offset 256
  .amdhsa_group_segment_fixed_size 0
  .amdhsa_kernarg_size 152
  .amdhsa_user_sgpr_count 2
  .amdhsa_user_sgpr_kernarg_segment_ptr 1
  .amdhsa_system_sgpr_workgroup_id_x 1
.end_amdhsa_kernel
```
